```python
import torch

def _softmax(x, axis=-1):
    return torch.softmax(x, dim=axis)
def _gelu(x):
    return torch.nn.functional.gelu(x, approximate="tanh")
def _silu(x):
    return torch.nn.functional.silu(x)
def _sigmoid(x):
    return torch.sigmoid(x)
def _layernorm(x, axis=-1, eps=1e-5):
    m = x.mean(dim=axis, keepdim=True)
    v = x.var(dim=axis, keepdim=True, unbiased=False)
    return (x - m) / torch.sqrt(v + eps)
def _scatter_add(tgt, idx, src, axis=0):
    return tgt.clone().index_add_(axis, idx, src)
def _segment_sum(src, seg, n):
    out = torch.zeros((n,) + src.shape[1:], dtype=src.dtype)
    return out.index_add_(0, seg, src)
def _pad(x, pw):
    flat = tuple(v for pair in reversed(pw) for v in pair)
    return torch.nn.functional.pad(x, flat)

kernel_name = 'recurrent_scan__ssm_conv_s4d__mixer_channel_mlp__prompt'

def setup_inputs():

    _w = (lambda a: (lambda t: t.to(torch.bfloat16) if t.is_floating_point() else t)(torch.as_tensor(a)))
    def _A_setup():
        Bsz, L, D, N = 1, 2048, 576, 128
        return {
            "u": _w((lambda *s: torch.randn(*s, dtype=torch.bfloat16) * 0.05)(Bsz, L, D)),
            "log_A_real": _w((lambda *s: torch.randn(*s, dtype=torch.bfloat16) * 3.2)(D, N) * 0.5),
            "A_imag": _w((lambda *s: torch.randn(*s, dtype=torch.bfloat16) * 0.2)(D, N) * 3.14),
            "C_real": _w((lambda *s: torch.randn(*s, dtype=torch.bfloat16) * 0.4)(D, N) / N ** 0.5),
            "C_imag": _w((lambda *s: torch.randn(*s, dtype=torch.bfloat16) * 0.4)(D, N) / N ** 0.5),
            "log_dt": _w((lambda *s: torch.randn(*s, dtype=torch.bfloat16) * 0.2)(D) * 0.5 - 4.0),
            "D_skip": _w((lambda *s: torch.randn(*s, dtype=torch.bfloat16) * 0.2)(D)),
        }
    _A_in = _A_setup()

    def _B_setup():
        B, S, D, F = 1, 2048, 576, 4608
        return {
            "x": _w((lambda *s: torch.randn(*s, dtype=torch.bfloat16) * 0.05)(B, S, D)),
            "w1": _w((lambda *s: torch.randn(*s, dtype=torch.bfloat16) * 0.8)(D, F) * (D ** -0.5)),
            "b1": _w((lambda *s: torch.randn(*s, dtype=torch.bfloat16) * 0.4)(F)),
            "w2": _w((lambda *s: torch.randn(*s, dtype=torch.bfloat16) * 0.1)(F, D) * (F ** -0.5)),
            "b2": _w((lambda *s: torch.randn(*s, dtype=torch.bfloat16) * 0.1)(D)),
        }
    _B_in = _B_setup()

    return {
        "A_u": _A_in["u"],
        "A_log_A_real": _A_in["log_A_real"],
        "A_A_imag": _A_in["A_imag"],
        "A_C_real": _A_in["C_real"],
        "A_C_imag": _A_in["C_imag"],
        "A_log_dt": _A_in["log_dt"],
        "A_D_skip": _A_in["D_skip"],
        "B_x": _B_in["x"],
        "B_w1": _B_in["w1"],
        "B_b1": _B_in["b1"],
        "B_w2": _B_in["w2"],
        "B_b2": _B_in["b2"],
    }

def reference(A_u, A_log_A_real, A_A_imag, A_C_real, A_C_imag, A_log_dt, A_D_skip, B_x, B_w1, B_b1, B_w2, B_b2):
    def _A_ref(u, log_A_real, A_imag, C_real, C_imag, log_dt, D_skip):
        L = u.shape[1]
        dt = torch.exp(log_dt)
        A = -torch.exp(log_A_real) + 1j * A_imag
        C = (C_real + 1j * C_imag) * dt[:, None]
        pos = (lambda x, dt: x.to(dt))(torch.arange(L), log_dt.dtype)
        P = torch.exp((A * dt[:, None])[:, :, None] * pos[None, None, :])
        K = 2.0 * torch.einsum("dn,dnl->dl", C, P).real
        L2 = 2 * L
        u_t = (lambda x, *d: x.permute(*d))(u, 0, 2, 1)
        Kf = (lambda x, *a, **k: torch.fft.rfft(x.float(), *a, **k))(K, L2)
        Uf = (lambda x, *a, **k: torch.fft.rfft(x.float(), *a, **k))(u_t, L2)
        y = (lambda x, *a, **k: torch.fft.irfft(x, *a, **k).to(torch.bfloat16))(Uf * Kf[None, :, :], L2)[:, :, :L]
        y = (lambda x, *d: x.permute(*d))(y, 0, 2, 1)
        return y + u * D_skip[None, None, :]

    def _B_ref(x, w1, b1, w2, b2):
        y = _layernorm(x, axis=-1)
        h = _gelu(torch.einsum("bsd,df->bsf", y, w1) + b1)
        return torch.einsum("bsf,fd->bsd", h, w2) + b2

    x = A_u
    xn = _layernorm(x, axis=-1)
    s = _A_ref(xn, A_log_A_real, A_A_imag, A_C_real, A_C_imag, A_log_dt, A_D_skip)
    g = _silu(_B_ref(xn, B_w1, B_b1, B_w2, B_b2))
    return x + s * g
```

```asm
; @launch grid=(256,1,1) block=(512,1,1) lds=163840
.amdgcn_target "amdgcn-amd-amdhsa--gfx950"
.text
.globl recurrent_scan__ssm_conv_s4d__mixer_channel_mlp__prompt_kernel
.p2align 8
.type recurrent_scan__ssm_conv_s4d__mixer_channel_mlp__prompt_kernel,@function
recurrent_scan__ssm_conv_s4d__mixer_channel_mlp__prompt_kernel:
    s_cmp_ge_u32 s2, 256
    s_cbranch_scc1 L_end
    s_load_dwordx16 s[16:31], s[0:1], 0
    s_load_dwordx8 s[32:39], s[0:1], 64
    s_load_dwordx4 s[40:43], s[0:1], 96
    s_load_dwordx2 s[44:45], s[0:1], 112
    v_and_b32 v1, 63, v0
    s_getpc_b64 s[6:7]
L_pc0:
    s_lshr_b32 s8, s2, 3
    s_mul_i32 s8, s8, 2048
    v_lshlrev_b32 v2, 6, v1
    v_add_u32 v2, s8, v2
    v_min_u32 v3, L_code_end-L_pc0-64, v2
    v_subrev_u32 v4, 448, v0
    v_cmp_gt_u32 vcc, 32, v4
    s_and_saveexec_b64 s[10:11], vcc
    s_cbranch_execz L_cpf_1
    global_load_dword v255, v3, s[6:7]
L_cpf_1:
    s_mov_b64 exec, s[10:11]
    v_lshrrev_b32 v2, 6, v0
    s_nop 0
    v_readfirstlane_b32 s5, v2
    s_and_b32 s6, s2, 7
    s_lshr_b32 s7, s2, 3
    s_lshr_b32 s8, s6, 2
    s_lshl_b32 s8, s8, 4
    s_and_b32 s9, s7, 15
    s_add_u32 s3, s8, s9
    s_and_b32 s6, s6, 3
    s_lshl_b32 s6, s6, 1
    s_lshr_b32 s7, s7, 4
    s_add_u32 s4, s6, s7
    v_mov_b32 v63, 0
    v_mov_b32 v224, 0
    s_waitcnt lgkmcnt(0)
    s_mov_b32 s48, s16
    s_and_b32 s49, s17, 0xffff
    s_mov_b32 s50, 2359296
    s_mov_b32 s51, 0x20000
    s_mov_b32 s52, s44
    s_and_b32 s53, s45, 0xffff
    s_mov_b32 s54, 268435456
    s_mov_b32 s55, 0x20000
    s_mov_b32 s56, s32
    s_and_b32 s57, s33, 0xffff
    s_mov_b32 s58, 5308416
    s_mov_b32 s59, 0x20000
    s_mov_b32 s60, s36
    s_and_b32 s61, s37, 0xffff
    s_mov_b32 s62, 5308416
    s_mov_b32 s63, 0x20000
    s_mov_b32 s64, s40
    s_and_b32 s65, s41, 0xffff
    s_mov_b32 s66, 2359296
    s_mov_b32 s67, 0x20000
    s_mov_b32 s68, s42
    s_and_b32 s69, s43, 0xffff
    s_mov_b32 s70, 256
    s_mov_b32 s71, 0x20000
    s_lshr_b32 s6, s5, 1
    s_lshl_b32 s7, s6, 8
    s_lshr_b32 s8, s2, 2
    s_cmp_eq_u32 s6, 2
    s_cselect_b32 s8, s8, s2
    s_add_u32 s79, s7, s8
    s_cmp_lt_u32 s5, 6
    s_cselect_b32 s83, 1, 0
    s_cbranch_scc0 L_no_k_2
    s_and_b32 s6, s5, 1
    s_lshl_b32 s6, s6, 7
    s_lshl_b32 s7, s79, 8
    s_add_u32 s8, s7, s6
    s_xor_b32 s6, s6, 128
    s_add_u32 s9, s7, s6
    v_lshlrev_b32 v2, 1, v1
    v_add_u32 v3, s9, v2
    v_add_u32 v2, s8, v2
    s_lshl_b32 s7, s79, 1
    v_mov_b32 v4, s7
    global_load_ushort v54, v2, s[18:19]
    global_load_ushort v55, v2, s[20:21]
    global_load_ushort v56, v2, s[22:23]
    global_load_ushort v57, v2, s[24:25]
    global_load_ushort v58, v3, s[22:23]
    global_load_ushort v59, v3, s[24:25]
    global_load_ushort v60, v4, s[26:27]
    global_load_ushort v61, v4, s[28:29]
L_no_k_2:
    s_lshl_b32 s46, s5, 12
    s_add_u32 s46, s46, 98304
    s_cmp_eq_u32 s5, 4
    s_cbranch_scc1 L_w45_3
    s_cmp_eq_u32 s5, 5
    s_cbranch_scc1 L_w45_3
    s_lshl_b32 s6, s3, 6
    s_lshl_b32 s7, s5, 3
    s_add_u32 s6, s6, s7
    s_mul_i32 s6, s6, 1152
    s_mul_i32 s7, s4, 9
    v_lshrrev_b32 v2, 3, v1
    v_mul_u32_u24 v2, 1152, v2
    v_add_u32 v2, s6, v2
    v_and_b32 v3, 7, v1
    v_add_u32 v3, s7, v3
    s_bitcmp1_b32 s2, 7
    s_cbranch_scc1 L_xrev_5
    v_add_u32 v5, 0xffffffb8, v3
    v_min_u32 v44, v3, v5
    v_lshl_add_u32 v5, v44, 4, v2
    buffer_load_dwordx4 v[8:11], v5, s[48:51], 0 offen
    v_add_u32 v4, 8, v3
    v_add_u32 v5, 0xffffffb8, v4
    v_min_u32 v45, v4, v5
    v_lshl_add_u32 v5, v45, 4, v2
    buffer_load_dwordx4 v[12:15], v5, s[48:51], 0 offen
    v_add_u32 v4, 16, v3
    v_add_u32 v5, 0xffffffb8, v4
    v_min_u32 v46, v4, v5
    v_lshl_add_u32 v5, v46, 4, v2
    buffer_load_dwordx4 v[16:19], v5, s[48:51], 0 offen
    v_add_u32 v4, 24, v3
    v_add_u32 v5, 0xffffffb8, v4
    v_min_u32 v47, v4, v5
    v_lshl_add_u32 v5, v47, 4, v2
    buffer_load_dwordx4 v[20:23], v5, s[48:51], 0 offen
    v_add_u32 v4, 32, v3
    v_add_u32 v5, 0xffffffb8, v4
    v_min_u32 v48, v4, v5
    v_lshl_add_u32 v5, v48, 4, v2
    buffer_load_dwordx4 v[24:27], v5, s[48:51], 0 offen
    v_add_u32 v4, 40, v3
    v_add_u32 v5, 0xffffffb8, v4
    v_min_u32 v49, v4, v5
    v_lshl_add_u32 v5, v49, 4, v2
    buffer_load_dwordx4 v[28:31], v5, s[48:51], 0 offen
    v_add_u32 v4, 48, v3
    v_add_u32 v5, 0xffffffb8, v4
    v_min_u32 v50, v4, v5
    v_lshl_add_u32 v5, v50, 4, v2
    buffer_load_dwordx4 v[32:35], v5, s[48:51], 0 offen
    v_add_u32 v4, 56, v3
    v_add_u32 v5, 0xffffffb8, v4
    v_min_u32 v51, v4, v5
    v_lshl_add_u32 v5, v51, 4, v2
    buffer_load_dwordx4 v[36:39], v5, s[48:51], 0 offen
    v_add_u32 v4, 64, v3
    v_add_u32 v5, 0xffffffb8, v4
    v_min_u32 v52, v4, v5
    v_lshl_add_u32 v5, v52, 4, v2
    buffer_load_dwordx4 v[40:43], v5, s[48:51], 0 offen
    s_branch L_xdone_6
L_xrev_5:
    v_add_u32 v4, 64, v3
    v_add_u32 v5, 0xffffffb8, v4
    v_min_u32 v52, v4, v5
    v_lshl_add_u32 v5, v52, 4, v2
    buffer_load_dwordx4 v[40:43], v5, s[48:51], 0 offen
    v_add_u32 v4, 56, v3
    v_add_u32 v5, 0xffffffb8, v4
    v_min_u32 v51, v4, v5
    v_lshl_add_u32 v5, v51, 4, v2
    buffer_load_dwordx4 v[36:39], v5, s[48:51], 0 offen
    v_add_u32 v4, 48, v3
    v_add_u32 v5, 0xffffffb8, v4
    v_min_u32 v50, v4, v5
    v_lshl_add_u32 v5, v50, 4, v2
    buffer_load_dwordx4 v[32:35], v5, s[48:51], 0 offen
    v_add_u32 v4, 40, v3
    v_add_u32 v5, 0xffffffb8, v4
    v_min_u32 v49, v4, v5
    v_lshl_add_u32 v5, v49, 4, v2
    buffer_load_dwordx4 v[28:31], v5, s[48:51], 0 offen
    v_add_u32 v4, 32, v3
    v_add_u32 v5, 0xffffffb8, v4
    v_min_u32 v48, v4, v5
    v_lshl_add_u32 v5, v48, 4, v2
    buffer_load_dwordx4 v[24:27], v5, s[48:51], 0 offen
    v_add_u32 v4, 24, v3
    v_add_u32 v5, 0xffffffb8, v4
    v_min_u32 v47, v4, v5
    v_lshl_add_u32 v5, v47, 4, v2
    buffer_load_dwordx4 v[20:23], v5, s[48:51], 0 offen
    v_add_u32 v4, 16, v3
    v_add_u32 v5, 0xffffffb8, v4
    v_min_u32 v46, v4, v5
    v_lshl_add_u32 v5, v46, 4, v2
    buffer_load_dwordx4 v[16:19], v5, s[48:51], 0 offen
    v_add_u32 v4, 8, v3
    v_add_u32 v5, 0xffffffb8, v4
    v_min_u32 v45, v4, v5
    v_lshl_add_u32 v5, v45, 4, v2
    buffer_load_dwordx4 v[12:15], v5, s[48:51], 0 offen
    v_add_u32 v5, 0xffffffb8, v3
    v_min_u32 v44, v3, v5
    v_lshl_add_u32 v5, v44, 4, v2
    buffer_load_dwordx4 v[8:11], v5, s[48:51], 0 offen
L_xdone_6:
    s_mul_i32 s6, s4, 1152
    v_min_u32 v2, 287, v0
    v_lshlrev_b32 v2, 2, v2
    v_add_u32 v3, s6, v2
    global_load_dword v62, v3, s[34:35]
    s_cmp_ge_u32 s5, 6
    s_cbranch_scc1 L_w1pf_7
    s_lshr_b32 s6, s2, 3
    s_and_b32 s6, s6, 15
    s_mul_i32 s7, s5, 864
    s_add_u32 s6, s6, s7
    v_add_u32 v2, 0, v1
    v_min_u32 v2, 53, v2
    v_lshl_add_u32 v2, v2, 4, s6
    v_mul_u32_u24 v3, 3641, v2
    v_lshrrev_b32 v3, 15, v3
    v_mul_u32_u24 v4, 9, v3
    v_sub_u32 v4, v2, v4
    v_mul_u32_u24 v3, 9216, v3
    v_lshl_add_u32 v3, v4, 7, v3
    s_mul_i32 s8, s4, 1152
    buffer_load_dword v255, v3, s[56:59], s8 offen
L_w1pf_7:
    s_sub_u32 s9, 7, s5
    s_lshl_b32 s9, s9, 8
    s_add_u32 s9, s9, s2
    s_cmp_lt_u32 s9, 1296
    s_cselect_b32 s47, 1, 0
    s_cbranch_scc0 L_no_u1_8
    s_mul_i32 s77, s9, 1619
    s_lshr_b32 s77, s77, 18
    s_mul_i32 s6, s77, 162
    s_sub_u32 s7, s9, s6
    s_mul_i32 s78, s7, 57
    s_lshr_b32 s78, s78, 9
    s_mul_i32 s6, s78, 9
    s_sub_u32 s79, s7, s6
    v_lshrrev_b32 v2, 3, v1
    v_and_b32 v3, 7, v1
    v_lshlrev_b32 v3, 4, v3
    s_mul_i32 s6, s77, 576
    s_lshl_b32 s7, s78, 5
    s_add_u32 s6, s6, s7
    s_mul_i32 s6, s6, 1152
    s_mov_b32 s7, 0
    s_add_u32 s6, s6, s7
    s_lshl_b32 s7, s79, 7
    s_add_u32 s6, s6, s7
    v_mul_u32_u24 v2, 1152, v2
    v_add_u32 v2, v2, v3
    s_add_u32 m0, s46, 0
    s_nop 0
    buffer_load_dwordx4 v2, s[60:63], s6 offen nt lds
    s_add_u32 s6, s6, 9216
    s_add_u32 m0, s46, 1024
    s_nop 0
    buffer_load_dwordx4 v2, s[60:63], s6 offen nt lds
    s_add_u32 s6, s6, 9216
    s_add_u32 m0, s46, 2048
    s_nop 0
    buffer_load_dwordx4 v2, s[60:63], s6 offen nt lds
    s_add_u32 s6, s6, 9216
    s_add_u32 m0, s46, 3072
    s_nop 0
    buffer_load_dwordx4 v2, s[60:63], s6 offen nt lds
    s_mul_i32 s15, s77, 1296
    s_mul_i32 s12, s77, 9
    s_lshr_b32 s12, s12, 1
    s_add_u32 s13, s78, 18
    s_lshl_b32 s8, s79, 2
    s_add_u32 s8, s8, 36
    s_sub_u32 s8, s8, s12
    s_sub_u32 s9, s8, 36
    s_min_u32 s8, s8, s9
    s_and_b32 s9, s8, 7
    s_lshr_b32 s10, s8, 3
    s_sub_u32 s11, s8, 32
    s_cmp_ge_u32 s8, 32
    s_cselect_b32 s9, s11, s9
    s_cmp_lt_u32 s9, 4
    s_cselect_b32 s11, 5, 4
    s_mul_i32 s11, s11, s13
    s_add_u32 s11, s11, s10
    s_mul_i32 s14, s78, 3
    s_add_u32 s14, s14, s10
    s_add_u32 s14, s14, 71
    s_add_u32 s6, s78, 126
    s_cmp_eq_u32 s10, 0
    s_cselect_b32 s14, s6, s14
    s_cmp_ge_u32 s9, 4
    s_cselect_b32 s11, s14, s11
    s_mul_i32 s14, s9, 144
    s_min_u32 s9, s9, 4
    s_mul_i32 s9, s9, 36
    s_add_u32 s14, s14, s9
    s_add_u32 s14, s14, s11
    s_add_u32 s14, s14, s15
    s_lshl_b32 s18, s14, 10
    s_lshl_b32 s8, s79, 2
    s_add_u32 s8, s8, 37
    s_sub_u32 s8, s8, s12
    s_sub_u32 s9, s8, 36
    s_min_u32 s8, s8, s9
    s_and_b32 s9, s8, 7
    s_lshr_b32 s10, s8, 3
    s_sub_u32 s11, s8, 32
    s_cmp_ge_u32 s8, 32
    s_cselect_b32 s9, s11, s9
    s_cmp_lt_u32 s9, 4
    s_cselect_b32 s11, 5, 4
    s_mul_i32 s11, s11, s13
    s_add_u32 s11, s11, s10
    s_mul_i32 s14, s78, 3
    s_add_u32 s14, s14, s10
    s_add_u32 s14, s14, 71
    s_add_u32 s6, s78, 126
    s_cmp_eq_u32 s10, 0
    s_cselect_b32 s14, s6, s14
    s_cmp_ge_u32 s9, 4
    s_cselect_b32 s11, s14, s11
    s_mul_i32 s14, s9, 144
    s_min_u32 s9, s9, 4
    s_mul_i32 s9, s9, 36
    s_add_u32 s14, s14, s9
    s_add_u32 s14, s14, s11
    s_add_u32 s14, s14, s15
    s_lshl_b32 s19, s14, 10
    s_lshl_b32 s8, s79, 2
    s_add_u32 s8, s8, 38
    s_sub_u32 s8, s8, s12
    s_sub_u32 s9, s8, 36
    s_min_u32 s8, s8, s9
    s_and_b32 s9, s8, 7
    s_lshr_b32 s10, s8, 3
    s_sub_u32 s11, s8, 32
    s_cmp_ge_u32 s8, 32
    s_cselect_b32 s9, s11, s9
    s_cmp_lt_u32 s9, 4
    s_cselect_b32 s11, 5, 4
    s_mul_i32 s11, s11, s13
    s_add_u32 s11, s11, s10
    s_mul_i32 s14, s78, 3
    s_add_u32 s14, s14, s10
    s_add_u32 s14, s14, 71
    s_add_u32 s6, s78, 126
    s_cmp_eq_u32 s10, 0
    s_cselect_b32 s14, s6, s14
    s_cmp_ge_u32 s9, 4
    s_cselect_b32 s11, s14, s11
    s_mul_i32 s14, s9, 144
    s_min_u32 s9, s9, 4
    s_mul_i32 s9, s9, 36
    s_add_u32 s14, s14, s9
    s_add_u32 s14, s14, s11
    s_add_u32 s14, s14, s15
    s_lshl_b32 s20, s14, 10
    s_lshl_b32 s8, s79, 2
    s_add_u32 s8, s8, 39
    s_sub_u32 s8, s8, s12
    s_sub_u32 s9, s8, 36
    s_min_u32 s8, s8, s9
    s_and_b32 s9, s8, 7
    s_lshr_b32 s10, s8, 3
    s_sub_u32 s11, s8, 32
    s_cmp_ge_u32 s8, 32
    s_cselect_b32 s9, s11, s9
    s_cmp_lt_u32 s9, 4
    s_cselect_b32 s11, 5, 4
    s_mul_i32 s11, s11, s13
    s_add_u32 s11, s11, s10
    s_mul_i32 s14, s78, 3
    s_add_u32 s14, s14, s10
    s_add_u32 s14, s14, 71
    s_add_u32 s6, s78, 126
    s_cmp_eq_u32 s10, 0
    s_cselect_b32 s14, s6, s14
    s_cmp_ge_u32 s9, 4
    s_cselect_b32 s11, s14, s11
    s_mul_i32 s14, s9, 144
    s_min_u32 s9, s9, 4
    s_mul_i32 s9, s9, 36
    s_add_u32 s14, s14, s9
    s_add_u32 s14, s14, s11
    s_add_u32 s14, s14, s15
    s_lshl_b32 s21, s14, 10
L_no_u1_8:
    s_cmp_ge_u32 s5, 6
    s_cbranch_scc1 L_wc6_9
    s_cmp_eq_u32 s47, 0
    s_cbranch_scc1 L_wc0_10
    s_waitcnt vmcnt(15)
    s_branch L_wcd_12
L_wc0_10:
    s_waitcnt vmcnt(11)
    s_branch L_wcd_12
L_wc6_9:
    s_waitcnt vmcnt(14)
L_wcd_12:
    s_cmp_eq_u32 s83, 0
    s_cbranch_scc1 L_tab_skip_13
    v_and_b32 v111, 0x7fff, v56
    v_and_b32 v112, 0x7fff, v57
    v_max_u32 v111, v111, v112
    v_and_b32 v112, 0x7fff, v58
    v_and_b32 v113, 0x7fff, v59
    v_max3_u32 v111, v111, v112, v113
    s_nop 1
    v_max_u32_dpp v111, v111, v111 quad_perm:[1,0,3,2] row_mask:0xf bank_mask:0xf
    s_nop 1
    v_max_u32_dpp v111, v111, v111 quad_perm:[2,3,0,1] row_mask:0xf bank_mask:0xf
    s_nop 1
    v_max_u32_dpp v111, v111, v111 row_half_mirror row_mask:0xf bank_mask:0xf
    s_nop 1
    v_max_u32_dpp v111, v111, v111 row_mirror row_mask:0xf bank_mask:0xf
    s_nop 0
    v_readlane_b32 s6, v111, 0
    v_readlane_b32 s7, v111, 16
    v_readlane_b32 s8, v111, 32
    v_readlane_b32 s9, v111, 48
    v_lshlrev_b32 v54, 16, v54
    v_lshlrev_b32 v55, 16, v55
    v_lshlrev_b32 v56, 16, v56
    v_lshlrev_b32 v57, 16, v57
    v_lshlrev_b32 v60, 16, v60
    v_lshlrev_b32 v61, 16, v61
    v_mul_f32 v110, 0x3fb8aa3b, v60
    v_mul_f32 v108, 0x3fb8aa3b, v54
    v_exp_f32 v110, v110
    v_exp_f32 v108, v108
    s_max_u32 s6, s6, s7
    s_max_u32 s8, s8, s9
    s_max_u32 s6, s6, s8
    s_lshr_b32 s6, s6, 7
    s_max_u32 s6, s6, 1
    s_min_u32 s6, s6, 252
    s_sub_u32 s7, 253, s6
    s_lshl_b32 s7, s7, 23
    s_add_u32 s6, s6, 1
    s_lshl_b32 s6, s6, 23
    v_cvt_pk_bf16_f32 v110, v110, v110
    v_and_b32 v110, 0xffff0000, v110
    v_cvt_pk_bf16_f32 v108, v108, v108
    v_and_b32 v108, 0xffff0000, v108
    v_mul_f32 v108, v108, v110
    v_mul_f32 v109, v55, v110
    v_mul_f32 v108, 0xbfb8aa3b, v108
    v_mul_f32 v109, 0.15915494, v109
    v_add_f32 v111, v110, v110
    v_mul_f32 v111, s6, v111
    v_mov_b32 v112, v61
    s_lshr_b32 s8, s5, 1
    s_lshl_b32 s9, s8, 4
    s_add_u32 s9, s9, 163584
    v_mov_b32 v113, s9
    v_mov_b32 v96, v111
    v_mov_b32 v97, v112
    ds_write_b64 v113, v[96:97]
    v_mul_f32 v64, s7, v56
    v_mul_f32 v65, s7, v57
    v_sub_f32 v65, 0, v65
    v_exp_f32 v111, v108
    v_fract_f32 v112, v109
    v_cos_f32 v82, v112
    v_sin_f32 v83, v112
    v_mul_f32 v82, v111, v82
    v_mul_f32 v83, -v111, v83
    v_mul_f32 v111, 0x41000000, v108
    v_mul_f32 v112, 0x41000000, v109
    v_exp_f32 v111, v111
    v_fract_f32 v112, v112
    v_cos_f32 v88, v112
    v_sin_f32 v89, v112
    v_mul_f32 v88, v111, v88
    v_mul_f32 v89, v111, v89
    v_mul_f32 v111, 0x43000000, v108
    v_mul_f32 v112, 0x43000000, v109
    v_exp_f32 v111, v111
    v_fract_f32 v112, v112
    v_cos_f32 v86, v112
    v_sin_f32 v87, v112
    v_mul_f32 v86, v111, v86
    v_mul_f32 v87, -v111, v87
    s_lshr_b32 s8, s5, 1
    s_mul_i32 s8, s8, 32096
    s_and_b32 s9, s5, 1
    s_lshl_b32 s9, s9, 8
    s_add_u32 s8, s8, s9
    s_add_u32 s8, s8, 0
    v_lshl_add_u32 v114, v1, 2, s8
    v_pk_mul_f32 v[96:97], v[82:83], v[82:83] op_sel:[0,0] op_sel_hi:[0,1]
    v_pk_fma_f32 v[84:85], v[82:83], v[82:83], v[96:97] op_sel:[1,1,0] op_sel_hi:[1,0,1] neg_lo:[1,0,0]
    v_pk_mul_f32 v[98:99], v[88:89], v[88:89] op_sel:[0,0] op_sel_hi:[0,1]
    v_pk_fma_f32 v[90:91], v[88:89], v[88:89], v[98:99] op_sel:[1,1,0] op_sel_hi:[1,0,1] neg_lo:[1,0,0]
    v_mov_b32 v107, 0x3c00
    ds_write_b32 v114, v107 offset:0
    v_cvt_pk_f16_f32 v104, v88, v89
    ds_write_b32 v114, v104 offset:544
    v_cvt_pk_f16_f32 v105, v90, v91
    ds_write_b32 v114, v105 offset:1088
    v_pk_mul_f32 v[100:101], v[64:65], v[82:83] op_sel:[0,0] op_sel_hi:[0,1]
    v_pk_fma_f32 v[66:67], v[64:65], v[82:83], v[100:101] op_sel:[1,1,0] op_sel_hi:[1,0,1] neg_lo:[1,0,0]
    v_pk_mul_f32 v[102:103], v[88:89], v[90:91] op_sel:[0,0] op_sel_hi:[0,1]
    v_pk_fma_f32 v[94:95], v[88:89], v[90:91], v[102:103] op_sel:[1,1,0] op_sel_hi:[1,0,1] neg_lo:[1,0,0]
    v_pk_mul_f32 v[96:97], v[90:91], v[90:91] op_sel:[0,0] op_sel_hi:[0,1]
    v_pk_fma_f32 v[92:93], v[90:91], v[90:91], v[96:97] op_sel:[1,1,0] op_sel_hi:[1,0,1] neg_lo:[1,0,0]
    v_pk_mul_f32 v[98:99], v[64:65], v[84:85] op_sel:[0,0] op_sel_hi:[0,1]
    v_pk_fma_f32 v[68:69], v[64:65], v[84:85], v[98:99] op_sel:[1,1,0] op_sel_hi:[1,0,1] neg_lo:[1,0,0]
    v_pk_mul_f32 v[100:101], v[66:67], v[84:85] op_sel:[0,0] op_sel_hi:[0,1]
    v_pk_fma_f32 v[70:71], v[66:67], v[84:85], v[100:101] op_sel:[1,1,0] op_sel_hi:[1,0,1] neg_lo:[1,0,0]
    v_pk_mul_f32 v[102:103], v[68:69], v[84:85] op_sel:[0,0] op_sel_hi:[0,1]
    v_pk_fma_f32 v[72:73], v[68:69], v[84:85], v[102:103] op_sel:[1,1,0] op_sel_hi:[1,0,1] neg_lo:[1,0,0]
    v_pk_mul_f32 v[96:97], v[70:71], v[84:85] op_sel:[0,0] op_sel_hi:[0,1]
    v_pk_fma_f32 v[74:75], v[70:71], v[84:85], v[96:97] op_sel:[1,1,0] op_sel_hi:[1,0,1] neg_lo:[1,0,0]
    v_pk_mul_f32 v[98:99], v[72:73], v[84:85] op_sel:[0,0] op_sel_hi:[0,1]
    v_pk_fma_f32 v[76:77], v[72:73], v[84:85], v[98:99] op_sel:[1,1,0] op_sel_hi:[1,0,1] neg_lo:[1,0,0]
    v_pk_mul_f32 v[100:101], v[74:75], v[84:85] op_sel:[0,0] op_sel_hi:[0,1]
    v_pk_fma_f32 v[78:79], v[74:75], v[84:85], v[100:101] op_sel:[1,1,0] op_sel_hi:[1,0,1] neg_lo:[1,0,0]
    v_pk_mul_f32 v[102:103], v[76:77], v[84:85] op_sel:[0,0] op_sel_hi:[0,1]
    v_pk_fma_f32 v[80:81], v[76:77], v[84:85], v[102:103] op_sel:[1,1,0] op_sel_hi:[1,0,1] neg_lo:[1,0,0]
    v_cvt_pk_f16_f32 v106, v94, v95
    ds_write_b32 v114, v106 offset:1632
    v_cvt_pk_f16_f32 v107, v92, v93
    ds_write_b32 v114, v107 offset:2176
    v_cvt_pk_f16_f32 v104, v64, v65
    ds_write_b32 v114, v104 offset:8704
    v_pk_mul_f32 v[96:97], v[94:95], v[90:91] op_sel:[0,0] op_sel_hi:[0,1]
    v_pk_fma_f32 v[94:95], v[94:95], v[90:91], v[96:97] op_sel:[1,1,0] op_sel_hi:[1,0,1] neg_lo:[1,0,0]
    v_cvt_pk_f16_f32 v105, v94, v95
    ds_write_b32 v114, v105 offset:2720
    v_cvt_pk_f16_f32 v106, v66, v67
    ds_write_b32 v114, v106 offset:9248
    v_pk_mul_f32 v[98:99], v[92:93], v[90:91] op_sel:[0,0] op_sel_hi:[0,1]
    v_pk_fma_f32 v[92:93], v[92:93], v[90:91], v[98:99] op_sel:[1,1,0] op_sel_hi:[1,0,1] neg_lo:[1,0,0]
    v_cvt_pk_f16_f32 v107, v92, v93
    ds_write_b32 v114, v107 offset:3264
    v_cvt_pk_f16_f32 v104, v68, v69
    ds_write_b32 v114, v104 offset:9792
    v_pk_mul_f32 v[100:101], v[94:95], v[90:91] op_sel:[0,0] op_sel_hi:[0,1]
    v_pk_fma_f32 v[94:95], v[94:95], v[90:91], v[100:101] op_sel:[1,1,0] op_sel_hi:[1,0,1] neg_lo:[1,0,0]
    v_cvt_pk_f16_f32 v105, v94, v95
    ds_write_b32 v114, v105 offset:3808
    v_cvt_pk_f16_f32 v106, v70, v71
    ds_write_b32 v114, v106 offset:10336
    v_pk_mul_f32 v[102:103], v[92:93], v[90:91] op_sel:[0,0] op_sel_hi:[0,1]
    v_pk_fma_f32 v[92:93], v[92:93], v[90:91], v[102:103] op_sel:[1,1,0] op_sel_hi:[1,0,1] neg_lo:[1,0,0]
    v_cvt_pk_f16_f32 v107, v92, v93
    ds_write_b32 v114, v107 offset:4352
    v_cvt_pk_f16_f32 v104, v72, v73
    ds_write_b32 v114, v104 offset:10880
    v_pk_mul_f32 v[96:97], v[94:95], v[90:91] op_sel:[0,0] op_sel_hi:[0,1]
    v_pk_fma_f32 v[94:95], v[94:95], v[90:91], v[96:97] op_sel:[1,1,0] op_sel_hi:[1,0,1] neg_lo:[1,0,0]
    v_cvt_pk_f16_f32 v105, v94, v95
    ds_write_b32 v114, v105 offset:4896
    v_cvt_pk_f16_f32 v106, v74, v75
    ds_write_b32 v114, v106 offset:11424
    v_pk_mul_f32 v[98:99], v[92:93], v[90:91] op_sel:[0,0] op_sel_hi:[0,1]
    v_pk_fma_f32 v[92:93], v[92:93], v[90:91], v[98:99] op_sel:[1,1,0] op_sel_hi:[1,0,1] neg_lo:[1,0,0]
    v_cvt_pk_f16_f32 v107, v92, v93
    ds_write_b32 v114, v107 offset:5440
    v_cvt_pk_f16_f32 v104, v76, v77
    ds_write_b32 v114, v104 offset:11968
    v_pk_mul_f32 v[100:101], v[94:95], v[90:91] op_sel:[0,0] op_sel_hi:[0,1]
    v_pk_fma_f32 v[94:95], v[94:95], v[90:91], v[100:101] op_sel:[1,1,0] op_sel_hi:[1,0,1] neg_lo:[1,0,0]
    v_cvt_pk_f16_f32 v105, v94, v95
    ds_write_b32 v114, v105 offset:5984
    v_cvt_pk_f16_f32 v106, v78, v79
    ds_write_b32 v114, v106 offset:12512
    v_pk_mul_f32 v[102:103], v[92:93], v[90:91] op_sel:[0,0] op_sel_hi:[0,1]
    v_pk_fma_f32 v[92:93], v[92:93], v[90:91], v[102:103] op_sel:[1,1,0] op_sel_hi:[1,0,1] neg_lo:[1,0,0]
    v_cvt_pk_f16_f32 v107, v92, v93
    ds_write_b32 v114, v107 offset:6528
    v_pk_mul_f32 v[96:97], v[64:65], v[86:87] op_sel:[0,0] op_sel_hi:[0,1]
    v_pk_fma_f32 v[64:65], v[64:65], v[86:87], v[96:97] op_sel:[1,1,0] op_sel_hi:[1,0,1] neg_lo:[1,0,0]
    v_pk_mul_f32 v[98:99], v[66:67], v[86:87] op_sel:[0,0] op_sel_hi:[0,1]
    v_pk_fma_f32 v[66:67], v[66:67], v[86:87], v[98:99] op_sel:[1,1,0] op_sel_hi:[1,0,1] neg_lo:[1,0,0]
    v_pk_mul_f32 v[100:101], v[68:69], v[86:87] op_sel:[0,0] op_sel_hi:[0,1]
    v_pk_fma_f32 v[68:69], v[68:69], v[86:87], v[100:101] op_sel:[1,1,0] op_sel_hi:[1,0,1] neg_lo:[1,0,0]
    v_pk_mul_f32 v[102:103], v[70:71], v[86:87] op_sel:[0,0] op_sel_hi:[0,1]
    v_pk_fma_f32 v[70:71], v[70:71], v[86:87], v[102:103] op_sel:[1,1,0] op_sel_hi:[1,0,1] neg_lo:[1,0,0]
    v_pk_mul_f32 v[96:97], v[72:73], v[86:87] op_sel:[0,0] op_sel_hi:[0,1]
    v_pk_fma_f32 v[72:73], v[72:73], v[86:87], v[96:97] op_sel:[1,1,0] op_sel_hi:[1,0,1] neg_lo:[1,0,0]
    v_pk_mul_f32 v[98:99], v[74:75], v[86:87] op_sel:[0,0] op_sel_hi:[0,1]
    v_pk_fma_f32 v[74:75], v[74:75], v[86:87], v[98:99] op_sel:[1,1,0] op_sel_hi:[1,0,1] neg_lo:[1,0,0]
    v_pk_mul_f32 v[100:101], v[76:77], v[86:87] op_sel:[0,0] op_sel_hi:[0,1]
    v_pk_fma_f32 v[76:77], v[76:77], v[86:87], v[100:101] op_sel:[1,1,0] op_sel_hi:[1,0,1] neg_lo:[1,0,0]
    v_pk_mul_f32 v[102:103], v[78:79], v[86:87] op_sel:[0,0] op_sel_hi:[0,1]
    v_pk_fma_f32 v[78:79], v[78:79], v[86:87], v[102:103] op_sel:[1,1,0] op_sel_hi:[1,0,1] neg_lo:[1,0,0]
    v_pk_mul_f32 v[96:97], v[80:81], v[86:87] op_sel:[0,0] op_sel_hi:[0,1]
    v_pk_fma_f32 v[80:81], v[80:81], v[86:87], v[96:97] op_sel:[1,1,0] op_sel_hi:[1,0,1] neg_lo:[1,0,0]
    v_cvt_pk_f16_f32 v104, v64, v65
    ds_write_b32 v114, v104 offset:13056
    v_pk_mul_f32 v[98:99], v[94:95], v[90:91] op_sel:[0,0] op_sel_hi:[0,1]
    v_pk_fma_f32 v[94:95], v[94:95], v[90:91], v[98:99] op_sel:[1,1,0] op_sel_hi:[1,0,1] neg_lo:[1,0,0]
    v_cvt_pk_f16_f32 v105, v94, v95
    ds_write_b32 v114, v105 offset:7072
    v_cvt_pk_f16_f32 v106, v66, v67
    ds_write_b32 v114, v106 offset:13600
    v_pk_mul_f32 v[100:101], v[92:93], v[90:91] op_sel:[0,0] op_sel_hi:[0,1]
    v_pk_fma_f32 v[92:93], v[92:93], v[90:91], v[100:101] op_sel:[1,1,0] op_sel_hi:[1,0,1] neg_lo:[1,0,0]
    v_cvt_pk_f16_f32 v107, v92, v93
    ds_write_b32 v114, v107 offset:7616
    v_cvt_pk_f16_f32 v104, v68, v69
    ds_write_b32 v114, v104 offset:14144
    v_pk_mul_f32 v[102:103], v[94:95], v[90:91] op_sel:[0,0] op_sel_hi:[0,1]
    v_pk_fma_f32 v[94:95], v[94:95], v[90:91], v[102:103] op_sel:[1,1,0] op_sel_hi:[1,0,1] neg_lo:[1,0,0]
    v_cvt_pk_f16_f32 v105, v94, v95
    ds_write_b32 v114, v105 offset:8160
    v_cvt_pk_f16_f32 v106, v70, v71
    ds_write_b32 v114, v106 offset:14688
    v_cvt_pk_f16_f32 v107, v72, v73
    ds_write_b32 v114, v107 offset:15232
    v_cvt_pk_f16_f32 v104, v74, v75
    ds_write_b32 v114, v104 offset:15776
    v_cvt_pk_f16_f32 v105, v76, v77
    ds_write_b32 v114, v105 offset:16320
    v_cvt_pk_f16_f32 v106, v78, v79
    ds_write_b32 v114, v106 offset:16864
    v_pk_mul_f32 v[96:97], v[64:65], v[86:87] op_sel:[0,0] op_sel_hi:[0,1]
    v_pk_fma_f32 v[64:65], v[64:65], v[86:87], v[96:97] op_sel:[1,1,0] op_sel_hi:[1,0,1] neg_lo:[1,0,0]
    v_pk_mul_f32 v[98:99], v[68:69], v[86:87] op_sel:[0,0] op_sel_hi:[0,1]
    v_pk_fma_f32 v[68:69], v[68:69], v[86:87], v[98:99] op_sel:[1,1,0] op_sel_hi:[1,0,1] neg_lo:[1,0,0]
    v_pk_mul_f32 v[100:101], v[72:73], v[86:87] op_sel:[0,0] op_sel_hi:[0,1]
    v_pk_fma_f32 v[72:73], v[72:73], v[86:87], v[100:101] op_sel:[1,1,0] op_sel_hi:[1,0,1] neg_lo:[1,0,0]
    v_pk_mul_f32 v[102:103], v[76:77], v[86:87] op_sel:[0,0] op_sel_hi:[0,1]
    v_pk_fma_f32 v[76:77], v[76:77], v[86:87], v[102:103] op_sel:[1,1,0] op_sel_hi:[1,0,1] neg_lo:[1,0,0]
    v_pk_mul_f32 v[96:97], v[80:81], v[86:87] op_sel:[0,0] op_sel_hi:[0,1]
    v_pk_fma_f32 v[80:81], v[80:81], v[86:87], v[96:97] op_sel:[1,1,0] op_sel_hi:[1,0,1] neg_lo:[1,0,0]
    v_cvt_pk_f16_f32 v107, v64, v65
    ds_write_b32 v114, v107 offset:17408
    v_cvt_pk_f16_f32 v104, v68, v69
    ds_write_b32 v114, v104 offset:17952
    v_cvt_pk_f16_f32 v105, v72, v73
    ds_write_b32 v114, v105 offset:18496
    v_cvt_pk_f16_f32 v106, v76, v77
    ds_write_b32 v114, v106 offset:19040
    v_cvt_pk_f16_f32 v107, v80, v81
    ds_write_b32 v114, v107 offset:19584
    v_pk_mul_f32 v[98:99], v[64:65], v[86:87] op_sel:[0,0] op_sel_hi:[0,1]
    v_pk_fma_f32 v[64:65], v[64:65], v[86:87], v[98:99] op_sel:[1,1,0] op_sel_hi:[1,0,1] neg_lo:[1,0,0]
    v_pk_mul_f32 v[100:101], v[68:69], v[86:87] op_sel:[0,0] op_sel_hi:[0,1]
    v_pk_fma_f32 v[68:69], v[68:69], v[86:87], v[100:101] op_sel:[1,1,0] op_sel_hi:[1,0,1] neg_lo:[1,0,0]
    v_pk_mul_f32 v[102:103], v[72:73], v[86:87] op_sel:[0,0] op_sel_hi:[0,1]
    v_pk_fma_f32 v[72:73], v[72:73], v[86:87], v[102:103] op_sel:[1,1,0] op_sel_hi:[1,0,1] neg_lo:[1,0,0]
    v_pk_mul_f32 v[96:97], v[76:77], v[86:87] op_sel:[0,0] op_sel_hi:[0,1]
    v_pk_fma_f32 v[76:77], v[76:77], v[86:87], v[96:97] op_sel:[1,1,0] op_sel_hi:[1,0,1] neg_lo:[1,0,0]
    v_pk_mul_f32 v[98:99], v[80:81], v[86:87] op_sel:[0,0] op_sel_hi:[0,1]
    v_pk_fma_f32 v[80:81], v[80:81], v[86:87], v[98:99] op_sel:[1,1,0] op_sel_hi:[1,0,1] neg_lo:[1,0,0]
    v_cvt_pk_f16_f32 v104, v64, v65
    ds_write_b32 v114, v104 offset:20128
    v_cvt_pk_f16_f32 v105, v68, v69
    ds_write_b32 v114, v105 offset:20672
    v_cvt_pk_f16_f32 v106, v72, v73
    ds_write_b32 v114, v106 offset:21216
    v_cvt_pk_f16_f32 v107, v76, v77
    ds_write_b32 v114, v107 offset:21760
    v_cvt_pk_f16_f32 v104, v80, v81
    ds_write_b32 v114, v104 offset:22304
    v_pk_mul_f32 v[100:101], v[64:65], v[86:87] op_sel:[0,0] op_sel_hi:[0,1]
    v_pk_fma_f32 v[64:65], v[64:65], v[86:87], v[100:101] op_sel:[1,1,0] op_sel_hi:[1,0,1] neg_lo:[1,0,0]
    v_pk_mul_f32 v[102:103], v[72:73], v[86:87] op_sel:[0,0] op_sel_hi:[0,1]
    v_pk_fma_f32 v[72:73], v[72:73], v[86:87], v[102:103] op_sel:[1,1,0] op_sel_hi:[1,0,1] neg_lo:[1,0,0]
    v_cvt_pk_f16_f32 v105, v64, v65
    ds_write_b32 v114, v105 offset:22848
    v_cvt_pk_f16_f32 v106, v72, v73
    ds_write_b32 v114, v106 offset:23392
    v_pk_mul_f32 v[96:97], v[64:65], v[86:87] op_sel:[0,0] op_sel_hi:[0,1]
    v_pk_fma_f32 v[64:65], v[64:65], v[86:87], v[96:97] op_sel:[1,1,0] op_sel_hi:[1,0,1] neg_lo:[1,0,0]
    v_pk_mul_f32 v[98:99], v[72:73], v[86:87] op_sel:[0,0] op_sel_hi:[0,1]
    v_pk_fma_f32 v[72:73], v[72:73], v[86:87], v[98:99] op_sel:[1,1,0] op_sel_hi:[1,0,1] neg_lo:[1,0,0]
    v_cvt_pk_f16_f32 v107, v64, v65
    ds_write_b32 v114, v107 offset:23936
    v_cvt_pk_f16_f32 v104, v72, v73
    ds_write_b32 v114, v104 offset:24480
    v_pk_mul_f32 v[100:101], v[64:65], v[86:87] op_sel:[0,0] op_sel_hi:[0,1]
    v_pk_fma_f32 v[64:65], v[64:65], v[86:87], v[100:101] op_sel:[1,1,0] op_sel_hi:[1,0,1] neg_lo:[1,0,0]
    v_pk_mul_f32 v[102:103], v[72:73], v[86:87] op_sel:[0,0] op_sel_hi:[0,1]
    v_pk_fma_f32 v[72:73], v[72:73], v[86:87], v[102:103] op_sel:[1,1,0] op_sel_hi:[1,0,1] neg_lo:[1,0,0]
    v_cvt_pk_f16_f32 v105, v64, v65
    ds_write_b32 v114, v105 offset:25024
    v_cvt_pk_f16_f32 v106, v72, v73
    ds_write_b32 v114, v106 offset:25568
    v_pk_mul_f32 v[96:97], v[64:65], v[86:87] op_sel:[0,0] op_sel_hi:[0,1]
    v_pk_fma_f32 v[64:65], v[64:65], v[86:87], v[96:97] op_sel:[1,1,0] op_sel_hi:[1,0,1] neg_lo:[1,0,0]
    v_pk_mul_f32 v[98:99], v[72:73], v[86:87] op_sel:[0,0] op_sel_hi:[0,1]
    v_pk_fma_f32 v[72:73], v[72:73], v[86:87], v[98:99] op_sel:[1,1,0] op_sel_hi:[1,0,1] neg_lo:[1,0,0]
    v_cvt_pk_f16_f32 v107, v64, v65
    ds_write_b32 v114, v107 offset:26112
    v_cvt_pk_f16_f32 v104, v72, v73
    ds_write_b32 v114, v104 offset:26656
    v_pk_mul_f32 v[100:101], v[64:65], v[86:87] op_sel:[0,0] op_sel_hi:[0,1]
    v_pk_fma_f32 v[64:65], v[64:65], v[86:87], v[100:101] op_sel:[1,1,0] op_sel_hi:[1,0,1] neg_lo:[1,0,0]
    v_cvt_pk_f16_f32 v105, v64, v65
    ds_write_b32 v114, v105 offset:27200
    v_pk_mul_f32 v[102:103], v[64:65], v[86:87] op_sel:[0,0] op_sel_hi:[0,1]
    v_pk_fma_f32 v[64:65], v[64:65], v[86:87], v[102:103] op_sel:[1,1,0] op_sel_hi:[1,0,1] neg_lo:[1,0,0]
    v_cvt_pk_f16_f32 v106, v64, v65
    ds_write_b32 v114, v106 offset:27744
    v_pk_mul_f32 v[96:97], v[64:65], v[86:87] op_sel:[0,0] op_sel_hi:[0,1]
    v_pk_fma_f32 v[64:65], v[64:65], v[86:87], v[96:97] op_sel:[1,1,0] op_sel_hi:[1,0,1] neg_lo:[1,0,0]
    v_cvt_pk_f16_f32 v107, v64, v65
    ds_write_b32 v114, v107 offset:28288
    v_pk_mul_f32 v[98:99], v[64:65], v[86:87] op_sel:[0,0] op_sel_hi:[0,1]
    v_pk_fma_f32 v[64:65], v[64:65], v[86:87], v[98:99] op_sel:[1,1,0] op_sel_hi:[1,0,1] neg_lo:[1,0,0]
    v_cvt_pk_f16_f32 v104, v64, v65
    ds_write_b32 v114, v104 offset:28832
    v_pk_mul_f32 v[100:101], v[64:65], v[86:87] op_sel:[0,0] op_sel_hi:[0,1]
    v_pk_fma_f32 v[64:65], v[64:65], v[86:87], v[100:101] op_sel:[1,1,0] op_sel_hi:[1,0,1] neg_lo:[1,0,0]
    v_cvt_pk_f16_f32 v105, v64, v65
    ds_write_b32 v114, v105 offset:29376
    v_pk_mul_f32 v[102:103], v[64:65], v[86:87] op_sel:[0,0] op_sel_hi:[0,1]
    v_pk_fma_f32 v[64:65], v[64:65], v[86:87], v[102:103] op_sel:[1,1,0] op_sel_hi:[1,0,1] neg_lo:[1,0,0]
    v_cvt_pk_f16_f32 v106, v64, v65
    ds_write_b32 v114, v106 offset:29920
    v_pk_mul_f32 v[96:97], v[64:65], v[86:87] op_sel:[0,0] op_sel_hi:[0,1]
    v_pk_fma_f32 v[64:65], v[64:65], v[86:87], v[96:97] op_sel:[1,1,0] op_sel_hi:[1,0,1] neg_lo:[1,0,0]
    v_cvt_pk_f16_f32 v107, v64, v65
    ds_write_b32 v114, v107 offset:30464
    v_pk_mul_f32 v[98:99], v[64:65], v[86:87] op_sel:[0,0] op_sel_hi:[0,1]
    v_pk_fma_f32 v[64:65], v[64:65], v[86:87], v[98:99] op_sel:[1,1,0] op_sel_hi:[1,0,1] neg_lo:[1,0,0]
    v_cvt_pk_f16_f32 v104, v64, v65
    ds_write_b32 v114, v104 offset:31008
    v_pk_mul_f32 v[100:101], v[64:65], v[86:87] op_sel:[0,0] op_sel_hi:[0,1]
    v_pk_fma_f32 v[64:65], v[64:65], v[86:87], v[100:101] op_sel:[1,1,0] op_sel_hi:[1,0,1] neg_lo:[1,0,0]
    v_cvt_pk_f16_f32 v105, v64, v65
    ds_write_b32 v114, v105 offset:31552
L_tab_skip_13:
    s_branch L_w45j_4
L_w45_3:
    s_waitcnt vmcnt(0)
    s_cmp_eq_u32 s83, 0
    s_cbranch_scc1 L_tab_skip_14
    v_and_b32 v111, 0x7fff, v56
    v_and_b32 v112, 0x7fff, v57
    v_max_u32 v111, v111, v112
    v_and_b32 v112, 0x7fff, v58
    v_and_b32 v113, 0x7fff, v59
    v_max3_u32 v111, v111, v112, v113
    s_nop 1
    v_max_u32_dpp v111, v111, v111 quad_perm:[1,0,3,2] row_mask:0xf bank_mask:0xf
    s_nop 1
    v_max_u32_dpp v111, v111, v111 quad_perm:[2,3,0,1] row_mask:0xf bank_mask:0xf
    s_nop 1
    v_max_u32_dpp v111, v111, v111 row_half_mirror row_mask:0xf bank_mask:0xf
    s_nop 1
    v_max_u32_dpp v111, v111, v111 row_mirror row_mask:0xf bank_mask:0xf
    s_nop 0
    v_readlane_b32 s6, v111, 0
    v_readlane_b32 s7, v111, 16
    v_readlane_b32 s8, v111, 32
    v_readlane_b32 s9, v111, 48
    v_lshlrev_b32 v54, 16, v54
    v_lshlrev_b32 v55, 16, v55
    v_lshlrev_b32 v56, 16, v56
    v_lshlrev_b32 v57, 16, v57
    v_lshlrev_b32 v60, 16, v60
    v_lshlrev_b32 v61, 16, v61
    v_mul_f32 v110, 0x3fb8aa3b, v60
    v_mul_f32 v108, 0x3fb8aa3b, v54
    v_exp_f32 v110, v110
    v_exp_f32 v108, v108
    s_max_u32 s6, s6, s7
    s_max_u32 s8, s8, s9
    s_max_u32 s6, s6, s8
    s_lshr_b32 s6, s6, 7
    s_max_u32 s6, s6, 1
    s_min_u32 s6, s6, 252
    s_sub_u32 s7, 253, s6
    s_lshl_b32 s7, s7, 23
    s_add_u32 s6, s6, 1
    s_lshl_b32 s6, s6, 23
    v_cvt_pk_bf16_f32 v110, v110, v110
    v_and_b32 v110, 0xffff0000, v110
    v_cvt_pk_bf16_f32 v108, v108, v108
    v_and_b32 v108, 0xffff0000, v108
    v_mul_f32 v108, v108, v110
    v_mul_f32 v109, v55, v110
    v_mul_f32 v108, 0xbfb8aa3b, v108
    v_mul_f32 v109, 0.15915494, v109
    v_add_f32 v111, v110, v110
    v_mul_f32 v111, s6, v111
    v_mov_b32 v112, v61
    s_lshr_b32 s8, s5, 1
    s_lshl_b32 s9, s8, 4
    s_add_u32 s9, s9, 163584
    v_mov_b32 v113, s9
    v_mov_b32 v96, v111
    v_mov_b32 v97, v112
    ds_write_b64 v113, v[96:97]
    v_mul_f32 v64, s7, v56
    v_mul_f32 v65, s7, v57
    v_sub_f32 v65, 0, v65
    v_exp_f32 v111, v108
    v_fract_f32 v112, v109
    v_cos_f32 v82, v112
    v_sin_f32 v83, v112
    v_mul_f32 v82, v111, v82
    v_mul_f32 v83, -v111, v83
    v_mul_f32 v111, 0x41000000, v108
    v_mul_f32 v112, 0x41000000, v109
    v_exp_f32 v111, v111
    v_fract_f32 v112, v112
    v_cos_f32 v88, v112
    v_sin_f32 v89, v112
    v_mul_f32 v88, v111, v88
    v_mul_f32 v89, v111, v89
    v_mul_f32 v111, 0x43000000, v108
    v_mul_f32 v112, 0x43000000, v109
    v_exp_f32 v111, v111
    v_fract_f32 v112, v112
    v_cos_f32 v86, v112
    v_sin_f32 v87, v112
    v_mul_f32 v86, v111, v86
    v_mul_f32 v87, -v111, v87
    s_lshr_b32 s8, s5, 1
    s_mul_i32 s8, s8, 32096
    s_and_b32 s9, s5, 1
    s_lshl_b32 s9, s9, 8
    s_add_u32 s8, s8, s9
    s_add_u32 s8, s8, 0
    v_lshl_add_u32 v114, v1, 2, s8
    v_pk_mul_f32 v[96:97], v[82:83], v[82:83] op_sel:[0,0] op_sel_hi:[0,1]
    v_pk_fma_f32 v[84:85], v[82:83], v[82:83], v[96:97] op_sel:[1,1,0] op_sel_hi:[1,0,1] neg_lo:[1,0,0]
    v_pk_mul_f32 v[98:99], v[88:89], v[88:89] op_sel:[0,0] op_sel_hi:[0,1]
    v_pk_fma_f32 v[90:91], v[88:89], v[88:89], v[98:99] op_sel:[1,1,0] op_sel_hi:[1,0,1] neg_lo:[1,0,0]
    v_mov_b32 v107, 0x3c00
    ds_write_b32 v114, v107 offset:0
    v_cvt_pk_f16_f32 v104, v88, v89
    ds_write_b32 v114, v104 offset:544
    v_cvt_pk_f16_f32 v105, v90, v91
    ds_write_b32 v114, v105 offset:1088
    v_pk_mul_f32 v[100:101], v[64:65], v[82:83] op_sel:[0,0] op_sel_hi:[0,1]
    v_pk_fma_f32 v[66:67], v[64:65], v[82:83], v[100:101] op_sel:[1,1,0] op_sel_hi:[1,0,1] neg_lo:[1,0,0]
    v_pk_mul_f32 v[102:103], v[88:89], v[90:91] op_sel:[0,0] op_sel_hi:[0,1]
    v_pk_fma_f32 v[94:95], v[88:89], v[90:91], v[102:103] op_sel:[1,1,0] op_sel_hi:[1,0,1] neg_lo:[1,0,0]
    v_pk_mul_f32 v[96:97], v[90:91], v[90:91] op_sel:[0,0] op_sel_hi:[0,1]
    v_pk_fma_f32 v[92:93], v[90:91], v[90:91], v[96:97] op_sel:[1,1,0] op_sel_hi:[1,0,1] neg_lo:[1,0,0]
    v_pk_mul_f32 v[98:99], v[64:65], v[84:85] op_sel:[0,0] op_sel_hi:[0,1]
    v_pk_fma_f32 v[68:69], v[64:65], v[84:85], v[98:99] op_sel:[1,1,0] op_sel_hi:[1,0,1] neg_lo:[1,0,0]
    v_pk_mul_f32 v[100:101], v[66:67], v[84:85] op_sel:[0,0] op_sel_hi:[0,1]
    v_pk_fma_f32 v[70:71], v[66:67], v[84:85], v[100:101] op_sel:[1,1,0] op_sel_hi:[1,0,1] neg_lo:[1,0,0]
    v_pk_mul_f32 v[102:103], v[68:69], v[84:85] op_sel:[0,0] op_sel_hi:[0,1]
    v_pk_fma_f32 v[72:73], v[68:69], v[84:85], v[102:103] op_sel:[1,1,0] op_sel_hi:[1,0,1] neg_lo:[1,0,0]
    v_pk_mul_f32 v[96:97], v[70:71], v[84:85] op_sel:[0,0] op_sel_hi:[0,1]
    v_pk_fma_f32 v[74:75], v[70:71], v[84:85], v[96:97] op_sel:[1,1,0] op_sel_hi:[1,0,1] neg_lo:[1,0,0]
    v_pk_mul_f32 v[98:99], v[72:73], v[84:85] op_sel:[0,0] op_sel_hi:[0,1]
    v_pk_fma_f32 v[76:77], v[72:73], v[84:85], v[98:99] op_sel:[1,1,0] op_sel_hi:[1,0,1] neg_lo:[1,0,0]
    v_pk_mul_f32 v[100:101], v[74:75], v[84:85] op_sel:[0,0] op_sel_hi:[0,1]
    v_pk_fma_f32 v[78:79], v[74:75], v[84:85], v[100:101] op_sel:[1,1,0] op_sel_hi:[1,0,1] neg_lo:[1,0,0]
    v_pk_mul_f32 v[102:103], v[76:77], v[84:85] op_sel:[0,0] op_sel_hi:[0,1]
    v_pk_fma_f32 v[80:81], v[76:77], v[84:85], v[102:103] op_sel:[1,1,0] op_sel_hi:[1,0,1] neg_lo:[1,0,0]
    v_cvt_pk_f16_f32 v106, v94, v95
    ds_write_b32 v114, v106 offset:1632
    v_cvt_pk_f16_f32 v107, v92, v93
    ds_write_b32 v114, v107 offset:2176
    v_cvt_pk_f16_f32 v104, v64, v65
    ds_write_b32 v114, v104 offset:8704
    v_pk_mul_f32 v[96:97], v[94:95], v[90:91] op_sel:[0,0] op_sel_hi:[0,1]
    v_pk_fma_f32 v[94:95], v[94:95], v[90:91], v[96:97] op_sel:[1,1,0] op_sel_hi:[1,0,1] neg_lo:[1,0,0]
    v_cvt_pk_f16_f32 v105, v94, v95
    ds_write_b32 v114, v105 offset:2720
    v_cvt_pk_f16_f32 v106, v66, v67
    ds_write_b32 v114, v106 offset:9248
    v_pk_mul_f32 v[98:99], v[92:93], v[90:91] op_sel:[0,0] op_sel_hi:[0,1]
    v_pk_fma_f32 v[92:93], v[92:93], v[90:91], v[98:99] op_sel:[1,1,0] op_sel_hi:[1,0,1] neg_lo:[1,0,0]
    v_cvt_pk_f16_f32 v107, v92, v93
    ds_write_b32 v114, v107 offset:3264
    v_cvt_pk_f16_f32 v104, v68, v69
    ds_write_b32 v114, v104 offset:9792
    v_pk_mul_f32 v[100:101], v[94:95], v[90:91] op_sel:[0,0] op_sel_hi:[0,1]
    v_pk_fma_f32 v[94:95], v[94:95], v[90:91], v[100:101] op_sel:[1,1,0] op_sel_hi:[1,0,1] neg_lo:[1,0,0]
    v_cvt_pk_f16_f32 v105, v94, v95
    ds_write_b32 v114, v105 offset:3808
    v_cvt_pk_f16_f32 v106, v70, v71
    ds_write_b32 v114, v106 offset:10336
    v_pk_mul_f32 v[102:103], v[92:93], v[90:91] op_sel:[0,0] op_sel_hi:[0,1]
    v_pk_fma_f32 v[92:93], v[92:93], v[90:91], v[102:103] op_sel:[1,1,0] op_sel_hi:[1,0,1] neg_lo:[1,0,0]
    v_cvt_pk_f16_f32 v107, v92, v93
    ds_write_b32 v114, v107 offset:4352
    v_cvt_pk_f16_f32 v104, v72, v73
    ds_write_b32 v114, v104 offset:10880
    v_pk_mul_f32 v[96:97], v[94:95], v[90:91] op_sel:[0,0] op_sel_hi:[0,1]
    v_pk_fma_f32 v[94:95], v[94:95], v[90:91], v[96:97] op_sel:[1,1,0] op_sel_hi:[1,0,1] neg_lo:[1,0,0]
    v_cvt_pk_f16_f32 v105, v94, v95
    ds_write_b32 v114, v105 offset:4896
    v_cvt_pk_f16_f32 v106, v74, v75
    ds_write_b32 v114, v106 offset:11424
    v_pk_mul_f32 v[98:99], v[92:93], v[90:91] op_sel:[0,0] op_sel_hi:[0,1]
    v_pk_fma_f32 v[92:93], v[92:93], v[90:91], v[98:99] op_sel:[1,1,0] op_sel_hi:[1,0,1] neg_lo:[1,0,0]
    v_cvt_pk_f16_f32 v107, v92, v93
    ds_write_b32 v114, v107 offset:5440
    v_cvt_pk_f16_f32 v104, v76, v77
    ds_write_b32 v114, v104 offset:11968
    v_pk_mul_f32 v[100:101], v[94:95], v[90:91] op_sel:[0,0] op_sel_hi:[0,1]
    v_pk_fma_f32 v[94:95], v[94:95], v[90:91], v[100:101] op_sel:[1,1,0] op_sel_hi:[1,0,1] neg_lo:[1,0,0]
    v_cvt_pk_f16_f32 v105, v94, v95
    ds_write_b32 v114, v105 offset:5984
    v_cvt_pk_f16_f32 v106, v78, v79
    ds_write_b32 v114, v106 offset:12512
    v_pk_mul_f32 v[102:103], v[92:93], v[90:91] op_sel:[0,0] op_sel_hi:[0,1]
    v_pk_fma_f32 v[92:93], v[92:93], v[90:91], v[102:103] op_sel:[1,1,0] op_sel_hi:[1,0,1] neg_lo:[1,0,0]
    v_cvt_pk_f16_f32 v107, v92, v93
    ds_write_b32 v114, v107 offset:6528
    v_pk_mul_f32 v[96:97], v[64:65], v[86:87] op_sel:[0,0] op_sel_hi:[0,1]
    v_pk_fma_f32 v[64:65], v[64:65], v[86:87], v[96:97] op_sel:[1,1,0] op_sel_hi:[1,0,1] neg_lo:[1,0,0]
    v_pk_mul_f32 v[98:99], v[66:67], v[86:87] op_sel:[0,0] op_sel_hi:[0,1]
    v_pk_fma_f32 v[66:67], v[66:67], v[86:87], v[98:99] op_sel:[1,1,0] op_sel_hi:[1,0,1] neg_lo:[1,0,0]
    v_pk_mul_f32 v[100:101], v[68:69], v[86:87] op_sel:[0,0] op_sel_hi:[0,1]
    v_pk_fma_f32 v[68:69], v[68:69], v[86:87], v[100:101] op_sel:[1,1,0] op_sel_hi:[1,0,1] neg_lo:[1,0,0]
    v_pk_mul_f32 v[102:103], v[70:71], v[86:87] op_sel:[0,0] op_sel_hi:[0,1]
    v_pk_fma_f32 v[70:71], v[70:71], v[86:87], v[102:103] op_sel:[1,1,0] op_sel_hi:[1,0,1] neg_lo:[1,0,0]
    v_pk_mul_f32 v[96:97], v[72:73], v[86:87] op_sel:[0,0] op_sel_hi:[0,1]
    v_pk_fma_f32 v[72:73], v[72:73], v[86:87], v[96:97] op_sel:[1,1,0] op_sel_hi:[1,0,1] neg_lo:[1,0,0]
    v_pk_mul_f32 v[98:99], v[74:75], v[86:87] op_sel:[0,0] op_sel_hi:[0,1]
    v_pk_fma_f32 v[74:75], v[74:75], v[86:87], v[98:99] op_sel:[1,1,0] op_sel_hi:[1,0,1] neg_lo:[1,0,0]
    v_pk_mul_f32 v[100:101], v[76:77], v[86:87] op_sel:[0,0] op_sel_hi:[0,1]
    v_pk_fma_f32 v[76:77], v[76:77], v[86:87], v[100:101] op_sel:[1,1,0] op_sel_hi:[1,0,1] neg_lo:[1,0,0]
    v_pk_mul_f32 v[102:103], v[78:79], v[86:87] op_sel:[0,0] op_sel_hi:[0,1]
    v_pk_fma_f32 v[78:79], v[78:79], v[86:87], v[102:103] op_sel:[1,1,0] op_sel_hi:[1,0,1] neg_lo:[1,0,0]
    v_pk_mul_f32 v[96:97], v[80:81], v[86:87] op_sel:[0,0] op_sel_hi:[0,1]
    v_pk_fma_f32 v[80:81], v[80:81], v[86:87], v[96:97] op_sel:[1,1,0] op_sel_hi:[1,0,1] neg_lo:[1,0,0]
    v_cvt_pk_f16_f32 v104, v64, v65
    ds_write_b32 v114, v104 offset:13056
    v_pk_mul_f32 v[98:99], v[94:95], v[90:91] op_sel:[0,0] op_sel_hi:[0,1]
    v_pk_fma_f32 v[94:95], v[94:95], v[90:91], v[98:99] op_sel:[1,1,0] op_sel_hi:[1,0,1] neg_lo:[1,0,0]
    v_cvt_pk_f16_f32 v105, v94, v95
    ds_write_b32 v114, v105 offset:7072
    v_cvt_pk_f16_f32 v106, v66, v67
    ds_write_b32 v114, v106 offset:13600
    v_pk_mul_f32 v[100:101], v[92:93], v[90:91] op_sel:[0,0] op_sel_hi:[0,1]
    v_pk_fma_f32 v[92:93], v[92:93], v[90:91], v[100:101] op_sel:[1,1,0] op_sel_hi:[1,0,1] neg_lo:[1,0,0]
    v_cvt_pk_f16_f32 v107, v92, v93
    ds_write_b32 v114, v107 offset:7616
    v_cvt_pk_f16_f32 v104, v68, v69
    ds_write_b32 v114, v104 offset:14144
    v_pk_mul_f32 v[102:103], v[94:95], v[90:91] op_sel:[0,0] op_sel_hi:[0,1]
    v_pk_fma_f32 v[94:95], v[94:95], v[90:91], v[102:103] op_sel:[1,1,0] op_sel_hi:[1,0,1] neg_lo:[1,0,0]
    v_cvt_pk_f16_f32 v105, v94, v95
    ds_write_b32 v114, v105 offset:8160
    v_cvt_pk_f16_f32 v106, v70, v71
    ds_write_b32 v114, v106 offset:14688
    v_cvt_pk_f16_f32 v107, v72, v73
    ds_write_b32 v114, v107 offset:15232
    v_cvt_pk_f16_f32 v104, v74, v75
    ds_write_b32 v114, v104 offset:15776
    v_cvt_pk_f16_f32 v105, v76, v77
    ds_write_b32 v114, v105 offset:16320
    v_cvt_pk_f16_f32 v106, v78, v79
    ds_write_b32 v114, v106 offset:16864
    v_pk_mul_f32 v[96:97], v[64:65], v[86:87] op_sel:[0,0] op_sel_hi:[0,1]
    v_pk_fma_f32 v[64:65], v[64:65], v[86:87], v[96:97] op_sel:[1,1,0] op_sel_hi:[1,0,1] neg_lo:[1,0,0]
    v_pk_mul_f32 v[98:99], v[68:69], v[86:87] op_sel:[0,0] op_sel_hi:[0,1]
    v_pk_fma_f32 v[68:69], v[68:69], v[86:87], v[98:99] op_sel:[1,1,0] op_sel_hi:[1,0,1] neg_lo:[1,0,0]
    v_pk_mul_f32 v[100:101], v[72:73], v[86:87] op_sel:[0,0] op_sel_hi:[0,1]
    v_pk_fma_f32 v[72:73], v[72:73], v[86:87], v[100:101] op_sel:[1,1,0] op_sel_hi:[1,0,1] neg_lo:[1,0,0]
    v_pk_mul_f32 v[102:103], v[76:77], v[86:87] op_sel:[0,0] op_sel_hi:[0,1]
    v_pk_fma_f32 v[76:77], v[76:77], v[86:87], v[102:103] op_sel:[1,1,0] op_sel_hi:[1,0,1] neg_lo:[1,0,0]
    v_pk_mul_f32 v[96:97], v[80:81], v[86:87] op_sel:[0,0] op_sel_hi:[0,1]
    v_pk_fma_f32 v[80:81], v[80:81], v[86:87], v[96:97] op_sel:[1,1,0] op_sel_hi:[1,0,1] neg_lo:[1,0,0]
    v_cvt_pk_f16_f32 v107, v64, v65
    ds_write_b32 v114, v107 offset:17408
    v_cvt_pk_f16_f32 v104, v68, v69
    ds_write_b32 v114, v104 offset:17952
    v_cvt_pk_f16_f32 v105, v72, v73
    ds_write_b32 v114, v105 offset:18496
    v_cvt_pk_f16_f32 v106, v76, v77
    ds_write_b32 v114, v106 offset:19040
    v_cvt_pk_f16_f32 v107, v80, v81
    ds_write_b32 v114, v107 offset:19584
    v_pk_mul_f32 v[98:99], v[64:65], v[86:87] op_sel:[0,0] op_sel_hi:[0,1]
    v_pk_fma_f32 v[64:65], v[64:65], v[86:87], v[98:99] op_sel:[1,1,0] op_sel_hi:[1,0,1] neg_lo:[1,0,0]
    v_pk_mul_f32 v[100:101], v[68:69], v[86:87] op_sel:[0,0] op_sel_hi:[0,1]
    v_pk_fma_f32 v[68:69], v[68:69], v[86:87], v[100:101] op_sel:[1,1,0] op_sel_hi:[1,0,1] neg_lo:[1,0,0]
    v_pk_mul_f32 v[102:103], v[72:73], v[86:87] op_sel:[0,0] op_sel_hi:[0,1]
    v_pk_fma_f32 v[72:73], v[72:73], v[86:87], v[102:103] op_sel:[1,1,0] op_sel_hi:[1,0,1] neg_lo:[1,0,0]
    v_pk_mul_f32 v[96:97], v[76:77], v[86:87] op_sel:[0,0] op_sel_hi:[0,1]
    v_pk_fma_f32 v[76:77], v[76:77], v[86:87], v[96:97] op_sel:[1,1,0] op_sel_hi:[1,0,1] neg_lo:[1,0,0]
    v_pk_mul_f32 v[98:99], v[80:81], v[86:87] op_sel:[0,0] op_sel_hi:[0,1]
    v_pk_fma_f32 v[80:81], v[80:81], v[86:87], v[98:99] op_sel:[1,1,0] op_sel_hi:[1,0,1] neg_lo:[1,0,0]
    v_cvt_pk_f16_f32 v104, v64, v65
    ds_write_b32 v114, v104 offset:20128
    v_cvt_pk_f16_f32 v105, v68, v69
    ds_write_b32 v114, v105 offset:20672
    v_cvt_pk_f16_f32 v106, v72, v73
    ds_write_b32 v114, v106 offset:21216
    v_cvt_pk_f16_f32 v107, v76, v77
    ds_write_b32 v114, v107 offset:21760
    v_cvt_pk_f16_f32 v104, v80, v81
    ds_write_b32 v114, v104 offset:22304
    v_pk_mul_f32 v[100:101], v[64:65], v[86:87] op_sel:[0,0] op_sel_hi:[0,1]
    v_pk_fma_f32 v[64:65], v[64:65], v[86:87], v[100:101] op_sel:[1,1,0] op_sel_hi:[1,0,1] neg_lo:[1,0,0]
    v_pk_mul_f32 v[102:103], v[72:73], v[86:87] op_sel:[0,0] op_sel_hi:[0,1]
    v_pk_fma_f32 v[72:73], v[72:73], v[86:87], v[102:103] op_sel:[1,1,0] op_sel_hi:[1,0,1] neg_lo:[1,0,0]
    v_cvt_pk_f16_f32 v105, v64, v65
    ds_write_b32 v114, v105 offset:22848
    v_cvt_pk_f16_f32 v106, v72, v73
    ds_write_b32 v114, v106 offset:23392
    v_pk_mul_f32 v[96:97], v[64:65], v[86:87] op_sel:[0,0] op_sel_hi:[0,1]
    v_pk_fma_f32 v[64:65], v[64:65], v[86:87], v[96:97] op_sel:[1,1,0] op_sel_hi:[1,0,1] neg_lo:[1,0,0]
    v_pk_mul_f32 v[98:99], v[72:73], v[86:87] op_sel:[0,0] op_sel_hi:[0,1]
    v_pk_fma_f32 v[72:73], v[72:73], v[86:87], v[98:99] op_sel:[1,1,0] op_sel_hi:[1,0,1] neg_lo:[1,0,0]
    v_cvt_pk_f16_f32 v107, v64, v65
    ds_write_b32 v114, v107 offset:23936
    v_cvt_pk_f16_f32 v104, v72, v73
    ds_write_b32 v114, v104 offset:24480
    v_pk_mul_f32 v[100:101], v[64:65], v[86:87] op_sel:[0,0] op_sel_hi:[0,1]
    v_pk_fma_f32 v[64:65], v[64:65], v[86:87], v[100:101] op_sel:[1,1,0] op_sel_hi:[1,0,1] neg_lo:[1,0,0]
    v_pk_mul_f32 v[102:103], v[72:73], v[86:87] op_sel:[0,0] op_sel_hi:[0,1]
    v_pk_fma_f32 v[72:73], v[72:73], v[86:87], v[102:103] op_sel:[1,1,0] op_sel_hi:[1,0,1] neg_lo:[1,0,0]
    v_cvt_pk_f16_f32 v105, v64, v65
    ds_write_b32 v114, v105 offset:25024
    v_cvt_pk_f16_f32 v106, v72, v73
    ds_write_b32 v114, v106 offset:25568
    v_pk_mul_f32 v[96:97], v[64:65], v[86:87] op_sel:[0,0] op_sel_hi:[0,1]
    v_pk_fma_f32 v[64:65], v[64:65], v[86:87], v[96:97] op_sel:[1,1,0] op_sel_hi:[1,0,1] neg_lo:[1,0,0]
    v_pk_mul_f32 v[98:99], v[72:73], v[86:87] op_sel:[0,0] op_sel_hi:[0,1]
    v_pk_fma_f32 v[72:73], v[72:73], v[86:87], v[98:99] op_sel:[1,1,0] op_sel_hi:[1,0,1] neg_lo:[1,0,0]
    v_cvt_pk_f16_f32 v107, v64, v65
    ds_write_b32 v114, v107 offset:26112
    v_cvt_pk_f16_f32 v104, v72, v73
    ds_write_b32 v114, v104 offset:26656
    v_pk_mul_f32 v[100:101], v[64:65], v[86:87] op_sel:[0,0] op_sel_hi:[0,1]
    v_pk_fma_f32 v[64:65], v[64:65], v[86:87], v[100:101] op_sel:[1,1,0] op_sel_hi:[1,0,1] neg_lo:[1,0,0]
    v_cvt_pk_f16_f32 v105, v64, v65
    ds_write_b32 v114, v105 offset:27200
    v_pk_mul_f32 v[102:103], v[64:65], v[86:87] op_sel:[0,0] op_sel_hi:[0,1]
    v_pk_fma_f32 v[64:65], v[64:65], v[86:87], v[102:103] op_sel:[1,1,0] op_sel_hi:[1,0,1] neg_lo:[1,0,0]
    v_cvt_pk_f16_f32 v106, v64, v65
    ds_write_b32 v114, v106 offset:27744
    v_pk_mul_f32 v[96:97], v[64:65], v[86:87] op_sel:[0,0] op_sel_hi:[0,1]
    v_pk_fma_f32 v[64:65], v[64:65], v[86:87], v[96:97] op_sel:[1,1,0] op_sel_hi:[1,0,1] neg_lo:[1,0,0]
    v_cvt_pk_f16_f32 v107, v64, v65
    ds_write_b32 v114, v107 offset:28288
    v_pk_mul_f32 v[98:99], v[64:65], v[86:87] op_sel:[0,0] op_sel_hi:[0,1]
    v_pk_fma_f32 v[64:65], v[64:65], v[86:87], v[98:99] op_sel:[1,1,0] op_sel_hi:[1,0,1] neg_lo:[1,0,0]
    v_cvt_pk_f16_f32 v104, v64, v65
    ds_write_b32 v114, v104 offset:28832
    v_pk_mul_f32 v[100:101], v[64:65], v[86:87] op_sel:[0,0] op_sel_hi:[0,1]
    v_pk_fma_f32 v[64:65], v[64:65], v[86:87], v[100:101] op_sel:[1,1,0] op_sel_hi:[1,0,1] neg_lo:[1,0,0]
    v_cvt_pk_f16_f32 v105, v64, v65
    ds_write_b32 v114, v105 offset:29376
    v_pk_mul_f32 v[102:103], v[64:65], v[86:87] op_sel:[0,0] op_sel_hi:[0,1]
    v_pk_fma_f32 v[64:65], v[64:65], v[86:87], v[102:103] op_sel:[1,1,0] op_sel_hi:[1,0,1] neg_lo:[1,0,0]
    v_cvt_pk_f16_f32 v106, v64, v65
    ds_write_b32 v114, v106 offset:29920
    v_pk_mul_f32 v[96:97], v[64:65], v[86:87] op_sel:[0,0] op_sel_hi:[0,1]
    v_pk_fma_f32 v[64:65], v[64:65], v[86:87], v[96:97] op_sel:[1,1,0] op_sel_hi:[1,0,1] neg_lo:[1,0,0]
    v_cvt_pk_f16_f32 v107, v64, v65
    ds_write_b32 v114, v107 offset:30464
    v_pk_mul_f32 v[98:99], v[64:65], v[86:87] op_sel:[0,0] op_sel_hi:[0,1]
    v_pk_fma_f32 v[64:65], v[64:65], v[86:87], v[98:99] op_sel:[1,1,0] op_sel_hi:[1,0,1] neg_lo:[1,0,0]
    v_cvt_pk_f16_f32 v104, v64, v65
    ds_write_b32 v114, v104 offset:31008
    v_pk_mul_f32 v[100:101], v[64:65], v[86:87] op_sel:[0,0] op_sel_hi:[0,1]
    v_pk_fma_f32 v[64:65], v[64:65], v[86:87], v[100:101] op_sel:[1,1,0] op_sel_hi:[1,0,1] neg_lo:[1,0,0]
    v_cvt_pk_f16_f32 v105, v64, v65
    ds_write_b32 v114, v105 offset:31552
L_tab_skip_14:
    s_lshl_b32 s6, s3, 6
    s_lshl_b32 s7, s5, 3
    s_add_u32 s6, s6, s7
    s_mul_i32 s6, s6, 1152
    s_mul_i32 s7, s4, 9
    v_lshrrev_b32 v2, 3, v1
    v_mul_u32_u24 v2, 1152, v2
    v_add_u32 v2, s6, v2
    v_and_b32 v3, 7, v1
    v_add_u32 v3, s7, v3
    s_bitcmp1_b32 s2, 7
    s_cbranch_scc1 L_xrev_15
    v_add_u32 v5, 0xffffffb8, v3
    v_min_u32 v44, v3, v5
    v_lshl_add_u32 v5, v44, 4, v2
    buffer_load_dwordx4 v[8:11], v5, s[48:51], 0 offen
    v_add_u32 v4, 8, v3
    v_add_u32 v5, 0xffffffb8, v4
    v_min_u32 v45, v4, v5
    v_lshl_add_u32 v5, v45, 4, v2
    buffer_load_dwordx4 v[12:15], v5, s[48:51], 0 offen
    v_add_u32 v4, 16, v3
    v_add_u32 v5, 0xffffffb8, v4
    v_min_u32 v46, v4, v5
    v_lshl_add_u32 v5, v46, 4, v2
    buffer_load_dwordx4 v[16:19], v5, s[48:51], 0 offen
    v_add_u32 v4, 24, v3
    v_add_u32 v5, 0xffffffb8, v4
    v_min_u32 v47, v4, v5
    v_lshl_add_u32 v5, v47, 4, v2
    buffer_load_dwordx4 v[20:23], v5, s[48:51], 0 offen
    v_add_u32 v4, 32, v3
    v_add_u32 v5, 0xffffffb8, v4
    v_min_u32 v48, v4, v5
    v_lshl_add_u32 v5, v48, 4, v2
    buffer_load_dwordx4 v[24:27], v5, s[48:51], 0 offen
    v_add_u32 v4, 40, v3
    v_add_u32 v5, 0xffffffb8, v4
    v_min_u32 v49, v4, v5
    v_lshl_add_u32 v5, v49, 4, v2
    buffer_load_dwordx4 v[28:31], v5, s[48:51], 0 offen
    v_add_u32 v4, 48, v3
    v_add_u32 v5, 0xffffffb8, v4
    v_min_u32 v50, v4, v5
    v_lshl_add_u32 v5, v50, 4, v2
    buffer_load_dwordx4 v[32:35], v5, s[48:51], 0 offen
    v_add_u32 v4, 56, v3
    v_add_u32 v5, 0xffffffb8, v4
    v_min_u32 v51, v4, v5
    v_lshl_add_u32 v5, v51, 4, v2
    buffer_load_dwordx4 v[36:39], v5, s[48:51], 0 offen
    v_add_u32 v4, 64, v3
    v_add_u32 v5, 0xffffffb8, v4
    v_min_u32 v52, v4, v5
    v_lshl_add_u32 v5, v52, 4, v2
    buffer_load_dwordx4 v[40:43], v5, s[48:51], 0 offen
    s_branch L_xdone_16
L_xrev_15:
    v_add_u32 v4, 64, v3
    v_add_u32 v5, 0xffffffb8, v4
    v_min_u32 v52, v4, v5
    v_lshl_add_u32 v5, v52, 4, v2
    buffer_load_dwordx4 v[40:43], v5, s[48:51], 0 offen
    v_add_u32 v4, 56, v3
    v_add_u32 v5, 0xffffffb8, v4
    v_min_u32 v51, v4, v5
    v_lshl_add_u32 v5, v51, 4, v2
    buffer_load_dwordx4 v[36:39], v5, s[48:51], 0 offen
    v_add_u32 v4, 48, v3
    v_add_u32 v5, 0xffffffb8, v4
    v_min_u32 v50, v4, v5
    v_lshl_add_u32 v5, v50, 4, v2
    buffer_load_dwordx4 v[32:35], v5, s[48:51], 0 offen
    v_add_u32 v4, 40, v3
    v_add_u32 v5, 0xffffffb8, v4
    v_min_u32 v49, v4, v5
    v_lshl_add_u32 v5, v49, 4, v2
    buffer_load_dwordx4 v[28:31], v5, s[48:51], 0 offen
    v_add_u32 v4, 32, v3
    v_add_u32 v5, 0xffffffb8, v4
    v_min_u32 v48, v4, v5
    v_lshl_add_u32 v5, v48, 4, v2
    buffer_load_dwordx4 v[24:27], v5, s[48:51], 0 offen
    v_add_u32 v4, 24, v3
    v_add_u32 v5, 0xffffffb8, v4
    v_min_u32 v47, v4, v5
    v_lshl_add_u32 v5, v47, 4, v2
    buffer_load_dwordx4 v[20:23], v5, s[48:51], 0 offen
    v_add_u32 v4, 16, v3
    v_add_u32 v5, 0xffffffb8, v4
    v_min_u32 v46, v4, v5
    v_lshl_add_u32 v5, v46, 4, v2
    buffer_load_dwordx4 v[16:19], v5, s[48:51], 0 offen
    v_add_u32 v4, 8, v3
    v_add_u32 v5, 0xffffffb8, v4
    v_min_u32 v45, v4, v5
    v_lshl_add_u32 v5, v45, 4, v2
    buffer_load_dwordx4 v[12:15], v5, s[48:51], 0 offen
    v_add_u32 v5, 0xffffffb8, v3
    v_min_u32 v44, v3, v5
    v_lshl_add_u32 v5, v44, 4, v2
    buffer_load_dwordx4 v[8:11], v5, s[48:51], 0 offen
L_xdone_16:
    s_mul_i32 s6, s4, 1152
    v_min_u32 v2, 287, v0
    v_lshlrev_b32 v2, 2, v2
    v_add_u32 v3, s6, v2
    global_load_dword v62, v3, s[34:35]
    s_cmp_ge_u32 s5, 6
    s_cbranch_scc1 L_w1pf_17
    s_lshr_b32 s6, s2, 3
    s_and_b32 s6, s6, 15
    s_mul_i32 s7, s5, 864
    s_add_u32 s6, s6, s7
    v_add_u32 v2, 0, v1
    v_min_u32 v2, 53, v2
    v_lshl_add_u32 v2, v2, 4, s6
    v_mul_u32_u24 v3, 3641, v2
    v_lshrrev_b32 v3, 15, v3
    v_mul_u32_u24 v4, 9, v3
    v_sub_u32 v4, v2, v4
    v_mul_u32_u24 v3, 9216, v3
    v_lshl_add_u32 v3, v4, 7, v3
    s_mul_i32 s8, s4, 1152
    buffer_load_dword v255, v3, s[56:59], s8 offen
L_w1pf_17:
    s_sub_u32 s9, 7, s5
    s_lshl_b32 s9, s9, 8
    s_add_u32 s9, s9, s2
    s_cmp_lt_u32 s9, 1296
    s_cselect_b32 s47, 1, 0
    s_cbranch_scc0 L_no_u1_18
    s_mul_i32 s77, s9, 1619
    s_lshr_b32 s77, s77, 18
    s_mul_i32 s6, s77, 162
    s_sub_u32 s7, s9, s6
    s_mul_i32 s78, s7, 57
    s_lshr_b32 s78, s78, 9
    s_mul_i32 s6, s78, 9
    s_sub_u32 s79, s7, s6
    v_lshrrev_b32 v2, 3, v1
    v_and_b32 v3, 7, v1
    v_lshlrev_b32 v3, 4, v3
    s_mul_i32 s6, s77, 576
    s_lshl_b32 s7, s78, 5
    s_add_u32 s6, s6, s7
    s_mul_i32 s6, s6, 1152
    s_mov_b32 s7, 0
    s_add_u32 s6, s6, s7
    s_lshl_b32 s7, s79, 7
    s_add_u32 s6, s6, s7
    v_mul_u32_u24 v2, 1152, v2
    v_add_u32 v2, v2, v3
    s_add_u32 m0, s46, 0
    s_nop 0
    buffer_load_dwordx4 v2, s[60:63], s6 offen nt lds
    s_add_u32 s6, s6, 9216
    s_add_u32 m0, s46, 1024
    s_nop 0
    buffer_load_dwordx4 v2, s[60:63], s6 offen nt lds
    s_add_u32 s6, s6, 9216
    s_add_u32 m0, s46, 2048
    s_nop 0
    buffer_load_dwordx4 v2, s[60:63], s6 offen nt lds
    s_add_u32 s6, s6, 9216
    s_add_u32 m0, s46, 3072
    s_nop 0
    buffer_load_dwordx4 v2, s[60:63], s6 offen nt lds
    s_mul_i32 s15, s77, 1296
    s_mul_i32 s12, s77, 9
    s_lshr_b32 s12, s12, 1
    s_add_u32 s13, s78, 18
    s_lshl_b32 s8, s79, 2
    s_add_u32 s8, s8, 36
    s_sub_u32 s8, s8, s12
    s_sub_u32 s9, s8, 36
    s_min_u32 s8, s8, s9
    s_and_b32 s9, s8, 7
    s_lshr_b32 s10, s8, 3
    s_sub_u32 s11, s8, 32
    s_cmp_ge_u32 s8, 32
    s_cselect_b32 s9, s11, s9
    s_cmp_lt_u32 s9, 4
    s_cselect_b32 s11, 5, 4
    s_mul_i32 s11, s11, s13
    s_add_u32 s11, s11, s10
    s_mul_i32 s14, s78, 3
    s_add_u32 s14, s14, s10
    s_add_u32 s14, s14, 71
    s_add_u32 s6, s78, 126
    s_cmp_eq_u32 s10, 0
    s_cselect_b32 s14, s6, s14
    s_cmp_ge_u32 s9, 4
    s_cselect_b32 s11, s14, s11
    s_mul_i32 s14, s9, 144
    s_min_u32 s9, s9, 4
    s_mul_i32 s9, s9, 36
    s_add_u32 s14, s14, s9
    s_add_u32 s14, s14, s11
    s_add_u32 s14, s14, s15
    s_lshl_b32 s18, s14, 10
    s_lshl_b32 s8, s79, 2
    s_add_u32 s8, s8, 37
    s_sub_u32 s8, s8, s12
    s_sub_u32 s9, s8, 36
    s_min_u32 s8, s8, s9
    s_and_b32 s9, s8, 7
    s_lshr_b32 s10, s8, 3
    s_sub_u32 s11, s8, 32
    s_cmp_ge_u32 s8, 32
    s_cselect_b32 s9, s11, s9
    s_cmp_lt_u32 s9, 4
    s_cselect_b32 s11, 5, 4
    s_mul_i32 s11, s11, s13
    s_add_u32 s11, s11, s10
    s_mul_i32 s14, s78, 3
    s_add_u32 s14, s14, s10
    s_add_u32 s14, s14, 71
    s_add_u32 s6, s78, 126
    s_cmp_eq_u32 s10, 0
    s_cselect_b32 s14, s6, s14
    s_cmp_ge_u32 s9, 4
    s_cselect_b32 s11, s14, s11
    s_mul_i32 s14, s9, 144
    s_min_u32 s9, s9, 4
    s_mul_i32 s9, s9, 36
    s_add_u32 s14, s14, s9
    s_add_u32 s14, s14, s11
    s_add_u32 s14, s14, s15
    s_lshl_b32 s19, s14, 10
    s_lshl_b32 s8, s79, 2
    s_add_u32 s8, s8, 38
    s_sub_u32 s8, s8, s12
    s_sub_u32 s9, s8, 36
    s_min_u32 s8, s8, s9
    s_and_b32 s9, s8, 7
    s_lshr_b32 s10, s8, 3
    s_sub_u32 s11, s8, 32
    s_cmp_ge_u32 s8, 32
    s_cselect_b32 s9, s11, s9
    s_cmp_lt_u32 s9, 4
    s_cselect_b32 s11, 5, 4
    s_mul_i32 s11, s11, s13
    s_add_u32 s11, s11, s10
    s_mul_i32 s14, s78, 3
    s_add_u32 s14, s14, s10
    s_add_u32 s14, s14, 71
    s_add_u32 s6, s78, 126
    s_cmp_eq_u32 s10, 0
    s_cselect_b32 s14, s6, s14
    s_cmp_ge_u32 s9, 4
    s_cselect_b32 s11, s14, s11
    s_mul_i32 s14, s9, 144
    s_min_u32 s9, s9, 4
    s_mul_i32 s9, s9, 36
    s_add_u32 s14, s14, s9
    s_add_u32 s14, s14, s11
    s_add_u32 s14, s14, s15
    s_lshl_b32 s20, s14, 10
    s_lshl_b32 s8, s79, 2
    s_add_u32 s8, s8, 39
    s_sub_u32 s8, s8, s12
    s_sub_u32 s9, s8, 36
    s_min_u32 s8, s8, s9
    s_and_b32 s9, s8, 7
    s_lshr_b32 s10, s8, 3
    s_sub_u32 s11, s8, 32
    s_cmp_ge_u32 s8, 32
    s_cselect_b32 s9, s11, s9
    s_cmp_lt_u32 s9, 4
    s_cselect_b32 s11, 5, 4
    s_mul_i32 s11, s11, s13
    s_add_u32 s11, s11, s10
    s_mul_i32 s14, s78, 3
    s_add_u32 s14, s14, s10
    s_add_u32 s14, s14, 71
    s_add_u32 s6, s78, 126
    s_cmp_eq_u32 s10, 0
    s_cselect_b32 s14, s6, s14
    s_cmp_ge_u32 s9, 4
    s_cselect_b32 s11, s14, s11
    s_mul_i32 s14, s9, 144
    s_min_u32 s9, s9, 4
    s_mul_i32 s9, s9, 36
    s_add_u32 s14, s14, s9
    s_add_u32 s14, s14, s11
    s_add_u32 s14, s14, s15
    s_lshl_b32 s21, s14, 10
L_no_u1_18:
L_w45j_4:
    s_waitcnt lgkmcnt(0)
    s_barrier
    s_cmp_eq_u32 s83, 0
    s_cbranch_scc1 L_task_end_19
    s_lshr_b32 s72, s5, 1
    s_mul_i32 s75, s72, 32096
    s_add_u32 s75, s75, 0
    s_mul_i32 s76, s72, 4608
    s_add_u32 s76, s76, 147712
    v_and_b32 v170, 15, v1
    v_lshrrev_b32 v171, 4, v1
    v_mul_u32_u24 v168, 544, v170
    v_lshl_add_u32 v168, v171, 4, v168
    v_add_u32 v168, s75, v168
    s_bitcmp1_b32 s5, 0
    s_cbranch_scc1 L_task_hi_20
    ds_read_b128 v[64:67], v168 offset:0
    ds_read_b128 v[96:99], v168 offset:8704
    ds_read_b128 v[128:131], v168 offset:17408
    ds_read_b128 v[68:71], v168 offset:64
    ds_read_b128 v[100:103], v168 offset:8768
    ds_read_b128 v[132:135], v168 offset:17472
    ds_read_b128 v[72:75], v168 offset:128
    ds_read_b128 v[104:107], v168 offset:8832
    ds_read_b128 v[136:139], v168 offset:17536
    ds_read_b128 v[76:79], v168 offset:192
    ds_read_b128 v[108:111], v168 offset:8896
    ds_read_b128 v[140:143], v168 offset:17600
    s_waitcnt lgkmcnt(9)
    v_mfma_f32_16x16x32_f16 v[160:163], v[96:99], v[64:67], 0
    v_mfma_f32_16x16x32_f16 v[164:167], v[64:67], v[128:131], 0
    ds_read_b128 v[80:83], v168 offset:256
    ds_read_b128 v[112:115], v168 offset:8960
    ds_read_b128 v[144:147], v168 offset:17664
    s_waitcnt lgkmcnt(9)
    v_mfma_f32_16x16x32_f16 v[160:163], v[100:103], v[68:71], v[160:163]
    v_mfma_f32_16x16x32_f16 v[164:167], v[68:71], v[132:135], v[164:167]
    ds_read_b128 v[84:87], v168 offset:320
    ds_read_b128 v[116:119], v168 offset:9024
    ds_read_b128 v[148:151], v168 offset:17728
    s_waitcnt lgkmcnt(9)
    v_mfma_f32_16x16x32_f16 v[160:163], v[104:107], v[72:75], v[160:163]
    v_mfma_f32_16x16x32_f16 v[164:167], v[72:75], v[136:139], v[164:167]
    ds_read_b128 v[88:91], v168 offset:384
    ds_read_b128 v[120:123], v168 offset:9088
    ds_read_b128 v[152:155], v168 offset:17792
    s_waitcnt lgkmcnt(9)
    v_mfma_f32_16x16x32_f16 v[160:163], v[108:111], v[76:79], v[160:163]
    v_mfma_f32_16x16x32_f16 v[164:167], v[76:79], v[140:143], v[164:167]
    ds_read_b128 v[92:95], v168 offset:448
    ds_read_b128 v[124:127], v168 offset:9152
    ds_read_b128 v[156:159], v168 offset:17856
    s_waitcnt lgkmcnt(9)
    v_mfma_f32_16x16x32_f16 v[160:163], v[112:115], v[80:83], v[160:163]
    v_mfma_f32_16x16x32_f16 v[164:167], v[80:83], v[144:147], v[164:167]
    s_waitcnt lgkmcnt(6)
    v_mfma_f32_16x16x32_f16 v[160:163], v[116:119], v[84:87], v[160:163]
    v_mfma_f32_16x16x32_f16 v[164:167], v[84:87], v[148:151], v[164:167]
    s_waitcnt lgkmcnt(3)
    v_mfma_f32_16x16x32_f16 v[160:163], v[120:123], v[88:91], v[160:163]
    v_mfma_f32_16x16x32_f16 v[164:167], v[88:91], v[152:155], v[164:167]
    s_waitcnt lgkmcnt(0)
    v_mfma_f32_16x16x32_f16 v[160:163], v[124:127], v[92:95], v[160:163]
    v_mfma_f32_16x16x32_f16 v[164:167], v[92:95], v[156:159], v[164:167]
    v_lshrrev_b32 v173, 1, v171
    v_lshlrev_b32 v173, 8, v173
    v_lshl_add_u32 v173, v170, 4, v173
    v_and_b32 v174, 1, v171
    v_lshl_add_u32 v173, v174, 3, v173
    s_add_u32 s6, s76, 4088
    v_sub_u32 v172, s6, v173
    v_cvt_pk_f16_f32 v180, v163, v162
    v_cvt_pk_f16_f32 v181, v161, v160
    ds_write_b64 v172, v[180:181]
    s_add_u32 s6, s76, 4096
    v_lshl_add_u32 v172, v1, 2, s6
    v_mov_b32 v173, 0
    v_cmp_gt_u32 vcc, 32, v1
    s_and_saveexec_b64 s[14:15], vcc
    ds_write_b32 v172, v173
    s_mov_b64 exec, s[14:15]
    v_cmp_le_u32 vcc, 5, v170
    s_nop 1
    v_cndmask_b32 v173, 0, 1, vcc
    v_mul_u32_u24 v174, 5, v173
    v_sub_u32 v174, v170, v174
    v_lshlrev_b32 v175, 8, v173
    v_lshl_add_u32 v175, v174, 2, v175
    v_lshl_add_u32 v175, v171, 6, v175
    s_add_u32 s6, s76, 3532
    v_sub_u32 v172, s6, v175
    v_and_b32 v175, 1, v174
    v_cmp_eq_u32 s[84:85], 1, v175
    v_cmp_gt_u32 vcc, 10, v170
    v_cmp_ne_u32 s[14:15], 4, v174
    s_and_b64 s[14:15], s[14:15], vcc
    v_mov_b32_dpp v180, v164 row_shl:1 row_mask:0xf bank_mask:0xf bound_ctrl:1
    v_mov_b32_dpp v181, v165 row_shl:1 row_mask:0xf bank_mask:0xf bound_ctrl:1
    v_mov_b32_dpp v182, v166 row_shl:1 row_mask:0xf bank_mask:0xf bound_ctrl:1
    v_mov_b32_dpp v183, v167 row_shl:1 row_mask:0xf bank_mask:0xf bound_ctrl:1
    v_cndmask_b32 v180, v164, v180, s[84:85]
    v_cvt_pk_f16_f32 v180, v180, v164
    v_cndmask_b32 v181, v165, v181, s[84:85]
    v_cvt_pk_f16_f32 v181, v181, v165
    v_cndmask_b32 v182, v166, v182, s[84:85]
    v_cvt_pk_f16_f32 v182, v182, v166
    v_cndmask_b32 v183, v167, v183, s[84:85]
    v_cvt_pk_f16_f32 v183, v183, v167
    s_and_saveexec_b64 s[14:15], s[14:15]
    ds_write_b32 v172, v180 offset:48
    ds_write_b32 v172, v181 offset:32
    ds_write_b32 v172, v182 offset:16
    ds_write_b32 v172, v183 offset:0
    s_mov_b64 exec, s[14:15]
    s_branch L_task_end_19
L_task_hi_20:
    ds_read_b128 v[64:67], v168 offset:0
    ds_read_b128 v[96:99], v168 offset:22848
    ds_read_b128 v[128:131], v168 offset:27200
    ds_read_b128 v[68:71], v168 offset:64
    ds_read_b128 v[100:103], v168 offset:22912
    ds_read_b128 v[132:135], v168 offset:27264
    ds_read_b128 v[72:75], v168 offset:128
    ds_read_b128 v[104:107], v168 offset:22976
    ds_read_b128 v[136:139], v168 offset:27328
    ds_read_b128 v[76:79], v168 offset:192
    ds_read_b128 v[108:111], v168 offset:23040
    ds_read_b128 v[140:143], v168 offset:27392
    s_waitcnt lgkmcnt(9)
    v_mfma_f32_16x16x32_f16 v[160:163], v[64:67], v[96:99], 0
    v_mfma_f32_16x16x32_f16 v[164:167], v[64:67], v[128:131], 0
    ds_read_b128 v[80:83], v168 offset:256
    ds_read_b128 v[112:115], v168 offset:23104
    ds_read_b128 v[144:147], v168 offset:27456
    s_waitcnt lgkmcnt(9)
    v_mfma_f32_16x16x32_f16 v[160:163], v[68:71], v[100:103], v[160:163]
    v_mfma_f32_16x16x32_f16 v[164:167], v[68:71], v[132:135], v[164:167]
    ds_read_b128 v[84:87], v168 offset:320
    ds_read_b128 v[116:119], v168 offset:23168
    ds_read_b128 v[148:151], v168 offset:27520
    s_waitcnt lgkmcnt(9)
    v_mfma_f32_16x16x32_f16 v[160:163], v[72:75], v[104:107], v[160:163]
    v_mfma_f32_16x16x32_f16 v[164:167], v[72:75], v[136:139], v[164:167]
    ds_read_b128 v[88:91], v168 offset:384
    ds_read_b128 v[120:123], v168 offset:23232
    ds_read_b128 v[152:155], v168 offset:27584
    s_waitcnt lgkmcnt(9)
    v_mfma_f32_16x16x32_f16 v[160:163], v[76:79], v[108:111], v[160:163]
    v_mfma_f32_16x16x32_f16 v[164:167], v[76:79], v[140:143], v[164:167]
    ds_read_b128 v[92:95], v168 offset:448
    ds_read_b128 v[124:127], v168 offset:23296
    ds_read_b128 v[156:159], v168 offset:27648
    s_waitcnt lgkmcnt(9)
    v_mfma_f32_16x16x32_f16 v[160:163], v[80:83], v[112:115], v[160:163]
    v_mfma_f32_16x16x32_f16 v[164:167], v[80:83], v[144:147], v[164:167]
    s_waitcnt lgkmcnt(6)
    v_mfma_f32_16x16x32_f16 v[160:163], v[84:87], v[116:119], v[160:163]
    v_mfma_f32_16x16x32_f16 v[164:167], v[84:87], v[148:151], v[164:167]
    s_waitcnt lgkmcnt(3)
    v_mfma_f32_16x16x32_f16 v[160:163], v[88:91], v[120:123], v[160:163]
    v_mfma_f32_16x16x32_f16 v[164:167], v[88:91], v[152:155], v[164:167]
    s_waitcnt lgkmcnt(0)
    v_mfma_f32_16x16x32_f16 v[160:163], v[92:95], v[124:127], v[160:163]
    v_mfma_f32_16x16x32_f16 v[164:167], v[92:95], v[156:159], v[164:167]
    v_lshrrev_b32 v173, 1, v170
    v_and_b32 v174, 1, v170
    v_lshlrev_b32 v175, 8, v173
    v_lshl_add_u32 v175, v174, 3, v175
    v_lshl_add_u32 v175, v171, 6, v175
    s_add_u32 s6, s76, 3020
    v_sub_u32 v172, s6, v175
    v_cmp_eq_u32 s[84:85], 1, v174
    v_mov_b32_dpp v180, v160 row_shr:1 row_mask:0xf bank_mask:0xf bound_ctrl:1
    v_mov_b32_dpp v181, v161 row_shr:1 row_mask:0xf bank_mask:0xf bound_ctrl:1
    v_mov_b32_dpp v182, v162 row_shr:1 row_mask:0xf bank_mask:0xf bound_ctrl:1
    v_mov_b32_dpp v183, v163 row_shr:1 row_mask:0xf bank_mask:0xf bound_ctrl:1
    v_cndmask_b32 v180, v160, v180, s[84:85]
    v_cvt_pk_f16_f32 v180, v160, v180
    v_cvt_pk_f16_f32 v184, v160, v160
    v_cndmask_b32 v181, v161, v181, s[84:85]
    v_cvt_pk_f16_f32 v181, v161, v181
    v_cvt_pk_f16_f32 v185, v161, v161
    v_cndmask_b32 v182, v162, v182, s[84:85]
    v_cvt_pk_f16_f32 v182, v162, v182
    v_cvt_pk_f16_f32 v186, v162, v162
    v_cndmask_b32 v183, v163, v183, s[84:85]
    v_cvt_pk_f16_f32 v183, v163, v183
    v_cvt_pk_f16_f32 v187, v163, v163
    v_add_u32 v173, 52, v172
    s_sub_u32 s6, s76, 256
    v_mov_b32 v174, s6
    v_cmp_eq_u32 vcc, 0, v1
    s_nop 1
    v_cndmask_b32 v173, v173, v174, vcc
    v_cmp_gt_u32 vcc, 8, v170
    s_and_saveexec_b64 s[14:15], vcc
    ds_write_b32 v172, v184 offset:48
    ds_write_b32 v173, v180
    ds_write2_b32 v172, v185, v181 offset0:8 offset1:9
    ds_write2_b32 v172, v186, v182 offset0:4 offset1:5
    ds_write2_b32 v172, v187, v183 offset0:0 offset1:1
    s_mov_b64 exec, s[14:15]
    v_lshlrev_b32 v175, 8, v170
    v_lshl_add_u32 v175, v171, 6, v175
    s_add_u32 s6, s76, 1992
    v_sub_u32 v172, s6, v175
    v_cvt_pk_f16_f32 v188, v164, v164
    v_cvt_pk_f16_f32 v189, v165, v165
    v_cvt_pk_f16_f32 v190, v166, v166
    v_cvt_pk_f16_f32 v191, v167, v167
    v_cvt_pk_f16_f32 v192, v165, v164
    v_cvt_pk_f16_f32 v193, v167, v166
    v_add_u32 v173, 60, v172
    s_sub_u32 s6, s76, 256
    v_mov_b32 v174, s6
    v_cmp_eq_u32 vcc, 0, v1
    s_nop 1
    v_cndmask_b32 v173, v173, v174, vcc
    v_cmp_gt_u32 vcc, 9, v170
    s_and_saveexec_b64 s[14:15], vcc
    ds_write2_b32 v172, v191, v191 offset0:0 offset1:1
    ds_write2_b32 v172, v191, v193 offset0:2 offset1:3
    ds_write2_b32 v172, v190, v190 offset0:4 offset1:5
    ds_write2_b32 v172, v190, v190 offset0:6 offset1:7
    ds_write2_b32 v172, v189, v189 offset0:8 offset1:9
    ds_write2_b32 v172, v189, v192 offset0:10 offset1:11
    ds_write2_b32 v172, v188, v188 offset0:12 offset1:13
    ds_write_b32 v172, v188 offset:56
    ds_write_b32 v173, v188
    s_mov_b64 exec, s[14:15]
L_task_end_19:
    s_cmp_ge_u32 s5, 4
    s_cbranch_scc1 L_gs5_21
    s_mul_i32 s80, s5, 10240
    s_add_u32 s80, s80, 73728
    v_lshrrev_b32 v2, 3, v1
    v_and_b32 v3, 7, v1
    v_bfe_u32 v4, v1, 4, 1
    v_lshlrev_b32 v4, 1, v4
    v_xor_b32 v3, v3, v4
    v_xor_b32 v4, 4, v3
    v_mul_u32_u24 v2, 9216, v2
    v_lshl_add_u32 v222, v3, 4, v2
    v_lshl_add_u32 v223, v4, 4, v2
    s_mul_i32 s6, s4, 1152
    s_lshl_b32 s7, s5, 7
    s_add_u32 s81, s6, s7
    v_lshrrev_b32 v5, 4, v1
    v_bfe_u32 v6, v1, 2, 2
    v_and_b32 v7, 3, v1
    v_lshlrev_b32 v2, 10, v5
    v_lshl_add_u32 v2, v6, 7, v2
    v_lshl_add_u32 v2, v7, 3, v2
    v_add_u32 v2, s80, v2
    v_and_b32 v3, 1, v5
    v_lshlrev_b32 v3, 1, v3
    v_lshrrev_b32 v4, 1, v6
    v_or_b32 v3, v3, v4
    v_xor_b32 v4, 0, v3
    v_lshl_add_u32 v216, v4, 5, v2
    v_xor_b32 v4, 1, v3
    v_lshl_add_u32 v217, v4, 5, v2
    v_xor_b32 v4, 2, v3
    v_lshl_add_u32 v218, v4, 5, v2
    v_xor_b32 v4, 3, v3
    v_lshl_add_u32 v219, v4, 5, v2
    v_lshrrev_b32 v2, 1, v1
    v_bfe_u32 v3, v2, 3, 1
    v_lshlrev_b32 v3, 2, v3
    v_xor_b32 v2, v2, v3
    v_mul_u32_u24 v2, 9216, v2
    v_and_b32 v3, 1, v1
    v_lshl_add_u32 v224, v3, 4, v2
    s_lshl_b32 s7, s5, 5
    s_add_u32 s7, s7, s6
    s_add_u32 s82, s7, 1024
    v_lshlrev_b32 v2, 3, v5
    v_add_u32 v2, v2, v6
    v_and_b32 v3, 1, v5
    v_lshlrev_b32 v3, 2, v3
    v_xor_b32 v2, v2, v3
    v_xor_b32 v3, 4, v2
    v_lshlrev_b32 v4, 5, v2
    v_lshl_add_u32 v4, v7, 3, v4
    s_add_u32 s7, s80, 4096
    v_add_u32 v220, s7, v4
    v_lshlrev_b32 v4, 5, v3
    v_lshl_add_u32 v4, v7, 3, v4
    s_add_u32 s7, s80, 4096
    v_add_u32 v221, s7, v4
    s_branch L_gsj_22
L_gs5_21:
    s_sub_u32 s6, s5, 4
    s_mul_i32 s80, s6, 8192
    s_add_u32 s80, s80, 114688
    v_lshrrev_b32 v2, 3, v1
    v_and_b32 v3, 7, v1
    v_bfe_u32 v4, v1, 4, 1
    v_lshlrev_b32 v4, 1, v4
    v_xor_b32 v3, v3, v4
    v_xor_b32 v4, 4, v3
    v_mul_u32_u24 v2, 9216, v2
    v_lshl_add_u32 v222, v3, 4, v2
    v_lshl_add_u32 v223, v4, 4, v2
    s_mul_i32 s6, s4, 1152
    s_lshl_b32 s7, s5, 7
    s_add_u32 s81, s6, s7
    v_lshrrev_b32 v5, 4, v1
    v_bfe_u32 v6, v1, 2, 2
    v_and_b32 v7, 3, v1
    v_lshlrev_b32 v2, 10, v5
    v_lshl_add_u32 v2, v6, 7, v2
    v_lshl_add_u32 v2, v7, 3, v2
    v_add_u32 v2, s80, v2
    v_and_b32 v3, 1, v5
    v_lshlrev_b32 v3, 1, v3
    v_lshrrev_b32 v4, 1, v6
    v_or_b32 v3, v3, v4
    v_xor_b32 v4, 0, v3
    v_lshl_add_u32 v216, v4, 5, v2
    v_xor_b32 v4, 1, v3
    v_lshl_add_u32 v217, v4, 5, v2
    v_xor_b32 v4, 2, v3
    v_lshl_add_u32 v218, v4, 5, v2
    v_xor_b32 v4, 3, v3
    v_lshl_add_u32 v219, v4, 5, v2
L_gsj_22:
    s_cmp_ge_u32 s5, 6
    s_cbranch_scc1 L_wc6_23
    s_cmp_eq_u32 s47, 0
    s_cbranch_scc1 L_wc0_24
    s_waitcnt vmcnt(6)
    s_branch L_wcd_26
L_wc0_24:
    s_waitcnt vmcnt(2)
    s_branch L_wcd_26
L_wc6_23:
    s_waitcnt vmcnt(5)
L_wcd_26:
    s_waitcnt lgkmcnt(0)
    s_barrier
    s_cmp_lg_u32 s5, 0
    s_cbranch_scc1 L_lcz_27
    v_mov_b32 v2, 163648
    v_mov_b32 v4, 0
    v_mov_b32 v5, 0
    v_mov_b32 v6, 0
    v_mov_b32 v7, 0
    ds_write_b128 v2, v[4:7]
    ds_write_b128 v2, v[4:7] offset:16
L_lcz_27:
    v_mov_b32 v75, 0x3f803f80
    v_dot2_f32_bf16 v68, v8, v75, 0
    v_dot2_f32_bf16 v70, v8, v8, 0
    v_dot2_f32_bf16 v69, v9, v75, 0
    v_dot2_f32_bf16 v71, v9, v9, 0
    v_dot2_f32_bf16 v68, v10, v75, v68
    v_dot2_f32_bf16 v70, v10, v10, v70
    v_dot2_f32_bf16 v69, v11, v75, v69
    v_dot2_f32_bf16 v71, v11, v11, v71
    v_dot2_f32_bf16 v68, v12, v75, v68
    v_dot2_f32_bf16 v70, v12, v12, v70
    v_dot2_f32_bf16 v69, v13, v75, v69
    v_dot2_f32_bf16 v71, v13, v13, v71
    v_dot2_f32_bf16 v68, v14, v75, v68
    v_dot2_f32_bf16 v70, v14, v14, v70
    v_dot2_f32_bf16 v69, v15, v75, v69
    v_dot2_f32_bf16 v71, v15, v15, v71
    v_dot2_f32_bf16 v68, v16, v75, v68
    v_dot2_f32_bf16 v70, v16, v16, v70
    v_dot2_f32_bf16 v69, v17, v75, v69
    v_dot2_f32_bf16 v71, v17, v17, v71
    v_dot2_f32_bf16 v68, v18, v75, v68
    v_dot2_f32_bf16 v70, v18, v18, v70
    v_dot2_f32_bf16 v69, v19, v75, v69
    v_dot2_f32_bf16 v71, v19, v19, v71
    v_dot2_f32_bf16 v68, v20, v75, v68
    v_dot2_f32_bf16 v70, v20, v20, v70
    v_dot2_f32_bf16 v69, v21, v75, v69
    v_dot2_f32_bf16 v71, v21, v21, v71
    v_dot2_f32_bf16 v68, v22, v75, v68
    v_dot2_f32_bf16 v70, v22, v22, v70
    v_dot2_f32_bf16 v69, v23, v75, v69
    v_dot2_f32_bf16 v71, v23, v23, v71
    v_dot2_f32_bf16 v68, v24, v75, v68
    v_dot2_f32_bf16 v70, v24, v24, v70
    v_dot2_f32_bf16 v69, v25, v75, v69
    v_dot2_f32_bf16 v71, v25, v25, v71
    v_dot2_f32_bf16 v68, v26, v75, v68
    v_dot2_f32_bf16 v70, v26, v26, v70
    v_dot2_f32_bf16 v69, v27, v75, v69
    v_dot2_f32_bf16 v71, v27, v27, v71
    v_dot2_f32_bf16 v68, v28, v75, v68
    v_dot2_f32_bf16 v70, v28, v28, v70
    v_dot2_f32_bf16 v69, v29, v75, v69
    v_dot2_f32_bf16 v71, v29, v29, v71
    v_dot2_f32_bf16 v68, v30, v75, v68
    v_dot2_f32_bf16 v70, v30, v30, v70
    v_dot2_f32_bf16 v69, v31, v75, v69
    v_dot2_f32_bf16 v71, v31, v31, v71
    v_dot2_f32_bf16 v68, v32, v75, v68
    v_dot2_f32_bf16 v70, v32, v32, v70
    v_dot2_f32_bf16 v69, v33, v75, v69
    v_dot2_f32_bf16 v71, v33, v33, v71
    v_dot2_f32_bf16 v68, v34, v75, v68
    v_dot2_f32_bf16 v70, v34, v34, v70
    v_dot2_f32_bf16 v69, v35, v75, v69
    v_dot2_f32_bf16 v71, v35, v35, v71
    v_dot2_f32_bf16 v68, v36, v75, v68
    v_dot2_f32_bf16 v70, v36, v36, v70
    v_dot2_f32_bf16 v69, v37, v75, v69
    v_dot2_f32_bf16 v71, v37, v37, v71
    v_dot2_f32_bf16 v68, v38, v75, v68
    v_dot2_f32_bf16 v70, v38, v38, v70
    v_dot2_f32_bf16 v69, v39, v75, v69
    v_dot2_f32_bf16 v71, v39, v39, v71
    v_dot2_f32_bf16 v68, v40, v75, v68
    v_dot2_f32_bf16 v70, v40, v40, v70
    v_dot2_f32_bf16 v69, v41, v75, v69
    v_dot2_f32_bf16 v71, v41, v41, v71
    v_dot2_f32_bf16 v68, v42, v75, v68
    v_dot2_f32_bf16 v70, v42, v42, v70
    v_dot2_f32_bf16 v69, v43, v75, v69
    v_dot2_f32_bf16 v71, v43, v43, v71
    s_nop 1
    v_add_f32 v68, v68, v69
    v_add_f32 v70, v70, v71
    s_nop 0
    v_add_f32_dpp v68, v68, v68 quad_perm:[1,0,3,2] row_mask:0xf bank_mask:0xf
    v_add_f32_dpp v70, v70, v70 quad_perm:[1,0,3,2] row_mask:0xf bank_mask:0xf
    s_nop 0
    v_add_f32_dpp v68, v68, v68 quad_perm:[2,3,0,1] row_mask:0xf bank_mask:0xf
    v_add_f32_dpp v70, v70, v70 quad_perm:[2,3,0,1] row_mask:0xf bank_mask:0xf
    s_nop 0
    v_add_f32_dpp v68, v68, v68 row_half_mirror row_mask:0xf bank_mask:0xf
    v_add_f32_dpp v70, v70, v70 row_half_mirror row_mask:0xf bank_mask:0xf
    v_mul_f32 v72, 0x3ae38e39, v68
    v_mul_f32 v73, 0x3ae38e39, v70
    v_fma_f32 v73, -v72, v72, v73
    v_max_f32 v73, 0, v73
    v_cvt_pk_bf16_f32 v74, v72, v72
    v_and_b32 v74, 0xffff0000, v74
    v_cvt_pk_bf16_f32 v75, v73, v73
    v_and_b32 v75, 0xffff0000, v75
    v_add_f32 v75, 0x3727c5ac, v75
    v_cvt_pk_bf16_f32 v75, v75, v75
    v_and_b32 v75, 0xffff0000, v75
    v_sqrt_f32 v75, v75
    s_nop 0
    v_cvt_pk_bf16_f32 v75, v75, v75
    v_and_b32 v75, 0xffff0000, v75
    v_rcp_f32 v64, v75
    v_sub_f32 v72, v72, v74
    v_mul_f32 v65, v74, v64
    v_sub_f32 v65, 0, v65
    v_mul_f32 v72, v72, v64
    v_mul_f32 v73, v73, v64
    v_mul_f32 v73, v73, v64
    v_cvt_pk_bf16_f32 v72, v72, v72
    v_and_b32 v72, 0xffff0000, v72
    v_cvt_pk_bf16_f32 v73, v73, v73
    v_and_b32 v73, 0xffff0000, v73
    v_add_f32 v73, 0x3727c5ac, v73
    v_cvt_pk_bf16_f32 v73, v73, v73
    v_and_b32 v73, 0xffff0000, v73
    v_sqrt_f32 v73, v73
    s_nop 0
    v_cvt_pk_bf16_f32 v73, v73, v73
    v_and_b32 v73, 0xffff0000, v73
    v_rcp_f32 v73, v73
    s_nop 0
    v_mul_f32 v66, v64, v73
    v_sub_f32 v67, v65, v72
    v_mul_f32 v67, v67, v73
    v_lshlrev_b32 v88, 16, v8
    v_and_b32 v89, 0xffff0000, v8
    v_fma_f32 v88, v88, v64, v65
    v_fma_f32 v89, v89, v64, v65
    v_cvt_pk_f16_f32 v80, v88, v89
    v_lshlrev_b32 v88, 16, v9
    v_and_b32 v89, 0xffff0000, v9
    v_fma_f32 v88, v88, v64, v65
    v_fma_f32 v89, v89, v64, v65
    v_cvt_pk_f16_f32 v81, v88, v89
    v_lshlrev_b32 v88, 16, v10
    v_and_b32 v89, 0xffff0000, v10
    v_fma_f32 v88, v88, v64, v65
    v_fma_f32 v89, v89, v64, v65
    v_cvt_pk_f16_f32 v82, v88, v89
    v_lshlrev_b32 v88, 16, v11
    v_and_b32 v89, 0xffff0000, v11
    v_fma_f32 v88, v88, v64, v65
    v_fma_f32 v89, v89, v64, v65
    v_cvt_pk_f16_f32 v83, v88, v89
    v_lshlrev_b32 v88, 16, v12
    v_and_b32 v89, 0xffff0000, v12
    v_fma_f32 v88, v88, v64, v65
    v_fma_f32 v89, v89, v64, v65
    v_cvt_pk_f16_f32 v84, v88, v89
    v_lshlrev_b32 v88, 16, v13
    v_and_b32 v89, 0xffff0000, v13
    v_fma_f32 v88, v88, v64, v65
    v_fma_f32 v89, v89, v64, v65
    v_cvt_pk_f16_f32 v85, v88, v89
    v_lshlrev_b32 v88, 16, v14
    v_and_b32 v89, 0xffff0000, v14
    v_fma_f32 v88, v88, v64, v65
    v_fma_f32 v89, v89, v64, v65
    v_cvt_pk_f16_f32 v86, v88, v89
    v_lshlrev_b32 v88, 16, v15
    v_and_b32 v89, 0xffff0000, v15
    v_fma_f32 v88, v88, v64, v65
    v_fma_f32 v89, v89, v64, v65
    v_cvt_pk_f16_f32 v87, v88, v89
    v_and_b32 v2, 7, v1
    v_lshrrev_b32 v3, 3, v1
    v_xor_b32 v4, s5, v2
    v_lshlrev_b32 v4, 4, v4
    v_lshl_add_u32 v4, v2, 10, v4
    v_lshl_add_u32 v4, v3, 1, v4
    v_add_u32 v4, 0, v4
    ds_write_b16 v4, v80 offset:0
    ds_write_b16_d16_hi v4, v80 offset:128
    ds_write_b16 v4, v81 offset:256
    ds_write_b16_d16_hi v4, v81 offset:384
    ds_write_b16 v4, v82 offset:512
    ds_write_b16_d16_hi v4, v82 offset:640
    ds_write_b16 v4, v83 offset:768
    ds_write_b16_d16_hi v4, v83 offset:896
    s_lshl_b32 s6, s5, 4
    s_add_u32 s6, s6, 8192
    v_lshl_add_u32 v4, v3, 1, s6
    v_cmp_eq_u32 vcc, 0, v2
    s_and_saveexec_b64 s[84:85], vcc
    ds_write_b16 v4, v84 offset:0
    ds_write_b16_d16_hi v4, v84 offset:128
    ds_write_b16 v4, v85 offset:256
    ds_write_b16_d16_hi v4, v85 offset:384
    ds_write_b16 v4, v86 offset:512
    ds_write_b16_d16_hi v4, v86 offset:640
    ds_write_b16 v4, v87 offset:768
    ds_write_b16_d16_hi v4, v87 offset:896
    s_mov_b64 exec, s[84:85]
    s_cmp_eq_u32 s47, 0
    s_cbranch_scc1 L_no_u1c_28
    s_waitcnt vmcnt(0)
L_uj_30:
    v_lshrrev_b32 v2, 4, v1
    v_lshlrev_b32 v2, 9, v2
    v_bfe_u32 v3, v1, 2, 2
    v_lshl_add_u32 v2, v3, 7, v2
    v_and_b32 v3, 3, v1
    v_lshl_add_u32 v2, v3, 3, v2
    v_add_u32 v4, s46, v2
    ds_read_b64_tr_b16 v[96:97], v4 offset:0
    ds_read_b64_tr_b16 v[98:99], v4 offset:2048
    ds_read_b64_tr_b16 v[100:101], v4 offset:32
    ds_read_b64_tr_b16 v[102:103], v4 offset:2080
    ds_read_b64_tr_b16 v[104:105], v4 offset:64
    ds_read_b64_tr_b16 v[106:107], v4 offset:2112
    ds_read_b64_tr_b16 v[108:109], v4 offset:96
    ds_read_b64_tr_b16 v[110:111], v4 offset:2144
    v_lshlrev_b32 v3, 4, v1
    s_waitcnt lgkmcnt(0)
    buffer_store_dwordx4 v[96:99], v3, s[52:55], s18 offen sc1
    buffer_store_dwordx4 v[100:103], v3, s[52:55], s19 offen sc1
    buffer_store_dwordx4 v[104:107], v3, s[52:55], s20 offen sc1
    buffer_store_dwordx4 v[108:111], v3, s[52:55], s21 offen sc1
L_no_u1c_28:
    s_cmp_lg_u32 s47, 0
    s_cbranch_scc1 L_wb1_31
    s_waitcnt vmcnt(1)
L_wb1_31:
    v_lshlrev_b32 v2, 3, v0
    v_add_u32 v2, 161280, v2
    v_lshlrev_b32 v4, 16, v62
    v_and_b32 v5, 0xffff0000, v62
    v_cmp_gt_u32 vcc, 288, v0
    s_and_saveexec_b64 s[84:85], vcc
    ds_write_b64 v2, v[4:5]
    s_mov_b64 exec, s[84:85]
    s_waitcnt lgkmcnt(0)
    s_barrier
    s_mul_i32 s6, s4, 72
    s_lshl_b32 s6, s6, 12
    s_lshl_b32 s7, s3, 7
    s_add_u32 s6, s6, s7
    s_add_u32 s6, s6, 10616832
    v_lshrrev_b32 v3, 3, v0
    v_and_b32 v4, 7, v0
    v_bfe_u32 v5, v3, 3, 3
    v_xor_b32 v5, v5, v4
    v_lshlrev_b32 v5, 4, v5
    v_lshl_add_u32 v5, v3, 7, v5
    v_add_u32 v5, 0, v5
    ds_read_b128 v[80:83], v5
    v_lshlrev_b32 v3, 12, v3
    v_lshl_add_u32 v3, v4, 4, v3
    s_waitcnt lgkmcnt(0)
    buffer_store_dwordx4 v[80:83], v3, s[52:55], s6 offen sc1
    s_cmp_lg_u32 s5, 0
    s_cbranch_scc1 L_xp_no_32
    v_add_u32 v2, 512, v1
    v_lshrrev_b32 v3, 3, v2
    v_and_b32 v4, 7, v2
    v_bfe_u32 v5, v3, 3, 3
    v_xor_b32 v5, v5, v4
    v_lshlrev_b32 v5, 4, v5
    v_lshl_add_u32 v5, v3, 7, v5
    v_add_u32 v5, 0, v5
    ds_read_b128 v[84:87], v5
    v_lshlrev_b32 v3, 12, v3
    v_lshl_add_u32 v3, v4, 4, v3
    s_waitcnt lgkmcnt(0)
    buffer_store_dwordx4 v[84:87], v3, s[52:55], s6 offen sc1
    v_mov_b32 v2, 0
    s_mov_b64 s[84:85], exec
    s_mov_b64 exec, 1
    s_cmp_lg_u32 s4, 0
    s_cbranch_scc1 L_xp_c_33
    s_lshl_b32 s6, s3, 7
    s_add_u32 s6, s6, 34209792
    buffer_store_dword v2, v2, s[52:55], s6 offen sc1
    s_add_u32 s6, s6, 8192
    buffer_store_dword v2, v2, s[52:55], s6 offen sc1
L_xp_c_33:
    s_cmp_ge_u32 s2, 8
    s_cbranch_scc1 L_xp_b_34
    s_lshl_b32 s6, s2, 7
    s_add_u32 s6, s6, 34213888
    buffer_store_dword v2, v2, s[52:55], s6 offen sc1
L_xp_b_34:
    s_mov_b64 exec, s[84:85]
L_xp_no_32:
    s_barrier
    s_cmp_ge_u32 s5, 4
    s_cbranch_scc1 L_n5a_35
    s_add_u32 m0, s80, 0
    s_nop 0
    buffer_load_dwordx4 v222, s[56:59], s81 offen lds
    v_lshlrev_b32 v68, 16, v8
    v_and_b32 v69, 0xffff0000, v8
    v_fma_f32 v68, v68, v66, v67
    v_fma_f32 v69, v69, v66, v67
    v_cvt_pk_bf16_f32 v8, v68, v69
    v_lshlrev_b32 v70, 16, v9
    v_and_b32 v71, 0xffff0000, v9
    v_fma_f32 v70, v70, v66, v67
    v_fma_f32 v71, v71, v66, v67
    v_cvt_pk_bf16_f32 v9, v70, v71
    v_lshlrev_b32 v68, 16, v10
    v_and_b32 v69, 0xffff0000, v10
    v_fma_f32 v68, v68, v66, v67
    v_fma_f32 v69, v69, v66, v67
    v_cvt_pk_bf16_f32 v10, v68, v69
    s_add_u32 m0, s80, 1024
    s_add_u32 s7, s81, 73728
    buffer_load_dwordx4 v223, s[56:59], s7 offen lds
    v_lshlrev_b32 v70, 16, v11
    v_and_b32 v71, 0xffff0000, v11
    v_fma_f32 v70, v70, v66, v67
    v_fma_f32 v71, v71, v66, v67
    v_cvt_pk_bf16_f32 v11, v70, v71
    v_lshlrev_b32 v68, 16, v12
    v_and_b32 v69, 0xffff0000, v12
    v_fma_f32 v68, v68, v66, v67
    v_fma_f32 v69, v69, v66, v67
    v_cvt_pk_bf16_f32 v12, v68, v69
    v_lshlrev_b32 v70, 16, v13
    v_and_b32 v71, 0xffff0000, v13
    v_fma_f32 v70, v70, v66, v67
    v_fma_f32 v71, v71, v66, v67
    v_cvt_pk_bf16_f32 v13, v70, v71
    s_add_u32 m0, s80, 2048
    s_add_u32 s7, s81, 147456
    buffer_load_dwordx4 v222, s[56:59], s7 offen lds
    v_lshlrev_b32 v68, 16, v14
    v_and_b32 v69, 0xffff0000, v14
    v_fma_f32 v68, v68, v66, v67
    v_fma_f32 v69, v69, v66, v67
    v_cvt_pk_bf16_f32 v14, v68, v69
    v_lshlrev_b32 v70, 16, v15
    v_and_b32 v71, 0xffff0000, v15
    v_fma_f32 v70, v70, v66, v67
    v_fma_f32 v71, v71, v66, v67
    v_cvt_pk_bf16_f32 v15, v70, v71
    v_lshlrev_b32 v68, 16, v16
    v_and_b32 v69, 0xffff0000, v16
    v_fma_f32 v68, v68, v66, v67
    v_fma_f32 v69, v69, v66, v67
    v_cvt_pk_bf16_f32 v16, v68, v69
    s_add_u32 m0, s80, 3072
    s_add_u32 s7, s81, 221184
    buffer_load_dwordx4 v223, s[56:59], s7 offen lds
    s_add_u32 s81, s81, 294912
    v_lshlrev_b32 v70, 16, v17
    v_and_b32 v71, 0xffff0000, v17
    v_fma_f32 v70, v70, v66, v67
    v_fma_f32 v71, v71, v66, v67
    v_cvt_pk_bf16_f32 v17, v70, v71
    v_lshlrev_b32 v68, 16, v18
    v_and_b32 v69, 0xffff0000, v18
    v_fma_f32 v68, v68, v66, v67
    v_fma_f32 v69, v69, v66, v67
    v_cvt_pk_bf16_f32 v18, v68, v69
    v_lshlrev_b32 v70, 16, v19
    v_and_b32 v71, 0xffff0000, v19
    v_fma_f32 v70, v70, v66, v67
    v_fma_f32 v71, v71, v66, v67
    v_cvt_pk_bf16_f32 v19, v70, v71
    s_add_u32 m0, s80, 4096
    s_nop 0
    buffer_load_dwordx4 v224, s[56:59], s82 offen lds
    s_add_u32 s82, s82, 294912
    v_lshlrev_b32 v68, 16, v20
    v_and_b32 v69, 0xffff0000, v20
    v_fma_f32 v68, v68, v66, v67
    v_fma_f32 v69, v69, v66, v67
    v_cvt_pk_bf16_f32 v20, v68, v69
    v_lshlrev_b32 v70, 16, v21
    v_and_b32 v71, 0xffff0000, v21
    v_fma_f32 v70, v70, v66, v67
    v_fma_f32 v71, v71, v66, v67
    v_cvt_pk_bf16_f32 v21, v70, v71
    v_lshlrev_b32 v68, 16, v22
    v_and_b32 v69, 0xffff0000, v22
    v_fma_f32 v68, v68, v66, v67
    v_fma_f32 v69, v69, v66, v67
    v_cvt_pk_bf16_f32 v22, v68, v69
    s_add_u32 m0, s80, 5120
    s_nop 0
    buffer_load_dwordx4 v222, s[56:59], s81 offen lds
    v_lshlrev_b32 v70, 16, v23
    v_and_b32 v71, 0xffff0000, v23
    v_fma_f32 v70, v70, v66, v67
    v_fma_f32 v71, v71, v66, v67
    v_cvt_pk_bf16_f32 v23, v70, v71
    v_lshlrev_b32 v68, 16, v24
    v_and_b32 v69, 0xffff0000, v24
    v_fma_f32 v68, v68, v66, v67
    v_fma_f32 v69, v69, v66, v67
    v_cvt_pk_bf16_f32 v24, v68, v69
    v_lshlrev_b32 v70, 16, v25
    v_and_b32 v71, 0xffff0000, v25
    v_fma_f32 v70, v70, v66, v67
    v_fma_f32 v71, v71, v66, v67
    v_cvt_pk_bf16_f32 v25, v70, v71
    s_add_u32 m0, s80, 6144
    s_add_u32 s7, s81, 73728
    buffer_load_dwordx4 v223, s[56:59], s7 offen lds
    v_lshlrev_b32 v68, 16, v26
    v_and_b32 v69, 0xffff0000, v26
    v_fma_f32 v68, v68, v66, v67
    v_fma_f32 v69, v69, v66, v67
    v_cvt_pk_bf16_f32 v26, v68, v69
    v_lshlrev_b32 v70, 16, v27
    v_and_b32 v71, 0xffff0000, v27
    v_fma_f32 v70, v70, v66, v67
    v_fma_f32 v71, v71, v66, v67
    v_cvt_pk_bf16_f32 v27, v70, v71
    v_lshlrev_b32 v68, 16, v28
    v_and_b32 v69, 0xffff0000, v28
    v_fma_f32 v68, v68, v66, v67
    v_fma_f32 v69, v69, v66, v67
    v_cvt_pk_bf16_f32 v28, v68, v69
    s_add_u32 m0, s80, 7168
    s_add_u32 s7, s81, 147456
    buffer_load_dwordx4 v222, s[56:59], s7 offen lds
    v_lshlrev_b32 v70, 16, v29
    v_and_b32 v71, 0xffff0000, v29
    v_fma_f32 v70, v70, v66, v67
    v_fma_f32 v71, v71, v66, v67
    v_cvt_pk_bf16_f32 v29, v70, v71
    v_lshlrev_b32 v68, 16, v30
    v_and_b32 v69, 0xffff0000, v30
    v_fma_f32 v68, v68, v66, v67
    v_fma_f32 v69, v69, v66, v67
    v_cvt_pk_bf16_f32 v30, v68, v69
    v_lshlrev_b32 v70, 16, v31
    v_and_b32 v71, 0xffff0000, v31
    v_fma_f32 v70, v70, v66, v67
    v_fma_f32 v71, v71, v66, v67
    v_cvt_pk_bf16_f32 v31, v70, v71
    s_add_u32 m0, s80, 8192
    s_add_u32 s7, s81, 221184
    buffer_load_dwordx4 v223, s[56:59], s7 offen lds
    s_add_u32 s81, s81, 294912
    v_lshlrev_b32 v68, 16, v32
    v_and_b32 v69, 0xffff0000, v32
    v_fma_f32 v68, v68, v66, v67
    v_fma_f32 v69, v69, v66, v67
    v_cvt_pk_bf16_f32 v32, v68, v69
    v_lshlrev_b32 v70, 16, v33
    v_and_b32 v71, 0xffff0000, v33
    v_fma_f32 v70, v70, v66, v67
    v_fma_f32 v71, v71, v66, v67
    v_cvt_pk_bf16_f32 v33, v70, v71
    v_lshlrev_b32 v68, 16, v34
    v_and_b32 v69, 0xffff0000, v34
    v_fma_f32 v68, v68, v66, v67
    v_fma_f32 v69, v69, v66, v67
    v_cvt_pk_bf16_f32 v34, v68, v69
    s_add_u32 m0, s80, 9216
    s_nop 0
    buffer_load_dwordx4 v224, s[56:59], s82 offen lds
    s_add_u32 s82, s82, 294912
    v_lshlrev_b32 v70, 16, v35
    v_and_b32 v71, 0xffff0000, v35
    v_fma_f32 v70, v70, v66, v67
    v_fma_f32 v71, v71, v66, v67
    v_cvt_pk_bf16_f32 v35, v70, v71
    v_lshlrev_b32 v68, 16, v36
    v_and_b32 v69, 0xffff0000, v36
    v_fma_f32 v68, v68, v66, v67
    v_fma_f32 v69, v69, v66, v67
    v_cvt_pk_bf16_f32 v36, v68, v69
    v_lshlrev_b32 v70, 16, v37
    v_and_b32 v71, 0xffff0000, v37
    v_fma_f32 v70, v70, v66, v67
    v_fma_f32 v71, v71, v66, v67
    v_cvt_pk_bf16_f32 v37, v70, v71
    v_lshlrev_b32 v68, 16, v38
    v_and_b32 v69, 0xffff0000, v38
    v_fma_f32 v68, v68, v66, v67
    v_fma_f32 v69, v69, v66, v67
    v_cvt_pk_bf16_f32 v38, v68, v69
    v_lshlrev_b32 v70, 16, v39
    v_and_b32 v71, 0xffff0000, v39
    v_fma_f32 v70, v70, v66, v67
    v_fma_f32 v71, v71, v66, v67
    v_cvt_pk_bf16_f32 v39, v70, v71
    v_lshlrev_b32 v68, 16, v40
    v_and_b32 v69, 0xffff0000, v40
    v_fma_f32 v68, v68, v66, v67
    v_fma_f32 v69, v69, v66, v67
    v_cvt_pk_bf16_f32 v40, v68, v69
    v_lshlrev_b32 v70, 16, v41
    v_and_b32 v71, 0xffff0000, v41
    v_fma_f32 v70, v70, v66, v67
    v_fma_f32 v71, v71, v66, v67
    v_cvt_pk_bf16_f32 v41, v70, v71
    v_lshlrev_b32 v68, 16, v42
    v_and_b32 v69, 0xffff0000, v42
    v_fma_f32 v68, v68, v66, v67
    v_fma_f32 v69, v69, v66, v67
    v_cvt_pk_bf16_f32 v42, v68, v69
    v_lshlrev_b32 v70, 16, v43
    v_and_b32 v71, 0xffff0000, v43
    v_fma_f32 v70, v70, v66, v67
    v_fma_f32 v71, v71, v66, v67
    v_cvt_pk_bf16_f32 v43, v70, v71
    s_lshr_b32 s6, s5, 1
    s_lshl_b32 s6, s6, 10
    s_add_u32 s6, s6, 0
    s_and_b32 s7, s5, 1
    s_lshl_b32 s7, s7, 3
    v_lshrrev_b32 v2, 3, v1
    v_add_u32 v2, s7, v2
    v_and_b32 v3, 7, v44
    v_xor_b32 v2, v2, v3
    v_and_b32 v3, 3, v44
    v_lshl_add_u32 v2, v3, 4, v2
    v_lshl_add_u32 v2, v2, 4, s6
    v_lshrrev_b32 v3, 2, v44
    v_lshl_add_u32 v3, v3, 12, v2
    ds_write_b128 v3, v[8:11]
    v_lshrrev_b32 v3, 2, v45
    v_lshl_add_u32 v3, v3, 12, v2
    ds_write_b128 v3, v[12:15]
    v_lshrrev_b32 v3, 2, v46
    v_lshl_add_u32 v3, v3, 12, v2
    ds_write_b128 v3, v[16:19]
    v_lshrrev_b32 v3, 2, v47
    v_lshl_add_u32 v3, v3, 12, v2
    ds_write_b128 v3, v[20:23]
    v_lshrrev_b32 v3, 2, v48
    v_lshl_add_u32 v3, v3, 12, v2
    ds_write_b128 v3, v[24:27]
    v_lshrrev_b32 v3, 2, v49
    v_lshl_add_u32 v3, v3, 12, v2
    ds_write_b128 v3, v[28:31]
    v_lshrrev_b32 v3, 2, v50
    v_lshl_add_u32 v3, v3, 12, v2
    ds_write_b128 v3, v[32:35]
    v_lshrrev_b32 v3, 2, v51
    v_lshl_add_u32 v3, v3, 12, v2
    ds_write_b128 v3, v[36:39]
    v_lshrrev_b32 v3, 2, v52
    v_lshl_add_u32 v3, v3, 12, v2
    ds_write_b128 v3, v[40:43]
    s_branch L_ja_36
L_n5a_35:
    s_add_u32 m0, s80, 0
    s_nop 0
    buffer_load_dwordx4 v222, s[56:59], s81 offen lds
    v_lshlrev_b32 v68, 16, v8
    v_and_b32 v69, 0xffff0000, v8
    v_fma_f32 v68, v68, v66, v67
    v_fma_f32 v69, v69, v66, v67
    v_cvt_pk_bf16_f32 v8, v68, v69
    v_lshlrev_b32 v70, 16, v9
    v_and_b32 v71, 0xffff0000, v9
    v_fma_f32 v70, v70, v66, v67
    v_fma_f32 v71, v71, v66, v67
    v_cvt_pk_bf16_f32 v9, v70, v71
    v_lshlrev_b32 v68, 16, v10
    v_and_b32 v69, 0xffff0000, v10
    v_fma_f32 v68, v68, v66, v67
    v_fma_f32 v69, v69, v66, v67
    v_cvt_pk_bf16_f32 v10, v68, v69
    v_lshlrev_b32 v70, 16, v11
    v_and_b32 v71, 0xffff0000, v11
    v_fma_f32 v70, v70, v66, v67
    v_fma_f32 v71, v71, v66, v67
    v_cvt_pk_bf16_f32 v11, v70, v71
    s_add_u32 m0, s80, 1024
    s_add_u32 s7, s81, 73728
    buffer_load_dwordx4 v223, s[56:59], s7 offen lds
    v_lshlrev_b32 v68, 16, v12
    v_and_b32 v69, 0xffff0000, v12
    v_fma_f32 v68, v68, v66, v67
    v_fma_f32 v69, v69, v66, v67
    v_cvt_pk_bf16_f32 v12, v68, v69
    v_lshlrev_b32 v70, 16, v13
    v_and_b32 v71, 0xffff0000, v13
    v_fma_f32 v70, v70, v66, v67
    v_fma_f32 v71, v71, v66, v67
    v_cvt_pk_bf16_f32 v13, v70, v71
    v_lshlrev_b32 v68, 16, v14
    v_and_b32 v69, 0xffff0000, v14
    v_fma_f32 v68, v68, v66, v67
    v_fma_f32 v69, v69, v66, v67
    v_cvt_pk_bf16_f32 v14, v68, v69
    v_lshlrev_b32 v70, 16, v15
    v_and_b32 v71, 0xffff0000, v15
    v_fma_f32 v70, v70, v66, v67
    v_fma_f32 v71, v71, v66, v67
    v_cvt_pk_bf16_f32 v15, v70, v71
    s_add_u32 m0, s80, 2048
    s_add_u32 s7, s81, 147456
    buffer_load_dwordx4 v222, s[56:59], s7 offen lds
    v_lshlrev_b32 v68, 16, v16
    v_and_b32 v69, 0xffff0000, v16
    v_fma_f32 v68, v68, v66, v67
    v_fma_f32 v69, v69, v66, v67
    v_cvt_pk_bf16_f32 v16, v68, v69
    v_lshlrev_b32 v70, 16, v17
    v_and_b32 v71, 0xffff0000, v17
    v_fma_f32 v70, v70, v66, v67
    v_fma_f32 v71, v71, v66, v67
    v_cvt_pk_bf16_f32 v17, v70, v71
    v_lshlrev_b32 v68, 16, v18
    v_and_b32 v69, 0xffff0000, v18
    v_fma_f32 v68, v68, v66, v67
    v_fma_f32 v69, v69, v66, v67
    v_cvt_pk_bf16_f32 v18, v68, v69
    v_lshlrev_b32 v70, 16, v19
    v_and_b32 v71, 0xffff0000, v19
    v_fma_f32 v70, v70, v66, v67
    v_fma_f32 v71, v71, v66, v67
    v_cvt_pk_bf16_f32 v19, v70, v71
    s_add_u32 m0, s80, 3072
    s_add_u32 s7, s81, 221184
    buffer_load_dwordx4 v223, s[56:59], s7 offen lds
    s_add_u32 s81, s81, 294912
    v_lshlrev_b32 v68, 16, v20
    v_and_b32 v69, 0xffff0000, v20
    v_fma_f32 v68, v68, v66, v67
    v_fma_f32 v69, v69, v66, v67
    v_cvt_pk_bf16_f32 v20, v68, v69
    v_lshlrev_b32 v70, 16, v21
    v_and_b32 v71, 0xffff0000, v21
    v_fma_f32 v70, v70, v66, v67
    v_fma_f32 v71, v71, v66, v67
    v_cvt_pk_bf16_f32 v21, v70, v71
    v_lshlrev_b32 v68, 16, v22
    v_and_b32 v69, 0xffff0000, v22
    v_fma_f32 v68, v68, v66, v67
    v_fma_f32 v69, v69, v66, v67
    v_cvt_pk_bf16_f32 v22, v68, v69
    v_lshlrev_b32 v70, 16, v23
    v_and_b32 v71, 0xffff0000, v23
    v_fma_f32 v70, v70, v66, v67
    v_fma_f32 v71, v71, v66, v67
    v_cvt_pk_bf16_f32 v23, v70, v71
    s_add_u32 m0, s80, 4096
    s_nop 0
    buffer_load_dwordx4 v222, s[56:59], s81 offen lds
    v_lshlrev_b32 v68, 16, v24
    v_and_b32 v69, 0xffff0000, v24
    v_fma_f32 v68, v68, v66, v67
    v_fma_f32 v69, v69, v66, v67
    v_cvt_pk_bf16_f32 v24, v68, v69
    v_lshlrev_b32 v70, 16, v25
    v_and_b32 v71, 0xffff0000, v25
    v_fma_f32 v70, v70, v66, v67
    v_fma_f32 v71, v71, v66, v67
    v_cvt_pk_bf16_f32 v25, v70, v71
    v_lshlrev_b32 v68, 16, v26
    v_and_b32 v69, 0xffff0000, v26
    v_fma_f32 v68, v68, v66, v67
    v_fma_f32 v69, v69, v66, v67
    v_cvt_pk_bf16_f32 v26, v68, v69
    v_lshlrev_b32 v70, 16, v27
    v_and_b32 v71, 0xffff0000, v27
    v_fma_f32 v70, v70, v66, v67
    v_fma_f32 v71, v71, v66, v67
    v_cvt_pk_bf16_f32 v27, v70, v71
    s_add_u32 m0, s80, 5120
    s_add_u32 s7, s81, 73728
    buffer_load_dwordx4 v223, s[56:59], s7 offen lds
    v_lshlrev_b32 v68, 16, v28
    v_and_b32 v69, 0xffff0000, v28
    v_fma_f32 v68, v68, v66, v67
    v_fma_f32 v69, v69, v66, v67
    v_cvt_pk_bf16_f32 v28, v68, v69
    v_lshlrev_b32 v70, 16, v29
    v_and_b32 v71, 0xffff0000, v29
    v_fma_f32 v70, v70, v66, v67
    v_fma_f32 v71, v71, v66, v67
    v_cvt_pk_bf16_f32 v29, v70, v71
    v_lshlrev_b32 v68, 16, v30
    v_and_b32 v69, 0xffff0000, v30
    v_fma_f32 v68, v68, v66, v67
    v_fma_f32 v69, v69, v66, v67
    v_cvt_pk_bf16_f32 v30, v68, v69
    v_lshlrev_b32 v70, 16, v31
    v_and_b32 v71, 0xffff0000, v31
    v_fma_f32 v70, v70, v66, v67
    v_fma_f32 v71, v71, v66, v67
    v_cvt_pk_bf16_f32 v31, v70, v71
    s_add_u32 m0, s80, 6144
    s_add_u32 s7, s81, 147456
    buffer_load_dwordx4 v222, s[56:59], s7 offen lds
    v_lshlrev_b32 v68, 16, v32
    v_and_b32 v69, 0xffff0000, v32
    v_fma_f32 v68, v68, v66, v67
    v_fma_f32 v69, v69, v66, v67
    v_cvt_pk_bf16_f32 v32, v68, v69
    v_lshlrev_b32 v70, 16, v33
    v_and_b32 v71, 0xffff0000, v33
    v_fma_f32 v70, v70, v66, v67
    v_fma_f32 v71, v71, v66, v67
    v_cvt_pk_bf16_f32 v33, v70, v71
    v_lshlrev_b32 v68, 16, v34
    v_and_b32 v69, 0xffff0000, v34
    v_fma_f32 v68, v68, v66, v67
    v_fma_f32 v69, v69, v66, v67
    v_cvt_pk_bf16_f32 v34, v68, v69
    v_lshlrev_b32 v70, 16, v35
    v_and_b32 v71, 0xffff0000, v35
    v_fma_f32 v70, v70, v66, v67
    v_fma_f32 v71, v71, v66, v67
    v_cvt_pk_bf16_f32 v35, v70, v71
    s_add_u32 m0, s80, 7168
    s_add_u32 s7, s81, 221184
    buffer_load_dwordx4 v223, s[56:59], s7 offen lds
    s_add_u32 s81, s81, 294912
    v_lshlrev_b32 v68, 16, v36
    v_and_b32 v69, 0xffff0000, v36
    v_fma_f32 v68, v68, v66, v67
    v_fma_f32 v69, v69, v66, v67
    v_cvt_pk_bf16_f32 v36, v68, v69
    v_lshlrev_b32 v70, 16, v37
    v_and_b32 v71, 0xffff0000, v37
    v_fma_f32 v70, v70, v66, v67
    v_fma_f32 v71, v71, v66, v67
    v_cvt_pk_bf16_f32 v37, v70, v71
    v_lshlrev_b32 v68, 16, v38
    v_and_b32 v69, 0xffff0000, v38
    v_fma_f32 v68, v68, v66, v67
    v_fma_f32 v69, v69, v66, v67
    v_cvt_pk_bf16_f32 v38, v68, v69
    v_lshlrev_b32 v70, 16, v39
    v_and_b32 v71, 0xffff0000, v39
    v_fma_f32 v70, v70, v66, v67
    v_fma_f32 v71, v71, v66, v67
    v_cvt_pk_bf16_f32 v39, v70, v71
    v_lshlrev_b32 v68, 16, v40
    v_and_b32 v69, 0xffff0000, v40
    v_fma_f32 v68, v68, v66, v67
    v_fma_f32 v69, v69, v66, v67
    v_cvt_pk_bf16_f32 v40, v68, v69
    v_lshlrev_b32 v70, 16, v41
    v_and_b32 v71, 0xffff0000, v41
    v_fma_f32 v70, v70, v66, v67
    v_fma_f32 v71, v71, v66, v67
    v_cvt_pk_bf16_f32 v41, v70, v71
    v_lshlrev_b32 v68, 16, v42
    v_and_b32 v69, 0xffff0000, v42
    v_fma_f32 v68, v68, v66, v67
    v_fma_f32 v69, v69, v66, v67
    v_cvt_pk_bf16_f32 v42, v68, v69
    v_lshlrev_b32 v70, 16, v43
    v_and_b32 v71, 0xffff0000, v43
    v_fma_f32 v70, v70, v66, v67
    v_fma_f32 v71, v71, v66, v67
    v_cvt_pk_bf16_f32 v43, v70, v71
    s_lshr_b32 s6, s5, 1
    s_lshl_b32 s6, s6, 10
    s_add_u32 s6, s6, 0
    s_and_b32 s7, s5, 1
    s_lshl_b32 s7, s7, 3
    v_lshrrev_b32 v2, 3, v1
    v_add_u32 v2, s7, v2
    v_and_b32 v3, 7, v44
    v_xor_b32 v2, v2, v3
    v_and_b32 v3, 3, v44
    v_lshl_add_u32 v2, v3, 4, v2
    v_lshl_add_u32 v2, v2, 4, s6
    v_lshrrev_b32 v3, 2, v44
    v_lshl_add_u32 v3, v3, 12, v2
    ds_write_b128 v3, v[8:11]
    v_lshrrev_b32 v3, 2, v45
    v_lshl_add_u32 v3, v3, 12, v2
    ds_write_b128 v3, v[12:15]
    v_lshrrev_b32 v3, 2, v46
    v_lshl_add_u32 v3, v3, 12, v2
    ds_write_b128 v3, v[16:19]
    v_lshrrev_b32 v3, 2, v47
    v_lshl_add_u32 v3, v3, 12, v2
    ds_write_b128 v3, v[20:23]
    v_lshrrev_b32 v3, 2, v48
    v_lshl_add_u32 v3, v3, 12, v2
    ds_write_b128 v3, v[24:27]
    v_lshrrev_b32 v3, 2, v49
    v_lshl_add_u32 v3, v3, 12, v2
    ds_write_b128 v3, v[28:31]
    v_lshrrev_b32 v3, 2, v50
    v_lshl_add_u32 v3, v3, 12, v2
    ds_write_b128 v3, v[32:35]
    v_lshrrev_b32 v3, 2, v51
    v_lshl_add_u32 v3, v3, 12, v2
    ds_write_b128 v3, v[36:39]
    v_lshrrev_b32 v3, 2, v52
    v_lshl_add_u32 v3, v3, 12, v2
    ds_write_b128 v3, v[40:43]
L_ja_36:
    s_cmp_ge_u32 s5, 4
    s_cbranch_scc1 L_w5_37
    s_waitcnt vmcnt(10) lgkmcnt(0)
    s_branch L_wj_38
L_w5_37:
    s_waitcnt vmcnt(8) lgkmcnt(0)
L_wj_38:
    s_barrier
    s_cmp_lg_u32 s5, 0
    s_cbranch_scc1 L_arrA_39
    s_and_b32 s6, s2, 3
    s_lshl_b32 s6, s6, 6
    v_mov_b32 v2, s6
    v_mov_b32 v3, 1
    s_mov_b64 s[14:15], exec
    s_mov_b64 exec, 1
    buffer_atomic_add v3, v2, s[68:71], 0 offen sc1
    s_mov_b64 exec, s[14:15]
L_arrA_39:
    v_mov_b32 v59, 0
    v_mov_b32 v60, 0
    v_lshlrev_b32 v58, 4, v1
    s_mul_i32 s77, s4, 1327104
    s_mul_i32 s6, s5, 144
    s_min_u32 s7, s5, 4
    s_mul_i32 s7, s7, 36
    s_add_u32 s6, s6, s7
    s_lshl_b32 s6, s6, 10
    s_add_u32 s77, s77, s6
    s_cmp_lt_u32 s5, 4
    s_cselect_b32 s6, 18, 0
    s_add_u32 s6, s6, 72
    s_lshl_b32 s6, s6, 10
    s_add_u32 s77, s77, s6
    s_mov_b32 s60, s44
    s_and_b32 s61, s45, 0xffff
    s_mov_b32 s62, 0
    s_mov_b32 s63, 0x20000
    s_cmp_ge_u32 s5, 4
    s_cbranch_scc1 L_n5_40
    v_and_b32 v2, 15, v1
    v_lshrrev_b32 v3, 4, v1
    v_xor_b32 v2, v2, v3
    v_lshl_add_u32 v4, v3, 4, v2
    v_lshlrev_b32 v56, 4, v4
    v_xor_b32 v2, 4, v2
    v_lshl_add_u32 v4, v3, 4, v2
    v_lshlrev_b32 v57, 4, v4
    v_lshlrev_b32 v3, 4, v3
    s_lshl_b32 s6, s5, 8
    s_add_u32 s6, s6, 161280
    v_add_u32 v4, s6, v3
    ds_read_b128 v[64:67], v4 offset:0
    ds_read_b128 v[68:71], v4 offset:0
    ds_read_b128 v[72:75], v4 offset:0
    ds_read_b128 v[76:79], v4 offset:0
    ds_read_b128 v[80:83], v4 offset:64
    ds_read_b128 v[84:87], v4 offset:64
    ds_read_b128 v[88:91], v4 offset:64
    ds_read_b128 v[92:95], v4 offset:64
    ds_read_b128 v[96:99], v4 offset:128
    ds_read_b128 v[100:103], v4 offset:128
    ds_read_b128 v[104:107], v4 offset:128
    ds_read_b128 v[108:111], v4 offset:128
    ds_read_b128 v[112:115], v4 offset:192
    ds_read_b128 v[116:119], v4 offset:192
    ds_read_b128 v[120:123], v4 offset:192
    ds_read_b128 v[124:127], v4 offset:192
    s_lshl_b32 s6, s5, 6
    s_add_u32 s6, s6, 163328
    v_add_u32 v4, s6, v3
    ds_read_b128 v[128:131], v4
    ds_read_b128 v[132:135], v4
    ds_read_b128 v[136:139], v4
    ds_read_b128 v[140:143], v4
    ds_read_b128 v[144:147], v56 offset:0
    ds_read_b128 v[148:151], v56 offset:1024
    ds_read_b128 v[152:155], v56 offset:2048
    ds_read_b128 v[156:159], v56 offset:3072
    s_waitcnt vmcnt(5)
    ds_read_b64_tr_b16 v[176:177], v216 offset:0
    ds_read_b64_tr_b16 v[178:179], v216 offset:512
    ds_read_b64_tr_b16 v[180:181], v217 offset:0
    ds_read_b64_tr_b16 v[182:183], v217 offset:512
    ds_read_b64_tr_b16 v[184:185], v218 offset:0
    ds_read_b64_tr_b16 v[186:187], v218 offset:512
    ds_read_b64_tr_b16 v[188:189], v219 offset:0
    ds_read_b64_tr_b16 v[190:191], v219 offset:512
    ds_read_b64_tr_b16 v[192:193], v220 offset:0
    ds_read_b64_tr_b16 v[194:195], v221 offset:0
    s_waitcnt lgkmcnt(0)
    s_add_u32 m0, s80, 0
    s_nop 0
    buffer_load_dwordx4 v222, s[56:59], s81 offen lds
    s_add_u32 m0, s80, 1024
    s_add_u32 s7, s81, 73728
    buffer_load_dwordx4 v223, s[56:59], s7 offen lds
    s_add_u32 m0, s80, 2048
    s_add_u32 s7, s81, 147456
    buffer_load_dwordx4 v222, s[56:59], s7 offen lds
    s_add_u32 m0, s80, 3072
    s_add_u32 s7, s81, 221184
    buffer_load_dwordx4 v223, s[56:59], s7 offen lds
    s_add_u32 s81, s81, 294912
    s_add_u32 m0, s80, 4096
    s_nop 0
    buffer_load_dwordx4 v224, s[56:59], s82 offen lds
    s_add_u32 s82, s82, 294912
    s_mov_b32 s78, 7
L_g1_42:
    s_waitcnt vmcnt(5)
    ds_read_b64_tr_b16 v[196:197], v216 offset:5120
    v_mfma_f32_16x16x32_bf16 v[64:67], v[176:179], v[144:147], v[64:67]
    ds_read_b64_tr_b16 v[198:199], v216 offset:5632
    v_mfma_f32_16x16x32_bf16 v[68:71], v[176:179], v[148:151], v[68:71]
    ds_read_b64_tr_b16 v[200:201], v217 offset:5120
    v_mfma_f32_16x16x32_bf16 v[72:75], v[176:179], v[152:155], v[72:75]
    ds_read_b64_tr_b16 v[202:203], v217 offset:5632
    v_mfma_f32_16x16x32_bf16 v[76:79], v[176:179], v[156:159], v[76:79]
    ds_read_b64_tr_b16 v[204:205], v218 offset:5120
    v_mfma_f32_16x16x32_bf16 v[80:83], v[180:183], v[144:147], v[80:83]
    ds_read_b64_tr_b16 v[206:207], v218 offset:5632
    v_mfma_f32_16x16x32_bf16 v[84:87], v[180:183], v[148:151], v[84:87]
    ds_read_b64_tr_b16 v[208:209], v219 offset:5120
    v_mfma_f32_16x16x32_bf16 v[88:91], v[180:183], v[152:155], v[88:91]
    ds_read_b64_tr_b16 v[210:211], v219 offset:5632
    v_mfma_f32_16x16x32_bf16 v[92:95], v[180:183], v[156:159], v[92:95]
    ds_read_b64_tr_b16 v[212:213], v220 offset:5120
    v_mfma_f32_16x16x32_bf16 v[96:99], v[184:187], v[144:147], v[96:99]
    ds_read_b64_tr_b16 v[214:215], v221 offset:5120
    v_mfma_f32_16x16x32_bf16 v[100:103], v[184:187], v[148:151], v[100:103]
    ds_read_b128 v[160:163], v57 offset:4096
    v_mfma_f32_16x16x32_bf16 v[104:107], v[184:187], v[152:155], v[104:107]
    ds_read_b128 v[164:167], v57 offset:5120
    v_mfma_f32_16x16x32_bf16 v[108:111], v[184:187], v[156:159], v[108:111]
    ds_read_b128 v[168:171], v57 offset:6144
    v_mfma_f32_16x16x32_bf16 v[112:115], v[188:191], v[144:147], v[112:115]
    ds_read_b128 v[172:175], v57 offset:7168
    v_mfma_f32_16x16x32_bf16 v[116:119], v[188:191], v[148:151], v[116:119]
    v_mfma_f32_16x16x32_bf16 v[120:123], v[188:191], v[152:155], v[120:123]
    s_waitcnt lgkmcnt(0)
    s_add_u32 m0, s80, 5120
    s_nop 0
    buffer_load_dwordx4 v222, s[56:59], s81 offen lds
    s_add_u32 m0, s80, 6144
    s_add_u32 s7, s81, 73728
    buffer_load_dwordx4 v223, s[56:59], s7 offen lds
    s_add_u32 m0, s80, 7168
    s_add_u32 s7, s81, 147456
    buffer_load_dwordx4 v222, s[56:59], s7 offen lds
    s_add_u32 m0, s80, 8192
    s_add_u32 s7, s81, 221184
    buffer_load_dwordx4 v223, s[56:59], s7 offen lds
    s_add_u32 s81, s81, 294912
    s_add_u32 m0, s80, 9216
    s_nop 0
    buffer_load_dwordx4 v224, s[56:59], s82 offen lds
    s_add_u32 s82, s82, 294912
    v_mfma_f32_16x16x32_bf16 v[124:127], v[188:191], v[156:159], v[124:127]
    v_mfma_f32_16x16x32_bf16 v[128:131], v[192:195], v[144:147], v[128:131]
    v_mfma_f32_16x16x32_bf16 v[132:135], v[192:195], v[148:151], v[132:135]
    v_mfma_f32_16x16x32_bf16 v[136:139], v[192:195], v[152:155], v[136:139]
    v_mfma_f32_16x16x32_bf16 v[140:143], v[192:195], v[156:159], v[140:143]
    s_waitcnt lgkmcnt(0)
    s_waitcnt vmcnt(5)
    ds_read_b64_tr_b16 v[176:177], v216 offset:0
    v_mfma_f32_16x16x32_bf16 v[64:67], v[196:199], v[160:163], v[64:67]
    ds_read_b64_tr_b16 v[178:179], v216 offset:512
    v_mfma_f32_16x16x32_bf16 v[68:71], v[196:199], v[164:167], v[68:71]
    ds_read_b64_tr_b16 v[180:181], v217 offset:0
    v_mfma_f32_16x16x32_bf16 v[72:75], v[196:199], v[168:171], v[72:75]
    ds_read_b64_tr_b16 v[182:183], v217 offset:512
    v_mfma_f32_16x16x32_bf16 v[76:79], v[196:199], v[172:175], v[76:79]
    ds_read_b64_tr_b16 v[184:185], v218 offset:0
    v_mfma_f32_16x16x32_bf16 v[80:83], v[200:203], v[160:163], v[80:83]
    ds_read_b64_tr_b16 v[186:187], v218 offset:512
    v_mfma_f32_16x16x32_bf16 v[84:87], v[200:203], v[164:167], v[84:87]
    ds_read_b64_tr_b16 v[188:189], v219 offset:0
    v_mfma_f32_16x16x32_bf16 v[88:91], v[200:203], v[168:171], v[88:91]
    ds_read_b64_tr_b16 v[190:191], v219 offset:512
    v_mfma_f32_16x16x32_bf16 v[92:95], v[200:203], v[172:175], v[92:95]
    ds_read_b64_tr_b16 v[192:193], v220 offset:0
    v_mfma_f32_16x16x32_bf16 v[96:99], v[204:207], v[160:163], v[96:99]
    ds_read_b64_tr_b16 v[194:195], v221 offset:0
    v_mfma_f32_16x16x32_bf16 v[100:103], v[204:207], v[164:167], v[100:103]
    ds_read_b128 v[144:147], v56 offset:8192
    v_mfma_f32_16x16x32_bf16 v[104:107], v[204:207], v[168:171], v[104:107]
    ds_read_b128 v[148:151], v56 offset:9216
    v_mfma_f32_16x16x32_bf16 v[108:111], v[204:207], v[172:175], v[108:111]
    ds_read_b128 v[152:155], v56 offset:10240
    v_mfma_f32_16x16x32_bf16 v[112:115], v[208:211], v[160:163], v[112:115]
    ds_read_b128 v[156:159], v56 offset:11264
    v_mfma_f32_16x16x32_bf16 v[116:119], v[208:211], v[164:167], v[116:119]
    v_mfma_f32_16x16x32_bf16 v[120:123], v[208:211], v[168:171], v[120:123]
    s_waitcnt lgkmcnt(0)
    s_add_u32 m0, s80, 0
    s_nop 0
    buffer_load_dwordx4 v222, s[56:59], s81 offen lds
    s_add_u32 m0, s80, 1024
    s_add_u32 s7, s81, 73728
    buffer_load_dwordx4 v223, s[56:59], s7 offen lds
    s_add_u32 m0, s80, 2048
    s_add_u32 s7, s81, 147456
    buffer_load_dwordx4 v222, s[56:59], s7 offen lds
    s_add_u32 m0, s80, 3072
    s_add_u32 s7, s81, 221184
    buffer_load_dwordx4 v223, s[56:59], s7 offen lds
    s_add_u32 s81, s81, 294912
    s_add_u32 m0, s80, 4096
    s_nop 0
    buffer_load_dwordx4 v224, s[56:59], s82 offen lds
    s_add_u32 s82, s82, 294912
    v_mfma_f32_16x16x32_bf16 v[124:127], v[208:211], v[172:175], v[124:127]
    v_mfma_f32_16x16x32_bf16 v[128:131], v[212:215], v[160:163], v[128:131]
    v_mfma_f32_16x16x32_bf16 v[132:135], v[212:215], v[164:167], v[132:135]
    v_mfma_f32_16x16x32_bf16 v[136:139], v[212:215], v[168:171], v[136:139]
    v_mfma_f32_16x16x32_bf16 v[140:143], v[212:215], v[172:175], v[140:143]
    s_waitcnt lgkmcnt(0)
    v_add_u32 v56, 8192, v56
    v_add_u32 v57, 8192, v57
    s_sub_u32 s78, s78, 1
    s_cmp_lg_u32 s78, 1
    s_cbranch_scc1 L_hk_43
    v_and_b32 v2, 3, v1
    v_lshlrev_b32 v2, 6, v2
    v_add_u32 v63, 0, v2
    buffer_load_dword v62, v63, s[68:71], 0 offen sc1
L_hk_43:
    s_cmp_lg_u32 s78, 0
    s_cbranch_scc1 L_g1_42
    s_waitcnt vmcnt(5)
    ds_read_b64_tr_b16 v[196:197], v216 offset:5120
    v_mfma_f32_16x16x32_bf16 v[64:67], v[176:179], v[144:147], v[64:67]
    ds_read_b64_tr_b16 v[198:199], v216 offset:5632
    v_mfma_f32_16x16x32_bf16 v[68:71], v[176:179], v[148:151], v[68:71]
    ds_read_b64_tr_b16 v[200:201], v217 offset:5120
    v_mfma_f32_16x16x32_bf16 v[72:75], v[176:179], v[152:155], v[72:75]
    ds_read_b64_tr_b16 v[202:203], v217 offset:5632
    v_mfma_f32_16x16x32_bf16 v[76:79], v[176:179], v[156:159], v[76:79]
    ds_read_b64_tr_b16 v[204:205], v218 offset:5120
    v_mfma_f32_16x16x32_bf16 v[80:83], v[180:183], v[144:147], v[80:83]
    ds_read_b64_tr_b16 v[206:207], v218 offset:5632
    v_mfma_f32_16x16x32_bf16 v[84:87], v[180:183], v[148:151], v[84:87]
    ds_read_b64_tr_b16 v[208:209], v219 offset:5120
    v_mfma_f32_16x16x32_bf16 v[88:91], v[180:183], v[152:155], v[88:91]
    ds_read_b64_tr_b16 v[210:211], v219 offset:5632
    v_mfma_f32_16x16x32_bf16 v[92:95], v[180:183], v[156:159], v[92:95]
    ds_read_b64_tr_b16 v[212:213], v220 offset:5120
    v_mfma_f32_16x16x32_bf16 v[96:99], v[184:187], v[144:147], v[96:99]
    ds_read_b64_tr_b16 v[214:215], v221 offset:5120
    v_mfma_f32_16x16x32_bf16 v[100:103], v[184:187], v[148:151], v[100:103]
    ds_read_b128 v[160:163], v57 offset:4096
    v_mfma_f32_16x16x32_bf16 v[104:107], v[184:187], v[152:155], v[104:107]
    ds_read_b128 v[164:167], v57 offset:5120
    v_mfma_f32_16x16x32_bf16 v[108:111], v[184:187], v[156:159], v[108:111]
    ds_read_b128 v[168:171], v57 offset:6144
    v_mfma_f32_16x16x32_bf16 v[112:115], v[188:191], v[144:147], v[112:115]
    ds_read_b128 v[172:175], v57 offset:7168
    v_mfma_f32_16x16x32_bf16 v[116:119], v[188:191], v[148:151], v[116:119]
    v_mfma_f32_16x16x32_bf16 v[120:123], v[188:191], v[152:155], v[120:123]
    s_waitcnt lgkmcnt(0)
    s_add_u32 m0, s80, 5120
    s_nop 0
    buffer_load_dwordx4 v222, s[56:59], s81 offen lds
    s_add_u32 m0, s80, 6144
    s_add_u32 s7, s81, 73728
    buffer_load_dwordx4 v223, s[56:59], s7 offen lds
    s_add_u32 m0, s80, 7168
    s_add_u32 s7, s81, 147456
    buffer_load_dwordx4 v222, s[56:59], s7 offen lds
    s_add_u32 m0, s80, 8192
    s_add_u32 s7, s81, 221184
    buffer_load_dwordx4 v223, s[56:59], s7 offen lds
    s_add_u32 s81, s81, 294912
    s_add_u32 m0, s80, 9216
    s_nop 0
    buffer_load_dwordx4 v224, s[56:59], s82 offen lds
    s_add_u32 s82, s82, 294912
    v_mfma_f32_16x16x32_bf16 v[124:127], v[188:191], v[156:159], v[124:127]
    v_mfma_f32_16x16x32_bf16 v[128:131], v[192:195], v[144:147], v[128:131]
    v_mfma_f32_16x16x32_bf16 v[132:135], v[192:195], v[148:151], v[132:135]
    v_mfma_f32_16x16x32_bf16 v[136:139], v[192:195], v[152:155], v[136:139]
    v_mfma_f32_16x16x32_bf16 v[140:143], v[192:195], v[156:159], v[140:143]
    s_waitcnt lgkmcnt(0)
    s_waitcnt vmcnt(5)
    ds_read_b64_tr_b16 v[176:177], v216 offset:0
    v_mfma_f32_16x16x32_bf16 v[64:67], v[196:199], v[160:163], v[64:67]
    ds_read_b64_tr_b16 v[178:179], v216 offset:512
    v_mfma_f32_16x16x32_bf16 v[68:71], v[196:199], v[164:167], v[68:71]
    ds_read_b64_tr_b16 v[180:181], v217 offset:0
    v_mfma_f32_16x16x32_bf16 v[72:75], v[196:199], v[168:171], v[72:75]
    ds_read_b64_tr_b16 v[182:183], v217 offset:512
    v_mfma_f32_16x16x32_bf16 v[76:79], v[196:199], v[172:175], v[76:79]
    ds_read_b64_tr_b16 v[184:185], v218 offset:0
    v_mfma_f32_16x16x32_bf16 v[80:83], v[200:203], v[160:163], v[80:83]
    ds_read_b64_tr_b16 v[186:187], v218 offset:512
    v_mfma_f32_16x16x32_bf16 v[84:87], v[200:203], v[164:167], v[84:87]
    ds_read_b64_tr_b16 v[188:189], v219 offset:0
    v_mfma_f32_16x16x32_bf16 v[88:91], v[200:203], v[168:171], v[88:91]
    ds_read_b64_tr_b16 v[190:191], v219 offset:512
    v_mfma_f32_16x16x32_bf16 v[92:95], v[200:203], v[172:175], v[92:95]
    ds_read_b64_tr_b16 v[192:193], v220 offset:0
    v_mfma_f32_16x16x32_bf16 v[96:99], v[204:207], v[160:163], v[96:99]
    ds_read_b64_tr_b16 v[194:195], v221 offset:0
    v_mfma_f32_16x16x32_bf16 v[100:103], v[204:207], v[164:167], v[100:103]
    ds_read_b128 v[144:147], v56 offset:8192
    v_mfma_f32_16x16x32_bf16 v[104:107], v[204:207], v[168:171], v[104:107]
    ds_read_b128 v[148:151], v56 offset:9216
    v_mfma_f32_16x16x32_bf16 v[108:111], v[204:207], v[172:175], v[108:111]
    ds_read_b128 v[152:155], v56 offset:10240
    v_mfma_f32_16x16x32_bf16 v[112:115], v[208:211], v[160:163], v[112:115]
    ds_read_b128 v[156:159], v56 offset:11264
    v_mfma_f32_16x16x32_bf16 v[116:119], v[208:211], v[164:167], v[116:119]
    v_mfma_f32_16x16x32_bf16 v[120:123], v[208:211], v[168:171], v[120:123]
    v_mfma_f32_16x16x32_bf16 v[124:127], v[208:211], v[172:175], v[124:127]
    v_mfma_f32_16x16x32_bf16 v[128:131], v[212:215], v[160:163], v[128:131]
    v_mfma_f32_16x16x32_bf16 v[132:135], v[212:215], v[164:167], v[132:135]
    v_mfma_f32_16x16x32_bf16 v[136:139], v[212:215], v[168:171], v[136:139]
    v_mfma_f32_16x16x32_bf16 v[140:143], v[212:215], v[172:175], v[140:143]
    s_waitcnt lgkmcnt(0)
    v_add_u32 v56, 8192, v56
    v_add_u32 v57, 8192, v57
    s_waitcnt vmcnt(0)
    ds_read_b64_tr_b16 v[196:197], v216 offset:5120
    v_mfma_f32_16x16x32_bf16 v[64:67], v[176:179], v[144:147], v[64:67]
    ds_read_b64_tr_b16 v[198:199], v216 offset:5632
    v_mfma_f32_16x16x32_bf16 v[68:71], v[176:179], v[148:151], v[68:71]
    ds_read_b64_tr_b16 v[200:201], v217 offset:5120
    v_mfma_f32_16x16x32_bf16 v[72:75], v[176:179], v[152:155], v[72:75]
    ds_read_b64_tr_b16 v[202:203], v217 offset:5632
    v_mfma_f32_16x16x32_bf16 v[76:79], v[176:179], v[156:159], v[76:79]
    ds_read_b64_tr_b16 v[204:205], v218 offset:5120
    v_mfma_f32_16x16x32_bf16 v[80:83], v[180:183], v[144:147], v[80:83]
    ds_read_b64_tr_b16 v[206:207], v218 offset:5632
    v_mfma_f32_16x16x32_bf16 v[84:87], v[180:183], v[148:151], v[84:87]
    ds_read_b64_tr_b16 v[208:209], v219 offset:5120
    v_mfma_f32_16x16x32_bf16 v[88:91], v[180:183], v[152:155], v[88:91]
    ds_read_b64_tr_b16 v[210:211], v219 offset:5632
    v_mfma_f32_16x16x32_bf16 v[92:95], v[180:183], v[156:159], v[92:95]
    ds_read_b64_tr_b16 v[212:213], v220 offset:5120
    v_mfma_f32_16x16x32_bf16 v[96:99], v[184:187], v[144:147], v[96:99]
    ds_read_b64_tr_b16 v[214:215], v221 offset:5120
    v_mfma_f32_16x16x32_bf16 v[100:103], v[184:187], v[148:151], v[100:103]
    ds_read_b128 v[160:163], v57 offset:4096
    v_mfma_f32_16x16x32_bf16 v[104:107], v[184:187], v[152:155], v[104:107]
    ds_read_b128 v[164:167], v57 offset:5120
    v_mfma_f32_16x16x32_bf16 v[108:111], v[184:187], v[156:159], v[108:111]
    ds_read_b128 v[168:171], v57 offset:6144
    v_mfma_f32_16x16x32_bf16 v[112:115], v[188:191], v[144:147], v[112:115]
    ds_read_b128 v[172:175], v57 offset:7168
    v_mfma_f32_16x16x32_bf16 v[116:119], v[188:191], v[148:151], v[116:119]
    v_mfma_f32_16x16x32_bf16 v[120:123], v[188:191], v[152:155], v[120:123]
    v_mfma_f32_16x16x32_bf16 v[124:127], v[188:191], v[156:159], v[124:127]
    v_mfma_f32_16x16x32_bf16 v[128:131], v[192:195], v[144:147], v[128:131]
    v_mfma_f32_16x16x32_bf16 v[132:135], v[192:195], v[148:151], v[132:135]
    v_mfma_f32_16x16x32_bf16 v[136:139], v[192:195], v[152:155], v[136:139]
    v_mfma_f32_16x16x32_bf16 v[140:143], v[192:195], v[156:159], v[140:143]
    s_waitcnt lgkmcnt(0)
    v_mfma_f32_16x16x32_bf16 v[64:67], v[196:199], v[160:163], v[64:67]
    v_mfma_f32_16x16x32_bf16 v[68:71], v[196:199], v[164:167], v[68:71]
    v_mfma_f32_16x16x32_bf16 v[72:75], v[196:199], v[168:171], v[72:75]
    v_mfma_f32_16x16x32_bf16 v[76:79], v[196:199], v[172:175], v[76:79]
    v_mfma_f32_16x16x32_bf16 v[80:83], v[200:203], v[160:163], v[80:83]
    v_mfma_f32_16x16x32_bf16 v[84:87], v[200:203], v[164:167], v[84:87]
    v_mfma_f32_16x16x32_bf16 v[88:91], v[200:203], v[168:171], v[88:91]
    v_mfma_f32_16x16x32_bf16 v[92:95], v[200:203], v[172:175], v[92:95]
    v_mfma_f32_16x16x32_bf16 v[96:99], v[204:207], v[160:163], v[96:99]
    v_mfma_f32_16x16x32_bf16 v[100:103], v[204:207], v[164:167], v[100:103]
    v_mfma_f32_16x16x32_bf16 v[104:107], v[204:207], v[168:171], v[104:107]
    v_mfma_f32_16x16x32_bf16 v[108:111], v[204:207], v[172:175], v[108:111]
    v_mfma_f32_16x16x32_bf16 v[112:115], v[208:211], v[160:163], v[112:115]
    v_mfma_f32_16x16x32_bf16 v[116:119], v[208:211], v[164:167], v[116:119]
    v_mfma_f32_16x16x32_bf16 v[120:123], v[208:211], v[168:171], v[120:123]
    v_mfma_f32_16x16x32_bf16 v[124:127], v[208:211], v[172:175], v[124:127]
    v_mfma_f32_16x16x32_bf16 v[128:131], v[212:215], v[160:163], v[128:131]
    v_mfma_f32_16x16x32_bf16 v[132:135], v[212:215], v[164:167], v[132:135]
    v_mfma_f32_16x16x32_bf16 v[136:139], v[212:215], v[168:171], v[136:139]
    v_mfma_f32_16x16x32_bf16 v[140:143], v[212:215], v[172:175], v[140:143]
    s_waitcnt lgkmcnt(0)
    s_mov_b32 s6, 0
    v_cmp_gt_u32 vcc, 64, v62
    s_nop 4
    s_cbranch_vccz L_pc_done_45
    buffer_load_dword v62, v63, s[68:71], 0 offen sc1
L_pc_44:
    s_waitcnt vmcnt(0)
    v_cmp_gt_u32 vcc, 64, v62
    s_nop 4
    s_cbranch_vccz L_pc_done_45
    s_add_u32 s6, s6, 1
    s_cmp_gt_u32 s6, 2000000
    s_cbranch_scc1 L_pc_done_45
    s_sleep 2
    buffer_load_dword v62, v63, s[68:71], 0 offen sc1
    s_branch L_pc_44
L_pc_done_45:
    s_lshr_b32 s6, s2, 3
    s_and_b32 s6, s6, 15
    s_mul_i32 s6, s6, 5760
    s_add_u32 s6, s6, s77
    v_lshlrev_b32 v2, 7, v1
    v_cmp_gt_u32 vcc, 45, v1
    s_and_saveexec_b64 s[14:15], vcc
    buffer_load_dword v61, v2, s[52:55], s6 offen sc1
    s_mov_b64 exec, s[14:15]
    s_add_u32 s62, s77, 92160
    buffer_load_dwordx4 v[176:179], v58, s[60:63], s77 offen offset:0 sc1
    buffer_load_dwordx4 v[180:183], v58, s[60:63], s77 offen offset:1024 sc1
    buffer_load_dwordx4 v[184:187], v58, s[60:63], s77 offen offset:2048 sc1
    buffer_load_dwordx4 v[188:191], v58, s[60:63], s77 offen offset:3072 sc1
    s_add_u32 s77, s77, 4096
    buffer_load_dwordx4 v[192:195], v58, s[60:63], s77 offen offset:0 sc1
    buffer_load_dwordx4 v[196:199], v58, s[60:63], s77 offen offset:1024 sc1
    buffer_load_dwordx4 v[200:203], v58, s[60:63], s77 offen offset:2048 sc1
    buffer_load_dwordx4 v[204:207], v58, s[60:63], s77 offen offset:3072 sc1
    s_add_u32 s77, s77, 4096
    buffer_load_dwordx4 v[208:211], v58, s[60:63], s77 offen offset:0 sc1
    buffer_load_dwordx4 v[212:215], v58, s[60:63], s77 offen offset:1024 sc1
    buffer_load_dwordx4 v[216:219], v58, s[60:63], s77 offen offset:2048 sc1
    buffer_load_dwordx4 v[220:223], v58, s[60:63], s77 offen offset:3072 sc1
    s_add_u32 s77, s77, 4096
    buffer_load_dwordx4 v[224:227], v58, s[60:63], s77 offen offset:0 sc1
    buffer_load_dwordx4 v[228:231], v58, s[60:63], s77 offen offset:1024 sc1
    buffer_load_dwordx4 v[232:235], v58, s[60:63], s77 offen offset:2048 sc1
    s_add_u32 s77, s77, 3072
    v_mov_b32 v12, 0xbdd2d3e8
    s_mov_b32 s72, 2
    s_lshl_b32 s73, s72, 8
    s_lshr_b32 s6, s2, 2
    s_add_u32 s73, s73, s6
    s_mul_i32 s74, s72, 18560
    s_add_u32 s74, s74, 73728
    s_mul_i32 s75, s72, 4608
    s_add_u32 s75, s75, 147712
    s_lshl_b32 s6, s73, 12
    s_lshl_b32 s7, s5, 10
    s_add_u32 s6, s6, s7
    s_add_u32 s6, s6, 10616824
    v_lshlrev_b32 v2, 4, v1
    buffer_load_dwordx2 v[18:19], v2, s[52:55], s6 offen offset:0 sc1
    buffer_load_dwordx4 v[20:23], v2, s[52:55], s6 offen offset:8 sc1
    v_mul_f32 v8, v64, v64
    v_mul_f32 v9, v65, v65
    v_mul_f32 v10, v66, v66
    v_mul_f32 v11, v67, v67
    v_fmaak_f32 v8, v8, v12, 0xc0135761
    v_fmaak_f32 v9, v9, v12, 0xc0135761
    v_fmaak_f32 v10, v10, v12, 0xc0135761
    v_fmaak_f32 v11, v11, v12, 0xc0135761
    v_mul_f32 v8, v64, v8
    v_mul_f32 v9, v65, v9
    v_mul_f32 v10, v66, v10
    v_mul_f32 v11, v67, v11
    v_exp_f32 v8, v8
    v_exp_f32 v9, v9
    v_exp_f32 v10, v10
    v_exp_f32 v11, v11
    v_add_f32 v8, 1.0, v8
    v_add_f32 v9, 1.0, v9
    v_add_f32 v10, 1.0, v10
    v_add_f32 v11, 1.0, v11
    v_rcp_f32 v8, v8
    v_rcp_f32 v9, v9
    v_rcp_f32 v10, v10
    v_rcp_f32 v11, v11
    v_mul_f32 v64, v64, v8
    v_mul_f32 v65, v65, v9
    v_mul_f32 v66, v66, v10
    v_mul_f32 v67, v67, v11
    v_cvt_pk_bf16_f32 v64, v64, v65
    v_cvt_pk_bf16_f32 v65, v66, v67
    v_mul_f32 v8, v80, v80
    v_mul_f32 v9, v81, v81
    v_mul_f32 v10, v82, v82
    v_mul_f32 v11, v83, v83
    v_fmaak_f32 v8, v8, v12, 0xc0135761
    v_fmaak_f32 v9, v9, v12, 0xc0135761
    v_fmaak_f32 v10, v10, v12, 0xc0135761
    v_fmaak_f32 v11, v11, v12, 0xc0135761
    v_mul_f32 v8, v80, v8
    v_mul_f32 v9, v81, v9
    v_mul_f32 v10, v82, v10
    v_mul_f32 v11, v83, v11
    v_exp_f32 v8, v8
    v_exp_f32 v9, v9
    v_exp_f32 v10, v10
    v_exp_f32 v11, v11
    v_add_f32 v8, 1.0, v8
    v_add_f32 v9, 1.0, v9
    v_add_f32 v10, 1.0, v10
    v_add_f32 v11, 1.0, v11
    v_rcp_f32 v8, v8
    v_rcp_f32 v9, v9
    v_rcp_f32 v10, v10
    v_rcp_f32 v11, v11
    v_mul_f32 v80, v80, v8
    v_mul_f32 v81, v81, v9
    v_mul_f32 v82, v82, v10
    v_mul_f32 v83, v83, v11
    v_cvt_pk_bf16_f32 v66, v80, v81
    v_cvt_pk_bf16_f32 v67, v82, v83
    v_mul_f32 v8, v68, v68
    v_mul_f32 v9, v69, v69
    v_mul_f32 v10, v70, v70
    v_mul_f32 v11, v71, v71
    v_fmaak_f32 v8, v8, v12, 0xc0135761
    v_fmaak_f32 v9, v9, v12, 0xc0135761
    v_fmaak_f32 v10, v10, v12, 0xc0135761
    v_fmaak_f32 v11, v11, v12, 0xc0135761
    v_mul_f32 v8, v68, v8
    v_mul_f32 v9, v69, v9
    v_mul_f32 v10, v70, v10
    v_mul_f32 v11, v71, v11
    v_exp_f32 v8, v8
    v_exp_f32 v9, v9
    v_exp_f32 v10, v10
    v_exp_f32 v11, v11
    v_add_f32 v8, 1.0, v8
    v_add_f32 v9, 1.0, v9
    v_add_f32 v10, 1.0, v10
    v_add_f32 v11, 1.0, v11
    v_rcp_f32 v8, v8
    v_rcp_f32 v9, v9
    v_rcp_f32 v10, v10
    v_rcp_f32 v11, v11
    v_mul_f32 v68, v68, v8
    v_mul_f32 v69, v69, v9
    v_mul_f32 v70, v70, v10
    v_mul_f32 v71, v71, v11
    v_cvt_pk_bf16_f32 v68, v68, v69
    v_cvt_pk_bf16_f32 v69, v70, v71
    v_mul_f32 v8, v84, v84
    v_mul_f32 v9, v85, v85
    v_mul_f32 v10, v86, v86
    v_mul_f32 v11, v87, v87
    v_fmaak_f32 v8, v8, v12, 0xc0135761
    v_fmaak_f32 v9, v9, v12, 0xc0135761
    v_fmaak_f32 v10, v10, v12, 0xc0135761
    v_fmaak_f32 v11, v11, v12, 0xc0135761
    v_mul_f32 v8, v84, v8
    v_mul_f32 v9, v85, v9
    v_mul_f32 v10, v86, v10
    v_mul_f32 v11, v87, v11
    v_exp_f32 v8, v8
    v_exp_f32 v9, v9
    v_exp_f32 v10, v10
    v_exp_f32 v11, v11
    v_add_f32 v8, 1.0, v8
    v_add_f32 v9, 1.0, v9
    v_add_f32 v10, 1.0, v10
    v_add_f32 v11, 1.0, v11
    v_rcp_f32 v8, v8
    v_rcp_f32 v9, v9
    v_rcp_f32 v10, v10
    v_rcp_f32 v11, v11
    v_mul_f32 v84, v84, v8
    v_mul_f32 v85, v85, v9
    v_mul_f32 v86, v86, v10
    v_mul_f32 v87, v87, v11
    v_cvt_pk_bf16_f32 v70, v84, v85
    v_cvt_pk_bf16_f32 v71, v86, v87
    v_mul_f32 v8, v72, v72
    v_mul_f32 v9, v73, v73
    v_mul_f32 v10, v74, v74
    v_mul_f32 v11, v75, v75
    v_fmaak_f32 v8, v8, v12, 0xc0135761
    v_fmaak_f32 v9, v9, v12, 0xc0135761
    v_fmaak_f32 v10, v10, v12, 0xc0135761
    v_fmaak_f32 v11, v11, v12, 0xc0135761
    v_mul_f32 v8, v72, v8
    v_mul_f32 v9, v73, v9
    v_mul_f32 v10, v74, v10
    v_mul_f32 v11, v75, v11
    v_exp_f32 v8, v8
    v_exp_f32 v9, v9
    v_exp_f32 v10, v10
    v_exp_f32 v11, v11
    v_add_f32 v8, 1.0, v8
    v_add_f32 v9, 1.0, v9
    v_add_f32 v10, 1.0, v10
    v_add_f32 v11, 1.0, v11
    v_rcp_f32 v8, v8
    v_rcp_f32 v9, v9
    v_rcp_f32 v10, v10
    v_rcp_f32 v11, v11
    v_mul_f32 v72, v72, v8
    v_mul_f32 v73, v73, v9
    v_mul_f32 v74, v74, v10
    v_mul_f32 v75, v75, v11
    v_cvt_pk_bf16_f32 v72, v72, v73
    v_cvt_pk_bf16_f32 v73, v74, v75
    v_mul_f32 v8, v88, v88
    v_mul_f32 v9, v89, v89
    v_mul_f32 v10, v90, v90
    v_mul_f32 v11, v91, v91
    v_fmaak_f32 v8, v8, v12, 0xc0135761
    v_fmaak_f32 v9, v9, v12, 0xc0135761
    v_fmaak_f32 v10, v10, v12, 0xc0135761
    v_fmaak_f32 v11, v11, v12, 0xc0135761
    v_mul_f32 v8, v88, v8
    v_mul_f32 v9, v89, v9
    v_mul_f32 v10, v90, v10
    v_mul_f32 v11, v91, v11
    v_exp_f32 v8, v8
    v_exp_f32 v9, v9
    v_exp_f32 v10, v10
    v_exp_f32 v11, v11
    v_add_f32 v8, 1.0, v8
    v_add_f32 v9, 1.0, v9
    v_add_f32 v10, 1.0, v10
    v_add_f32 v11, 1.0, v11
    v_rcp_f32 v8, v8
    v_rcp_f32 v9, v9
    v_rcp_f32 v10, v10
    v_rcp_f32 v11, v11
    v_mul_f32 v88, v88, v8
    v_mul_f32 v89, v89, v9
    v_mul_f32 v90, v90, v10
    v_mul_f32 v91, v91, v11
    v_cvt_pk_bf16_f32 v74, v88, v89
    v_cvt_pk_bf16_f32 v75, v90, v91
    v_mul_f32 v8, v76, v76
    v_mul_f32 v9, v77, v77
    v_mul_f32 v10, v78, v78
    v_mul_f32 v11, v79, v79
    v_fmaak_f32 v8, v8, v12, 0xc0135761
    v_fmaak_f32 v9, v9, v12, 0xc0135761
    v_fmaak_f32 v10, v10, v12, 0xc0135761
    v_fmaak_f32 v11, v11, v12, 0xc0135761
    v_mul_f32 v8, v76, v8
    v_mul_f32 v9, v77, v9
    v_mul_f32 v10, v78, v10
    v_mul_f32 v11, v79, v11
    v_exp_f32 v8, v8
    v_exp_f32 v9, v9
    v_exp_f32 v10, v10
    v_exp_f32 v11, v11
    v_add_f32 v8, 1.0, v8
    v_add_f32 v9, 1.0, v9
    v_add_f32 v10, 1.0, v10
    v_add_f32 v11, 1.0, v11
    v_rcp_f32 v8, v8
    v_rcp_f32 v9, v9
    v_rcp_f32 v10, v10
    v_rcp_f32 v11, v11
    v_mul_f32 v76, v76, v8
    v_mul_f32 v77, v77, v9
    v_mul_f32 v78, v78, v10
    v_mul_f32 v79, v79, v11
    v_cvt_pk_bf16_f32 v76, v76, v77
    v_cvt_pk_bf16_f32 v77, v78, v79
    v_mul_f32 v8, v92, v92
    v_mul_f32 v9, v93, v93
    v_mul_f32 v10, v94, v94
    v_mul_f32 v11, v95, v95
    v_fmaak_f32 v8, v8, v12, 0xc0135761
    v_fmaak_f32 v9, v9, v12, 0xc0135761
    v_fmaak_f32 v10, v10, v12, 0xc0135761
    v_fmaak_f32 v11, v11, v12, 0xc0135761
    v_mul_f32 v8, v92, v8
    v_mul_f32 v9, v93, v9
    v_mul_f32 v10, v94, v10
    v_mul_f32 v11, v95, v11
    v_exp_f32 v8, v8
    v_exp_f32 v9, v9
    v_exp_f32 v10, v10
    v_exp_f32 v11, v11
    v_add_f32 v8, 1.0, v8
    v_add_f32 v9, 1.0, v9
    v_add_f32 v10, 1.0, v10
    v_add_f32 v11, 1.0, v11
    v_rcp_f32 v8, v8
    v_rcp_f32 v9, v9
    v_rcp_f32 v10, v10
    v_rcp_f32 v11, v11
    v_mul_f32 v92, v92, v8
    v_mul_f32 v93, v93, v9
    v_mul_f32 v94, v94, v10
    v_mul_f32 v95, v95, v11
    v_cvt_pk_bf16_f32 v78, v92, v93
    v_cvt_pk_bf16_f32 v79, v94, v95
    v_mul_f32 v8, v96, v96
    v_mul_f32 v9, v97, v97
    v_mul_f32 v10, v98, v98
    v_mul_f32 v11, v99, v99
    v_fmaak_f32 v8, v8, v12, 0xc0135761
    v_fmaak_f32 v9, v9, v12, 0xc0135761
    v_fmaak_f32 v10, v10, v12, 0xc0135761
    v_fmaak_f32 v11, v11, v12, 0xc0135761
    v_mul_f32 v8, v96, v8
    v_mul_f32 v9, v97, v9
    v_mul_f32 v10, v98, v10
    v_mul_f32 v11, v99, v11
    v_exp_f32 v8, v8
    v_exp_f32 v9, v9
    v_exp_f32 v10, v10
    v_exp_f32 v11, v11
    v_add_f32 v8, 1.0, v8
    v_add_f32 v9, 1.0, v9
    v_add_f32 v10, 1.0, v10
    v_add_f32 v11, 1.0, v11
    v_rcp_f32 v8, v8
    v_rcp_f32 v9, v9
    v_rcp_f32 v10, v10
    v_rcp_f32 v11, v11
    v_mul_f32 v96, v96, v8
    v_mul_f32 v97, v97, v9
    v_mul_f32 v98, v98, v10
    v_mul_f32 v99, v99, v11
    v_cvt_pk_bf16_f32 v96, v96, v97
    v_cvt_pk_bf16_f32 v97, v98, v99
    v_mul_f32 v8, v112, v112
    v_mul_f32 v9, v113, v113
    v_mul_f32 v10, v114, v114
    v_mul_f32 v11, v115, v115
    v_fmaak_f32 v8, v8, v12, 0xc0135761
    v_fmaak_f32 v9, v9, v12, 0xc0135761
    v_fmaak_f32 v10, v10, v12, 0xc0135761
    v_fmaak_f32 v11, v11, v12, 0xc0135761
    v_mul_f32 v8, v112, v8
    v_mul_f32 v9, v113, v9
    v_mul_f32 v10, v114, v10
    v_mul_f32 v11, v115, v11
    v_exp_f32 v8, v8
    v_exp_f32 v9, v9
    v_exp_f32 v10, v10
    v_exp_f32 v11, v11
    v_add_f32 v8, 1.0, v8
    v_add_f32 v9, 1.0, v9
    v_add_f32 v10, 1.0, v10
    v_add_f32 v11, 1.0, v11
    v_rcp_f32 v8, v8
    v_rcp_f32 v9, v9
    v_rcp_f32 v10, v10
    v_rcp_f32 v11, v11
    v_mul_f32 v112, v112, v8
    v_mul_f32 v113, v113, v9
    v_mul_f32 v114, v114, v10
    v_mul_f32 v115, v115, v11
    v_cvt_pk_bf16_f32 v98, v112, v113
    v_cvt_pk_bf16_f32 v99, v114, v115
    v_mul_f32 v8, v100, v100
    v_mul_f32 v9, v101, v101
    v_mul_f32 v10, v102, v102
    v_mul_f32 v11, v103, v103
    v_fmaak_f32 v8, v8, v12, 0xc0135761
    v_fmaak_f32 v9, v9, v12, 0xc0135761
    v_fmaak_f32 v10, v10, v12, 0xc0135761
    v_fmaak_f32 v11, v11, v12, 0xc0135761
    v_mul_f32 v8, v100, v8
    v_mul_f32 v9, v101, v9
    v_mul_f32 v10, v102, v10
    v_mul_f32 v11, v103, v11
    v_exp_f32 v8, v8
    v_exp_f32 v9, v9
    v_exp_f32 v10, v10
    v_exp_f32 v11, v11
    v_add_f32 v8, 1.0, v8
    v_add_f32 v9, 1.0, v9
    v_add_f32 v10, 1.0, v10
    v_add_f32 v11, 1.0, v11
    v_rcp_f32 v8, v8
    v_rcp_f32 v9, v9
    v_rcp_f32 v10, v10
    v_rcp_f32 v11, v11
    v_mul_f32 v100, v100, v8
    v_mul_f32 v101, v101, v9
    v_mul_f32 v102, v102, v10
    v_mul_f32 v103, v103, v11
    v_cvt_pk_bf16_f32 v100, v100, v101
    v_cvt_pk_bf16_f32 v101, v102, v103
    v_mul_f32 v8, v116, v116
    v_mul_f32 v9, v117, v117
    v_mul_f32 v10, v118, v118
    v_mul_f32 v11, v119, v119
    v_fmaak_f32 v8, v8, v12, 0xc0135761
    v_fmaak_f32 v9, v9, v12, 0xc0135761
    v_fmaak_f32 v10, v10, v12, 0xc0135761
    v_fmaak_f32 v11, v11, v12, 0xc0135761
    v_mul_f32 v8, v116, v8
    v_mul_f32 v9, v117, v9
    v_mul_f32 v10, v118, v10
    v_mul_f32 v11, v119, v11
    v_exp_f32 v8, v8
    v_exp_f32 v9, v9
    v_exp_f32 v10, v10
    v_exp_f32 v11, v11
    v_add_f32 v8, 1.0, v8
    v_add_f32 v9, 1.0, v9
    v_add_f32 v10, 1.0, v10
    v_add_f32 v11, 1.0, v11
    v_rcp_f32 v8, v8
    v_rcp_f32 v9, v9
    v_rcp_f32 v10, v10
    v_rcp_f32 v11, v11
    v_mul_f32 v116, v116, v8
    v_mul_f32 v117, v117, v9
    v_mul_f32 v118, v118, v10
    v_mul_f32 v119, v119, v11
    v_cvt_pk_bf16_f32 v102, v116, v117
    v_cvt_pk_bf16_f32 v103, v118, v119
    v_mul_f32 v8, v104, v104
    v_mul_f32 v9, v105, v105
    v_mul_f32 v10, v106, v106
    v_mul_f32 v11, v107, v107
    v_fmaak_f32 v8, v8, v12, 0xc0135761
    v_fmaak_f32 v9, v9, v12, 0xc0135761
    v_fmaak_f32 v10, v10, v12, 0xc0135761
    v_fmaak_f32 v11, v11, v12, 0xc0135761
    v_mul_f32 v8, v104, v8
    v_mul_f32 v9, v105, v9
    v_mul_f32 v10, v106, v10
    v_mul_f32 v11, v107, v11
    v_exp_f32 v8, v8
    v_exp_f32 v9, v9
    v_exp_f32 v10, v10
    v_exp_f32 v11, v11
    v_add_f32 v8, 1.0, v8
    v_add_f32 v9, 1.0, v9
    v_add_f32 v10, 1.0, v10
    v_add_f32 v11, 1.0, v11
    v_rcp_f32 v8, v8
    v_rcp_f32 v9, v9
    v_rcp_f32 v10, v10
    v_rcp_f32 v11, v11
    v_mul_f32 v104, v104, v8
    v_mul_f32 v105, v105, v9
    v_mul_f32 v106, v106, v10
    v_mul_f32 v107, v107, v11
    v_cvt_pk_bf16_f32 v104, v104, v105
    v_cvt_pk_bf16_f32 v105, v106, v107
    v_mul_f32 v8, v120, v120
    v_mul_f32 v9, v121, v121
    v_mul_f32 v10, v122, v122
    v_mul_f32 v11, v123, v123
    v_fmaak_f32 v8, v8, v12, 0xc0135761
    v_fmaak_f32 v9, v9, v12, 0xc0135761
    v_fmaak_f32 v10, v10, v12, 0xc0135761
    v_fmaak_f32 v11, v11, v12, 0xc0135761
    v_mul_f32 v8, v120, v8
    v_mul_f32 v9, v121, v9
    v_mul_f32 v10, v122, v10
    v_mul_f32 v11, v123, v11
    v_exp_f32 v8, v8
    v_exp_f32 v9, v9
    v_exp_f32 v10, v10
    v_exp_f32 v11, v11
    v_add_f32 v8, 1.0, v8
    v_add_f32 v9, 1.0, v9
    v_add_f32 v10, 1.0, v10
    v_add_f32 v11, 1.0, v11
    v_rcp_f32 v8, v8
    v_rcp_f32 v9, v9
    v_rcp_f32 v10, v10
    v_rcp_f32 v11, v11
    v_mul_f32 v120, v120, v8
    v_mul_f32 v121, v121, v9
    v_mul_f32 v122, v122, v10
    v_mul_f32 v123, v123, v11
    v_cvt_pk_bf16_f32 v106, v120, v121
    v_cvt_pk_bf16_f32 v107, v122, v123
    v_mul_f32 v8, v108, v108
    v_mul_f32 v9, v109, v109
    v_mul_f32 v10, v110, v110
    v_mul_f32 v11, v111, v111
    v_fmaak_f32 v8, v8, v12, 0xc0135761
    v_fmaak_f32 v9, v9, v12, 0xc0135761
    v_fmaak_f32 v10, v10, v12, 0xc0135761
    v_fmaak_f32 v11, v11, v12, 0xc0135761
    v_mul_f32 v8, v108, v8
    v_mul_f32 v9, v109, v9
    v_mul_f32 v10, v110, v10
    v_mul_f32 v11, v111, v11
    v_exp_f32 v8, v8
    v_exp_f32 v9, v9
    v_exp_f32 v10, v10
    v_exp_f32 v11, v11
    v_add_f32 v8, 1.0, v8
    v_add_f32 v9, 1.0, v9
    v_add_f32 v10, 1.0, v10
    v_add_f32 v11, 1.0, v11
    v_rcp_f32 v8, v8
    v_rcp_f32 v9, v9
    v_rcp_f32 v10, v10
    v_rcp_f32 v11, v11
    v_mul_f32 v108, v108, v8
    v_mul_f32 v109, v109, v9
    v_mul_f32 v110, v110, v10
    v_mul_f32 v111, v111, v11
    v_cvt_pk_bf16_f32 v108, v108, v109
    v_cvt_pk_bf16_f32 v109, v110, v111
    v_mul_f32 v8, v124, v124
    v_mul_f32 v9, v125, v125
    v_mul_f32 v10, v126, v126
    v_mul_f32 v11, v127, v127
    v_fmaak_f32 v8, v8, v12, 0xc0135761
    v_fmaak_f32 v9, v9, v12, 0xc0135761
    v_fmaak_f32 v10, v10, v12, 0xc0135761
    v_fmaak_f32 v11, v11, v12, 0xc0135761
    v_mul_f32 v8, v124, v8
    v_mul_f32 v9, v125, v9
    v_mul_f32 v10, v126, v10
    v_mul_f32 v11, v127, v11
    v_exp_f32 v8, v8
    v_exp_f32 v9, v9
    v_exp_f32 v10, v10
    v_exp_f32 v11, v11
    v_add_f32 v8, 1.0, v8
    v_add_f32 v9, 1.0, v9
    v_add_f32 v10, 1.0, v10
    v_add_f32 v11, 1.0, v11
    v_rcp_f32 v8, v8
    v_rcp_f32 v9, v9
    v_rcp_f32 v10, v10
    v_rcp_f32 v11, v11
    v_mul_f32 v124, v124, v8
    v_mul_f32 v125, v125, v9
    v_mul_f32 v126, v126, v10
    v_mul_f32 v127, v127, v11
    v_cvt_pk_bf16_f32 v110, v124, v125
    v_cvt_pk_bf16_f32 v111, v126, v127
    v_mul_f32 v8, v128, v128
    v_mul_f32 v9, v129, v129
    v_mul_f32 v10, v130, v130
    v_mul_f32 v11, v131, v131
    v_fmaak_f32 v8, v8, v12, 0xc0135761
    v_fmaak_f32 v9, v9, v12, 0xc0135761
    v_fmaak_f32 v10, v10, v12, 0xc0135761
    v_fmaak_f32 v11, v11, v12, 0xc0135761
    v_mul_f32 v8, v128, v8
    v_mul_f32 v9, v129, v9
    v_mul_f32 v10, v130, v10
    v_mul_f32 v11, v131, v11
    v_exp_f32 v8, v8
    v_exp_f32 v9, v9
    v_exp_f32 v10, v10
    v_exp_f32 v11, v11
    v_add_f32 v8, 1.0, v8
    v_add_f32 v9, 1.0, v9
    v_add_f32 v10, 1.0, v10
    v_add_f32 v11, 1.0, v11
    v_rcp_f32 v8, v8
    v_rcp_f32 v9, v9
    v_rcp_f32 v10, v10
    v_rcp_f32 v11, v11
    v_mul_f32 v128, v128, v8
    v_mul_f32 v129, v129, v9
    v_mul_f32 v130, v130, v10
    v_mul_f32 v131, v131, v11
    v_cvt_pk_bf16_f32 v128, v128, v129
    v_cvt_pk_bf16_f32 v129, v130, v131
    v_mul_f32 v8, v132, v132
    v_mul_f32 v9, v133, v133
    v_mul_f32 v10, v134, v134
    v_mul_f32 v11, v135, v135
    v_fmaak_f32 v8, v8, v12, 0xc0135761
    v_fmaak_f32 v9, v9, v12, 0xc0135761
    v_fmaak_f32 v10, v10, v12, 0xc0135761
    v_fmaak_f32 v11, v11, v12, 0xc0135761
    v_mul_f32 v8, v132, v8
    v_mul_f32 v9, v133, v9
    v_mul_f32 v10, v134, v10
    v_mul_f32 v11, v135, v11
    v_exp_f32 v8, v8
    v_exp_f32 v9, v9
    v_exp_f32 v10, v10
    v_exp_f32 v11, v11
    v_add_f32 v8, 1.0, v8
    v_add_f32 v9, 1.0, v9
    v_add_f32 v10, 1.0, v10
    v_add_f32 v11, 1.0, v11
    v_rcp_f32 v8, v8
    v_rcp_f32 v9, v9
    v_rcp_f32 v10, v10
    v_rcp_f32 v11, v11
    v_mul_f32 v132, v132, v8
    v_mul_f32 v133, v133, v9
    v_mul_f32 v134, v134, v10
    v_mul_f32 v135, v135, v11
    v_cvt_pk_bf16_f32 v132, v132, v133
    v_cvt_pk_bf16_f32 v133, v134, v135
    v_mul_f32 v8, v136, v136
    v_mul_f32 v9, v137, v137
    v_mul_f32 v10, v138, v138
    v_mul_f32 v11, v139, v139
    v_fmaak_f32 v8, v8, v12, 0xc0135761
    v_fmaak_f32 v9, v9, v12, 0xc0135761
    v_fmaak_f32 v10, v10, v12, 0xc0135761
    v_fmaak_f32 v11, v11, v12, 0xc0135761
    v_mul_f32 v8, v136, v8
    v_mul_f32 v9, v137, v9
    v_mul_f32 v10, v138, v10
    v_mul_f32 v11, v139, v11
    v_exp_f32 v8, v8
    v_exp_f32 v9, v9
    v_exp_f32 v10, v10
    v_exp_f32 v11, v11
    v_add_f32 v8, 1.0, v8
    v_add_f32 v9, 1.0, v9
    v_add_f32 v10, 1.0, v10
    v_add_f32 v11, 1.0, v11
    v_rcp_f32 v8, v8
    v_rcp_f32 v9, v9
    v_rcp_f32 v10, v10
    v_rcp_f32 v11, v11
    v_mul_f32 v136, v136, v8
    v_mul_f32 v137, v137, v9
    v_mul_f32 v138, v138, v10
    v_mul_f32 v139, v139, v11
    v_cvt_pk_bf16_f32 v136, v136, v137
    v_cvt_pk_bf16_f32 v137, v138, v139
    v_mul_f32 v8, v140, v140
    v_mul_f32 v9, v141, v141
    v_mul_f32 v10, v142, v142
    v_mul_f32 v11, v143, v143
    v_fmaak_f32 v8, v8, v12, 0xc0135761
    v_fmaak_f32 v9, v9, v12, 0xc0135761
    v_fmaak_f32 v10, v10, v12, 0xc0135761
    v_fmaak_f32 v11, v11, v12, 0xc0135761
    v_mul_f32 v8, v140, v8
    v_mul_f32 v9, v141, v9
    v_mul_f32 v10, v142, v10
    v_mul_f32 v11, v143, v11
    v_exp_f32 v8, v8
    v_exp_f32 v9, v9
    v_exp_f32 v10, v10
    v_exp_f32 v11, v11
    v_add_f32 v8, 1.0, v8
    v_add_f32 v9, 1.0, v9
    v_add_f32 v10, 1.0, v10
    v_add_f32 v11, 1.0, v11
    v_rcp_f32 v8, v8
    v_rcp_f32 v9, v9
    v_rcp_f32 v10, v10
    v_rcp_f32 v11, v11
    v_mul_f32 v140, v140, v8
    v_mul_f32 v141, v141, v9
    v_mul_f32 v142, v142, v10
    v_mul_f32 v143, v143, v11
    v_cvt_pk_bf16_f32 v140, v140, v141
    v_cvt_pk_bf16_f32 v141, v142, v143
    s_barrier
    s_lshl_b32 s6, s5, 13
    v_add_u32 v2, s6, v58
    ds_write_b128 v2, v[64:67] offset:0
    ds_write_b128 v2, v[68:71] offset:1024
    ds_write_b128 v2, v[72:75] offset:2048
    ds_write_b128 v2, v[76:79] offset:3072
    ds_write_b128 v2, v[96:99] offset:4096
    ds_write_b128 v2, v[100:103] offset:5120
    ds_write_b128 v2, v[104:107] offset:6144
    ds_write_b128 v2, v[108:111] offset:7168
    s_lshr_b32 s7, s5, 1
    s_lshl_b32 s7, s7, 12
    s_and_b32 s6, s5, 1
    s_lshl_b32 s6, s6, 3
    s_add_u32 s6, s6, s7
    s_add_u32 s6, s6, 65536
    v_add_u32 v2, s6, v58
    ds_write_b64 v2, v[128:129] offset:0
    ds_write_b64 v2, v[132:133] offset:1024
    ds_write_b64 v2, v[136:137] offset:2048
    ds_write_b64 v2, v[140:141] offset:3072
    s_waitcnt vmcnt(0)
    s_lshl_b32 s6, s5, 10
    s_add_u32 s6, s6, s74
    s_add_u32 s6, s6, 384
    v_lshl_add_u32 v2, v1, 4, s6
    s_cmp_lg_u32 s5, 0
    s_cbranch_scc1 L_ub_nz_46
    v_cmp_eq_u32 vcc, 0, v1
    s_nop 1
    v_cndmask_b32 v18, v18, 0, vcc
    v_cndmask_b32 v19, v19, 0, vcc
    v_mov_b32 v128, 0
    v_mov_b32 v129, 0
    v_mov_b32 v130, 0
    v_mov_b32 v131, 0
    v_lshlrev_b32 v3, 4, v1
    v_add_u32 v3, s74, v3
    v_cmp_gt_u32 vcc, 24, v1
    s_and_saveexec_b64 s[14:15], vcc
    ds_write_b128 v3, v[128:131] offset:0
    ds_write_b128 v3, v[128:131] offset:4640
    ds_write_b128 v3, v[128:131] offset:9280
    ds_write_b128 v3, v[128:131] offset:13920
    s_mov_b64 exec, s[14:15]
L_ub_nz_46:
    v_alignbyte_b32 v128, v19, v18, 2
    v_alignbyte_b32 v129, v20, v19, 2
    v_alignbyte_b32 v130, v21, v20, 2
    v_alignbyte_b32 v131, v22, v21, 2
    v_mov_b32 v136, v129
    v_mov_b32 v137, v130
    v_mov_b32 v138, v131
    v_alignbyte_b32 v139, v23, v22, 2
    v_mov_b32 v132, v19
    v_mov_b32 v133, v20
    v_mov_b32 v134, v21
    v_mov_b32 v135, v22
    ds_write_b128 v2, v[128:131] offset:0
    ds_write_b128 v2, v[132:135] offset:4640
    ds_write_b128 v2, v[136:139] offset:9280
    ds_write_b128 v2, v[20:23] offset:13920
    s_mov_b32 s76, 163660
    s_waitcnt lgkmcnt(0)
    v_mov_b32 v2, s76
    v_mov_b32 v3, 1
    s_mov_b64 s[14:15], exec
    s_mov_b64 exec, 1
    ds_add_u32 v2, v3
    s_mov_b64 exec, s[14:15]
    s_mov_b32 s6, 0
L_ls_47:
    ds_read_b32 v3, v2
    s_add_u32 s6, s6, 1
    s_cmp_gt_u32 s6, 4000000
    s_cbranch_scc1 L_ls_done_48
    s_waitcnt lgkmcnt(0)
    v_readfirstlane_b32 s7, v3
    s_cmp_ge_u32 s7, 4
    s_cbranch_scc1 L_ls_done_48
    s_branch L_ls_47
L_ls_done_48:
    s_and_b32 s76, s2, 3
    s_cmp_eq_u32 s76, 1
    s_cbranch_scc1 L_q1_51
    s_cmp_eq_u32 s76, 2
    s_cbranch_scc1 L_q2_52
    s_cmp_eq_u32 s76, 3
    s_cbranch_scc1 L_q3_53
L_q0_50:
    v_and_b32 v2, 15, v1
    v_lshrrev_b32 v3, 4, v1
    v_and_b32 v4, 3, v2
    v_lshrrev_b32 v5, 2, v2
    v_mul_u32_u24 v4, 4640, v4
    v_lshl_add_u32 v4, v5, 7, v4
    v_lshl_add_u32 v4, v3, 4, v4
    s_add_u32 s6, s74, 448
    v_add_u32 v40, s6, v4
    v_lshlrev_b32 v4, 4, v3
    v_lshlrev_b32 v5, 3, v2
    v_sub_u32 v4, v4, v5
    s_add_u32 s6, s75, 568
    v_add_u32 v41, s6, v4
    s_sub_u32 s6, s5, 0
    s_lshl_b32 s6, s6, 7
    v_subrev_u32 v40, s6, v40
    v_subrev_u32 v41, s6, v41
    v_mov_b32 v160, 0
    v_mov_b32 v161, 0
    v_mov_b32 v162, 0
    v_mov_b32 v163, 0
    v_mov_b32 v164, 0
    v_mov_b32 v165, 0
    v_mov_b32 v166, 0
    v_mov_b32 v167, 0
    ds_read_b64 v[8:9], v41 offset:3584
    ds_read_b64 v[10:11], v41 offset:3592
    ds_read_b128 v[64:67], v40 offset:0
    ds_read_b128 v[92:95], v40 offset:3584
    ds_read_b64 v[12:13], v41 offset:3072
    ds_read_b64 v[14:15], v41 offset:3080
    ds_read_b128 v[88:91], v40 offset:3072
    ds_read_b64 v[16:17], v41 offset:2560
    ds_read_b64 v[18:19], v41 offset:2568
    ds_read_b128 v[84:87], v40 offset:2560
    ds_read_b64 v[20:21], v41 offset:2048
    ds_read_b64 v[22:23], v41 offset:2056
    ds_read_b128 v[80:83], v40 offset:2048
    ds_read_b64 v[24:25], v41 offset:1536
    ds_read_b64 v[26:27], v41 offset:1544
    ds_read_b128 v[76:79], v40 offset:1536
    ds_read_b64 v[28:29], v41 offset:1024
    ds_read_b64 v[30:31], v41 offset:1032
    ds_read_b128 v[72:75], v40 offset:1024
    ds_read_b64 v[32:33], v41 offset:512
    ds_read_b64 v[34:35], v41 offset:520
    ds_read_b128 v[68:71], v40 offset:512
    ds_read_b64 v[36:37], v41 offset:0
    ds_read_b64 v[38:39], v41 offset:8
    v_subrev_u32 v40, 64, v40
    v_subrev_u32 v41, 64, v41
    s_mov_b32 s6, 1
L_conv_54:
    s_waitcnt lgkmcnt(0)
    ds_read_b64 v[96:97], v41 offset:3584
    ds_read_b64 v[98:99], v41 offset:3592
    ds_read_b128 v[128:131], v40 offset:0
    ds_read_b128 v[156:159], v40 offset:3584
    v_mfma_f32_16x16x32_f16 v[160:163], v[64:67], v[8:11], v[160:163]
    ds_read_b64 v[100:101], v41 offset:3072
    ds_read_b64 v[102:103], v41 offset:3080
    ds_read_b128 v[152:155], v40 offset:3072
    ds_read_b64 v[104:105], v41 offset:2560
    v_mfma_f32_16x16x32_f16 v[164:167], v[92:95], v[8:11], v[164:167]
    ds_read_b64 v[106:107], v41 offset:2568
    ds_read_b128 v[148:151], v40 offset:2560
    ds_read_b64 v[108:109], v41 offset:2048
    ds_read_b64 v[110:111], v41 offset:2056
    v_mfma_f32_16x16x32_f16 v[164:167], v[88:91], v[12:15], v[164:167]
    ds_read_b128 v[144:147], v40 offset:2048
    ds_read_b64 v[112:113], v41 offset:1536
    ds_read_b64 v[114:115], v41 offset:1544
    ds_read_b128 v[140:143], v40 offset:1536
    v_mfma_f32_16x16x32_f16 v[164:167], v[84:87], v[16:19], v[164:167]
    ds_read_b64 v[116:117], v41 offset:1024
    ds_read_b64 v[118:119], v41 offset:1032
    ds_read_b128 v[136:139], v40 offset:1024
    ds_read_b64 v[120:121], v41 offset:512
    v_mfma_f32_16x16x32_f16 v[164:167], v[80:83], v[20:23], v[164:167]
    ds_read_b64 v[122:123], v41 offset:520
    ds_read_b128 v[132:135], v40 offset:512
    ds_read_b64 v[124:125], v41 offset:0
    ds_read_b64 v[126:127], v41 offset:8
    v_mfma_f32_16x16x32_f16 v[164:167], v[76:79], v[24:27], v[164:167]
    v_mfma_f32_16x16x32_f16 v[164:167], v[72:75], v[28:31], v[164:167]
    v_mfma_f32_16x16x32_f16 v[164:167], v[68:71], v[32:35], v[164:167]
    v_mfma_f32_16x16x32_f16 v[164:167], v[64:67], v[36:39], v[164:167]
    v_subrev_u32 v40, 64, v40
    v_subrev_u32 v41, 64, v41
    s_waitcnt lgkmcnt(0)
    ds_read_b64 v[8:9], v41 offset:3584
    ds_read_b64 v[10:11], v41 offset:3592
    ds_read_b128 v[64:67], v40 offset:0
    ds_read_b128 v[92:95], v40 offset:3584
    v_mfma_f32_16x16x32_f16 v[160:163], v[128:131], v[96:99], v[160:163]
    ds_read_b64 v[12:13], v41 offset:3072
    ds_read_b64 v[14:15], v41 offset:3080
    ds_read_b128 v[88:91], v40 offset:3072
    ds_read_b64 v[16:17], v41 offset:2560
    v_mfma_f32_16x16x32_f16 v[164:167], v[156:159], v[96:99], v[164:167]
    ds_read_b64 v[18:19], v41 offset:2568
    ds_read_b128 v[84:87], v40 offset:2560
    ds_read_b64 v[20:21], v41 offset:2048
    ds_read_b64 v[22:23], v41 offset:2056
    v_mfma_f32_16x16x32_f16 v[164:167], v[152:155], v[100:103], v[164:167]
    ds_read_b128 v[80:83], v40 offset:2048
    ds_read_b64 v[24:25], v41 offset:1536
    ds_read_b64 v[26:27], v41 offset:1544
    ds_read_b128 v[76:79], v40 offset:1536
    v_mfma_f32_16x16x32_f16 v[164:167], v[148:151], v[104:107], v[164:167]
    ds_read_b64 v[28:29], v41 offset:1024
    ds_read_b64 v[30:31], v41 offset:1032
    ds_read_b128 v[72:75], v40 offset:1024
    ds_read_b64 v[32:33], v41 offset:512
    v_mfma_f32_16x16x32_f16 v[164:167], v[144:147], v[108:111], v[164:167]
    ds_read_b64 v[34:35], v41 offset:520
    ds_read_b128 v[68:71], v40 offset:512
    ds_read_b64 v[36:37], v41 offset:0
    ds_read_b64 v[38:39], v41 offset:8
    v_mfma_f32_16x16x32_f16 v[164:167], v[140:143], v[112:115], v[164:167]
    v_mfma_f32_16x16x32_f16 v[164:167], v[136:139], v[116:119], v[164:167]
    v_mfma_f32_16x16x32_f16 v[164:167], v[132:135], v[120:123], v[164:167]
    v_mfma_f32_16x16x32_f16 v[164:167], v[128:131], v[124:127], v[164:167]
    v_subrev_u32 v40, 64, v40
    v_subrev_u32 v41, 64, v41
    s_sub_u32 s6, s6, 1
    s_cmp_lg_u32 s6, 0
    s_cbranch_scc1 L_conv_54
    s_waitcnt lgkmcnt(0)
    s_sub_u32 s6, s5, 0
    s_lshl_b32 s6, s6, 11
    s_add_u32 s6, s6, 131072
    v_lshl_add_u32 v2, v1, 4, s6
    ds_write_b128 v2, v[160:163] offset:0
    ds_write_b128 v2, v[164:167] offset:1024
    s_mov_b32 s76, 163660
    s_waitcnt lgkmcnt(0)
    v_mov_b32 v2, s76
    v_mov_b32 v3, 1
    s_mov_b64 s[14:15], exec
    s_mov_b64 exec, 1
    ds_add_u32 v2, v3
    s_mov_b64 exec, s[14:15]
    s_mov_b32 s6, 0
L_ls_55:
    ds_read_b32 v3, v2
    s_add_u32 s6, s6, 1
    s_cmp_gt_u32 s6, 4000000
    s_cbranch_scc1 L_ls_done_56
    s_waitcnt lgkmcnt(0)
    v_readfirstlane_b32 s7, v3
    s_cmp_ge_u32 s7, 8
    s_cbranch_scc1 L_ls_done_56
    s_branch L_ls_55
L_ls_done_56:
    s_cmp_ge_u32 s5, 2
    s_cbranch_scc1 L_cv_done_57
    s_sub_u32 s6, s5, 0
    s_lshl_b32 s6, s6, 10
    s_add_u32 s6, s6, 131072
    v_lshl_add_u32 v2, v1, 4, s6
    ds_read_b128 v[144:147], v2 offset:0
    ds_read_b128 v[148:151], v2 offset:2048
    ds_read_b128 v[152:155], v2 offset:4096
    ds_read_b128 v[156:159], v2 offset:6144
    s_waitcnt lgkmcnt(0)
    v_add_f32 v144, v144, v148
    v_add_f32 v152, v152, v156
    v_add_f32 v145, v145, v149
    v_add_f32 v153, v153, v157
    v_add_f32 v146, v146, v150
    v_add_f32 v154, v154, v158
    v_add_f32 v147, v147, v151
    v_add_f32 v155, v155, v159
    v_add_f32 v160, v144, v152
    v_add_f32 v161, v145, v153
    v_add_f32 v162, v146, v154
    v_add_f32 v163, v147, v155
    s_cmp_eq_u32 s5, 0
    s_cselect_b32 s8, 0, 7
    s_lshl_b32 s8, s8, 9
    s_lshl_b32 s6, s72, 4
    s_add_u32 s6, s6, 163584
    v_mov_b32 v2, s6
    ds_read_b64 v[8:9], v2
    v_and_b32 v2, 15, v1
    v_lshrrev_b32 v3, 4, v1
    v_lshlrev_b32 v3, 7, v3
    v_lshl_add_u32 v3, v2, 3, v3
    s_add_u32 s6, s74, 14304
    s_add_u32 s6, s6, s8
    v_add_u32 v4, s6, v3
    ds_read_b64 v[10:11], v4
    s_lshl_b32 s7, s73, 12
    s_add_u32 s7, s7, 12976128
    s_add_u32 s7, s7, s8
    s_waitcnt lgkmcnt(0)
    v_cvt_f32_f16 v20, v10
    v_cvt_f32_f16_sdwa v21, v10 dst_sel:DWORD dst_unused:UNUSED_PAD src0_sel:WORD_1
    v_cvt_f32_f16 v22, v11
    v_cvt_f32_f16_sdwa v23, v11 dst_sel:DWORD dst_unused:UNUSED_PAD src0_sel:WORD_1
    v_mul_f32 v160, v160, v8
    v_mul_f32 v161, v161, v8
    v_mul_f32 v162, v162, v8
    v_mul_f32 v163, v163, v8
    v_fma_f32 v160, v20, v9, v160
    v_fma_f32 v161, v21, v9, v161
    v_fma_f32 v162, v22, v9, v162
    v_fma_f32 v163, v23, v9, v163
    v_cvt_pk_bf16_f32 v24, v160, v161
    v_cvt_pk_bf16_f32 v25, v162, v163
    buffer_store_dwordx2 v[24:25], v3, s[52:55], s7 offen sc1
L_cv_done_57:
    s_branch L_conv_done_49
L_q1_51:
    v_and_b32 v2, 15, v1
    v_lshrrev_b32 v3, 4, v1
    v_and_b32 v4, 3, v2
    v_lshrrev_b32 v5, 2, v2
    v_mul_u32_u24 v4, 4640, v4
    v_lshl_add_u32 v4, v5, 7, v4
    v_lshl_add_u32 v4, v3, 4, v4
    s_add_u32 s6, s74, 448
    v_add_u32 v40, s6, v4
    v_lshlrev_b32 v4, 4, v3
    v_lshlrev_b32 v5, 3, v2
    v_sub_u32 v4, v4, v5
    s_add_u32 s6, s75, 568
    v_add_u32 v41, s6, v4
    s_sub_u32 s6, s5, 0
    s_lshl_b32 s6, s6, 7
    v_subrev_u32 v40, s6, v40
    v_subrev_u32 v41, s6, v41
    v_mov_b32 v160, 0
    v_mov_b32 v161, 0
    v_mov_b32 v162, 0
    v_mov_b32 v163, 0
    v_mov_b32 v164, 0
    v_mov_b32 v165, 0
    v_mov_b32 v166, 0
    v_mov_b32 v167, 0
    ds_read_b64 v[8:9], v41 offset:3584
    ds_read_b64 v[10:11], v41 offset:3592
    ds_read_b128 v[68:71], v40 offset:512
    ds_read_b64 v[12:13], v41 offset:3072
    ds_read_b64 v[14:15], v41 offset:3080
    ds_read_b128 v[64:67], v40 offset:0
    ds_read_b128 v[88:91], v40 offset:3072
    ds_read_b128 v[84:87], v40 offset:2560
    ds_read_b64 v[16:17], v41 offset:2560
    ds_read_b64 v[18:19], v41 offset:2568
    ds_read_b128 v[80:83], v40 offset:2048
    ds_read_b64 v[20:21], v41 offset:2048
    ds_read_b64 v[22:23], v41 offset:2056
    ds_read_b128 v[76:79], v40 offset:1536
    ds_read_b64 v[24:25], v41 offset:1536
    ds_read_b64 v[26:27], v41 offset:1544
    ds_read_b128 v[72:75], v40 offset:1024
    ds_read_b64 v[28:29], v41 offset:1024
    ds_read_b64 v[30:31], v41 offset:1032
    ds_read_b64 v[32:33], v41 offset:512
    ds_read_b64 v[34:35], v41 offset:520
    v_subrev_u32 v40, 64, v40
    v_subrev_u32 v41, 64, v41
    s_mov_b32 s6, 1
L_conv_58:
    s_waitcnt lgkmcnt(0)
    ds_read_b64 v[96:97], v41 offset:3584
    ds_read_b64 v[98:99], v41 offset:3592
    ds_read_b128 v[132:135], v40 offset:512
    ds_read_b64 v[100:101], v41 offset:3072
    v_mfma_f32_16x16x32_f16 v[160:163], v[68:71], v[8:11], v[160:163]
    ds_read_b64 v[102:103], v41 offset:3080
    ds_read_b128 v[128:131], v40 offset:0
    ds_read_b128 v[152:155], v40 offset:3072
    ds_read_b128 v[148:151], v40 offset:2560
    v_mfma_f32_16x16x32_f16 v[160:163], v[64:67], v[12:15], v[160:163]
    ds_read_b64 v[104:105], v41 offset:2560
    ds_read_b64 v[106:107], v41 offset:2568
    ds_read_b128 v[144:147], v40 offset:2048
    ds_read_b64 v[108:109], v41 offset:2048
    v_mfma_f32_16x16x32_f16 v[164:167], v[88:91], v[8:11], v[164:167]
    ds_read_b64 v[110:111], v41 offset:2056
    ds_read_b128 v[140:143], v40 offset:1536
    ds_read_b64 v[112:113], v41 offset:1536
    ds_read_b64 v[114:115], v41 offset:1544
    v_mfma_f32_16x16x32_f16 v[164:167], v[84:87], v[12:15], v[164:167]
    ds_read_b128 v[136:139], v40 offset:1024
    ds_read_b64 v[116:117], v41 offset:1024
    ds_read_b64 v[118:119], v41 offset:1032
    ds_read_b64 v[120:121], v41 offset:512
    v_mfma_f32_16x16x32_f16 v[164:167], v[80:83], v[16:19], v[164:167]
    ds_read_b64 v[122:123], v41 offset:520
    v_mfma_f32_16x16x32_f16 v[164:167], v[76:79], v[20:23], v[164:167]
    v_mfma_f32_16x16x32_f16 v[164:167], v[72:75], v[24:27], v[164:167]
    v_mfma_f32_16x16x32_f16 v[164:167], v[68:71], v[28:31], v[164:167]
    v_mfma_f32_16x16x32_f16 v[164:167], v[64:67], v[32:35], v[164:167]
    v_subrev_u32 v40, 64, v40
    v_subrev_u32 v41, 64, v41
    s_waitcnt lgkmcnt(0)
    ds_read_b64 v[8:9], v41 offset:3584
    ds_read_b64 v[10:11], v41 offset:3592
    ds_read_b128 v[68:71], v40 offset:512
    ds_read_b64 v[12:13], v41 offset:3072
    v_mfma_f32_16x16x32_f16 v[160:163], v[132:135], v[96:99], v[160:163]
    ds_read_b64 v[14:15], v41 offset:3080
    ds_read_b128 v[64:67], v40 offset:0
    ds_read_b128 v[88:91], v40 offset:3072
    ds_read_b128 v[84:87], v40 offset:2560
    v_mfma_f32_16x16x32_f16 v[160:163], v[128:131], v[100:103], v[160:163]
    ds_read_b64 v[16:17], v41 offset:2560
    ds_read_b64 v[18:19], v41 offset:2568
    ds_read_b128 v[80:83], v40 offset:2048
    ds_read_b64 v[20:21], v41 offset:2048
    v_mfma_f32_16x16x32_f16 v[164:167], v[152:155], v[96:99], v[164:167]
    ds_read_b64 v[22:23], v41 offset:2056
    ds_read_b128 v[76:79], v40 offset:1536
    ds_read_b64 v[24:25], v41 offset:1536
    ds_read_b64 v[26:27], v41 offset:1544
    v_mfma_f32_16x16x32_f16 v[164:167], v[148:151], v[100:103], v[164:167]
    ds_read_b128 v[72:75], v40 offset:1024
    ds_read_b64 v[28:29], v41 offset:1024
    ds_read_b64 v[30:31], v41 offset:1032
    ds_read_b64 v[32:33], v41 offset:512
    v_mfma_f32_16x16x32_f16 v[164:167], v[144:147], v[104:107], v[164:167]
    ds_read_b64 v[34:35], v41 offset:520
    v_mfma_f32_16x16x32_f16 v[164:167], v[140:143], v[108:111], v[164:167]
    v_mfma_f32_16x16x32_f16 v[164:167], v[136:139], v[112:115], v[164:167]
    v_mfma_f32_16x16x32_f16 v[164:167], v[132:135], v[116:119], v[164:167]
    v_mfma_f32_16x16x32_f16 v[164:167], v[128:131], v[120:123], v[164:167]
    v_subrev_u32 v40, 64, v40
    v_subrev_u32 v41, 64, v41
    s_sub_u32 s6, s6, 1
    s_cmp_lg_u32 s6, 0
    s_cbranch_scc1 L_conv_58
    s_waitcnt lgkmcnt(0)
    s_sub_u32 s6, s5, 0
    s_lshl_b32 s6, s6, 11
    s_add_u32 s6, s6, 131072
    v_lshl_add_u32 v2, v1, 4, s6
    ds_write_b128 v2, v[160:163] offset:0
    ds_write_b128 v2, v[164:167] offset:1024
    s_mov_b32 s76, 163660
    s_waitcnt lgkmcnt(0)
    v_mov_b32 v2, s76
    v_mov_b32 v3, 1
    s_mov_b64 s[14:15], exec
    s_mov_b64 exec, 1
    ds_add_u32 v2, v3
    s_mov_b64 exec, s[14:15]
    s_mov_b32 s6, 0
L_ls_59:
    ds_read_b32 v3, v2
    s_add_u32 s6, s6, 1
    s_cmp_gt_u32 s6, 4000000
    s_cbranch_scc1 L_ls_done_60
    s_waitcnt lgkmcnt(0)
    v_readfirstlane_b32 s7, v3
    s_cmp_ge_u32 s7, 8
    s_cbranch_scc1 L_ls_done_60
    s_branch L_ls_59
L_ls_done_60:
    s_cmp_ge_u32 s5, 2
    s_cbranch_scc1 L_cv_done_61
    s_sub_u32 s6, s5, 0
    s_lshl_b32 s6, s6, 10
    s_add_u32 s6, s6, 131072
    v_lshl_add_u32 v2, v1, 4, s6
    ds_read_b128 v[144:147], v2 offset:0
    ds_read_b128 v[148:151], v2 offset:2048
    ds_read_b128 v[152:155], v2 offset:4096
    ds_read_b128 v[156:159], v2 offset:6144
    s_waitcnt lgkmcnt(0)
    v_add_f32 v144, v144, v148
    v_add_f32 v152, v152, v156
    v_add_f32 v145, v145, v149
    v_add_f32 v153, v153, v157
    v_add_f32 v146, v146, v150
    v_add_f32 v154, v154, v158
    v_add_f32 v147, v147, v151
    v_add_f32 v155, v155, v159
    v_add_f32 v160, v144, v152
    v_add_f32 v161, v145, v153
    v_add_f32 v162, v146, v154
    v_add_f32 v163, v147, v155
    s_cmp_eq_u32 s5, 0
    s_cselect_b32 s8, 1, 6
    s_lshl_b32 s8, s8, 9
    s_lshl_b32 s6, s72, 4
    s_add_u32 s6, s6, 163584
    v_mov_b32 v2, s6
    ds_read_b64 v[8:9], v2
    v_and_b32 v2, 15, v1
    v_lshrrev_b32 v3, 4, v1
    v_lshlrev_b32 v3, 7, v3
    v_lshl_add_u32 v3, v2, 3, v3
    s_add_u32 s6, s74, 14304
    s_add_u32 s6, s6, s8
    v_add_u32 v4, s6, v3
    ds_read_b64 v[10:11], v4
    s_lshl_b32 s7, s73, 12
    s_add_u32 s7, s7, 12976128
    s_add_u32 s7, s7, s8
    s_waitcnt lgkmcnt(0)
    v_cvt_f32_f16 v20, v10
    v_cvt_f32_f16_sdwa v21, v10 dst_sel:DWORD dst_unused:UNUSED_PAD src0_sel:WORD_1
    v_cvt_f32_f16 v22, v11
    v_cvt_f32_f16_sdwa v23, v11 dst_sel:DWORD dst_unused:UNUSED_PAD src0_sel:WORD_1
    v_mul_f32 v160, v160, v8
    v_mul_f32 v161, v161, v8
    v_mul_f32 v162, v162, v8
    v_mul_f32 v163, v163, v8
    v_fma_f32 v160, v20, v9, v160
    v_fma_f32 v161, v21, v9, v161
    v_fma_f32 v162, v22, v9, v162
    v_fma_f32 v163, v23, v9, v163
    v_cvt_pk_bf16_f32 v24, v160, v161
    v_cvt_pk_bf16_f32 v25, v162, v163
    buffer_store_dwordx2 v[24:25], v3, s[52:55], s7 offen sc1
L_cv_done_61:
    s_branch L_conv_done_49
L_q2_52:
    v_and_b32 v2, 15, v1
    v_lshrrev_b32 v3, 4, v1
    v_and_b32 v4, 3, v2
    v_lshrrev_b32 v5, 2, v2
    v_mul_u32_u24 v4, 4640, v4
    v_lshl_add_u32 v4, v5, 7, v4
    v_lshl_add_u32 v4, v3, 4, v4
    s_add_u32 s6, s74, 448
    v_add_u32 v40, s6, v4
    v_lshlrev_b32 v4, 4, v3
    v_lshlrev_b32 v5, 3, v2
    v_sub_u32 v4, v4, v5
    s_add_u32 s6, s75, 568
    v_add_u32 v41, s6, v4
    s_sub_u32 s6, s5, 0
    s_lshl_b32 s6, s6, 7
    v_subrev_u32 v40, s6, v40
    v_subrev_u32 v41, s6, v41
    v_mov_b32 v160, 0
    v_mov_b32 v161, 0
    v_mov_b32 v162, 0
    v_mov_b32 v163, 0
    v_mov_b32 v164, 0
    v_mov_b32 v165, 0
    v_mov_b32 v166, 0
    v_mov_b32 v167, 0
    ds_read_b64 v[8:9], v41 offset:3584
    ds_read_b64 v[10:11], v41 offset:3592
    ds_read_b128 v[72:75], v40 offset:1024
    ds_read_b64 v[12:13], v41 offset:3072
    ds_read_b64 v[14:15], v41 offset:3080
    ds_read_b128 v[68:71], v40 offset:512
    ds_read_b64 v[16:17], v41 offset:2560
    ds_read_b64 v[18:19], v41 offset:2568
    ds_read_b128 v[64:67], v40 offset:0
    ds_read_b128 v[84:87], v40 offset:2560
    ds_read_b128 v[80:83], v40 offset:2048
    ds_read_b128 v[76:79], v40 offset:1536
    ds_read_b64 v[20:21], v41 offset:2048
    ds_read_b64 v[22:23], v41 offset:2056
    ds_read_b64 v[24:25], v41 offset:1536
    ds_read_b64 v[26:27], v41 offset:1544
    ds_read_b64 v[28:29], v41 offset:1024
    ds_read_b64 v[30:31], v41 offset:1032
    v_subrev_u32 v40, 64, v40
    v_subrev_u32 v41, 64, v41
    s_mov_b32 s6, 1
L_conv_62:
    s_waitcnt lgkmcnt(0)
    ds_read_b64 v[96:97], v41 offset:3584
    ds_read_b64 v[98:99], v41 offset:3592
    ds_read_b128 v[136:139], v40 offset:1024
    v_mfma_f32_16x16x32_f16 v[160:163], v[72:75], v[8:11], v[160:163]
    ds_read_b64 v[100:101], v41 offset:3072
    ds_read_b64 v[102:103], v41 offset:3080
    ds_read_b128 v[132:135], v40 offset:512
    v_mfma_f32_16x16x32_f16 v[160:163], v[68:71], v[12:15], v[160:163]
    ds_read_b64 v[104:105], v41 offset:2560
    ds_read_b64 v[106:107], v41 offset:2568
    ds_read_b128 v[128:131], v40 offset:0
    v_mfma_f32_16x16x32_f16 v[160:163], v[64:67], v[16:19], v[160:163]
    ds_read_b128 v[148:151], v40 offset:2560
    ds_read_b128 v[144:147], v40 offset:2048
    ds_read_b128 v[140:143], v40 offset:1536
    v_mfma_f32_16x16x32_f16 v[164:167], v[84:87], v[8:11], v[164:167]
    ds_read_b64 v[108:109], v41 offset:2048
    ds_read_b64 v[110:111], v41 offset:2056
    ds_read_b64 v[112:113], v41 offset:1536
    v_mfma_f32_16x16x32_f16 v[164:167], v[80:83], v[12:15], v[164:167]
    ds_read_b64 v[114:115], v41 offset:1544
    ds_read_b64 v[116:117], v41 offset:1024
    ds_read_b64 v[118:119], v41 offset:1032
    v_mfma_f32_16x16x32_f16 v[164:167], v[76:79], v[16:19], v[164:167]
    v_mfma_f32_16x16x32_f16 v[164:167], v[72:75], v[20:23], v[164:167]
    v_mfma_f32_16x16x32_f16 v[164:167], v[68:71], v[24:27], v[164:167]
    v_mfma_f32_16x16x32_f16 v[164:167], v[64:67], v[28:31], v[164:167]
    v_subrev_u32 v40, 64, v40
    v_subrev_u32 v41, 64, v41
    s_waitcnt lgkmcnt(0)
    ds_read_b64 v[8:9], v41 offset:3584
    ds_read_b64 v[10:11], v41 offset:3592
    ds_read_b128 v[72:75], v40 offset:1024
    v_mfma_f32_16x16x32_f16 v[160:163], v[136:139], v[96:99], v[160:163]
    ds_read_b64 v[12:13], v41 offset:3072
    ds_read_b64 v[14:15], v41 offset:3080
    ds_read_b128 v[68:71], v40 offset:512
    v_mfma_f32_16x16x32_f16 v[160:163], v[132:135], v[100:103], v[160:163]
    ds_read_b64 v[16:17], v41 offset:2560
    ds_read_b64 v[18:19], v41 offset:2568
    ds_read_b128 v[64:67], v40 offset:0
    v_mfma_f32_16x16x32_f16 v[160:163], v[128:131], v[104:107], v[160:163]
    ds_read_b128 v[84:87], v40 offset:2560
    ds_read_b128 v[80:83], v40 offset:2048
    ds_read_b128 v[76:79], v40 offset:1536
    v_mfma_f32_16x16x32_f16 v[164:167], v[148:151], v[96:99], v[164:167]
    ds_read_b64 v[20:21], v41 offset:2048
    ds_read_b64 v[22:23], v41 offset:2056
    ds_read_b64 v[24:25], v41 offset:1536
    v_mfma_f32_16x16x32_f16 v[164:167], v[144:147], v[100:103], v[164:167]
    ds_read_b64 v[26:27], v41 offset:1544
    ds_read_b64 v[28:29], v41 offset:1024
    ds_read_b64 v[30:31], v41 offset:1032
    v_mfma_f32_16x16x32_f16 v[164:167], v[140:143], v[104:107], v[164:167]
    v_mfma_f32_16x16x32_f16 v[164:167], v[136:139], v[108:111], v[164:167]
    v_mfma_f32_16x16x32_f16 v[164:167], v[132:135], v[112:115], v[164:167]
    v_mfma_f32_16x16x32_f16 v[164:167], v[128:131], v[116:119], v[164:167]
    v_subrev_u32 v40, 64, v40
    v_subrev_u32 v41, 64, v41
    s_sub_u32 s6, s6, 1
    s_cmp_lg_u32 s6, 0
    s_cbranch_scc1 L_conv_62
    s_waitcnt lgkmcnt(0)
    s_sub_u32 s6, s5, 0
    s_lshl_b32 s6, s6, 11
    s_add_u32 s6, s6, 131072
    v_lshl_add_u32 v2, v1, 4, s6
    ds_write_b128 v2, v[160:163] offset:0
    ds_write_b128 v2, v[164:167] offset:1024
    s_mov_b32 s76, 163660
    s_waitcnt lgkmcnt(0)
    v_mov_b32 v2, s76
    v_mov_b32 v3, 1
    s_mov_b64 s[14:15], exec
    s_mov_b64 exec, 1
    ds_add_u32 v2, v3
    s_mov_b64 exec, s[14:15]
    s_mov_b32 s6, 0
L_ls_63:
    ds_read_b32 v3, v2
    s_add_u32 s6, s6, 1
    s_cmp_gt_u32 s6, 4000000
    s_cbranch_scc1 L_ls_done_64
    s_waitcnt lgkmcnt(0)
    v_readfirstlane_b32 s7, v3
    s_cmp_ge_u32 s7, 8
    s_cbranch_scc1 L_ls_done_64
    s_branch L_ls_63
L_ls_done_64:
    s_cmp_ge_u32 s5, 2
    s_cbranch_scc1 L_cv_done_65
    s_sub_u32 s6, s5, 0
    s_lshl_b32 s6, s6, 10
    s_add_u32 s6, s6, 131072
    v_lshl_add_u32 v2, v1, 4, s6
    ds_read_b128 v[144:147], v2 offset:0
    ds_read_b128 v[148:151], v2 offset:2048
    ds_read_b128 v[152:155], v2 offset:4096
    ds_read_b128 v[156:159], v2 offset:6144
    s_waitcnt lgkmcnt(0)
    v_add_f32 v144, v144, v148
    v_add_f32 v152, v152, v156
    v_add_f32 v145, v145, v149
    v_add_f32 v153, v153, v157
    v_add_f32 v146, v146, v150
    v_add_f32 v154, v154, v158
    v_add_f32 v147, v147, v151
    v_add_f32 v155, v155, v159
    v_add_f32 v160, v144, v152
    v_add_f32 v161, v145, v153
    v_add_f32 v162, v146, v154
    v_add_f32 v163, v147, v155
    s_cmp_eq_u32 s5, 0
    s_cselect_b32 s8, 2, 5
    s_lshl_b32 s8, s8, 9
    s_lshl_b32 s6, s72, 4
    s_add_u32 s6, s6, 163584
    v_mov_b32 v2, s6
    ds_read_b64 v[8:9], v2
    v_and_b32 v2, 15, v1
    v_lshrrev_b32 v3, 4, v1
    v_lshlrev_b32 v3, 7, v3
    v_lshl_add_u32 v3, v2, 3, v3
    s_add_u32 s6, s74, 14304
    s_add_u32 s6, s6, s8
    v_add_u32 v4, s6, v3
    ds_read_b64 v[10:11], v4
    s_lshl_b32 s7, s73, 12
    s_add_u32 s7, s7, 12976128
    s_add_u32 s7, s7, s8
    s_waitcnt lgkmcnt(0)
    v_cvt_f32_f16 v20, v10
    v_cvt_f32_f16_sdwa v21, v10 dst_sel:DWORD dst_unused:UNUSED_PAD src0_sel:WORD_1
    v_cvt_f32_f16 v22, v11
    v_cvt_f32_f16_sdwa v23, v11 dst_sel:DWORD dst_unused:UNUSED_PAD src0_sel:WORD_1
    v_mul_f32 v160, v160, v8
    v_mul_f32 v161, v161, v8
    v_mul_f32 v162, v162, v8
    v_mul_f32 v163, v163, v8
    v_fma_f32 v160, v20, v9, v160
    v_fma_f32 v161, v21, v9, v161
    v_fma_f32 v162, v22, v9, v162
    v_fma_f32 v163, v23, v9, v163
    v_cvt_pk_bf16_f32 v24, v160, v161
    v_cvt_pk_bf16_f32 v25, v162, v163
    buffer_store_dwordx2 v[24:25], v3, s[52:55], s7 offen sc1
L_cv_done_65:
    s_branch L_conv_done_49
L_q3_53:
    v_and_b32 v2, 15, v1
    v_lshrrev_b32 v3, 4, v1
    v_and_b32 v4, 3, v2
    v_lshrrev_b32 v5, 2, v2
    v_mul_u32_u24 v4, 4640, v4
    v_lshl_add_u32 v4, v5, 7, v4
    v_lshl_add_u32 v4, v3, 4, v4
    s_add_u32 s6, s74, 448
    v_add_u32 v40, s6, v4
    v_lshlrev_b32 v4, 4, v3
    v_lshlrev_b32 v5, 3, v2
    v_sub_u32 v4, v4, v5
    s_add_u32 s6, s75, 568
    v_add_u32 v41, s6, v4
    s_sub_u32 s6, s5, 0
    s_lshl_b32 s6, s6, 7
    v_subrev_u32 v40, s6, v40
    v_subrev_u32 v41, s6, v41
    v_mov_b32 v160, 0
    v_mov_b32 v161, 0
    v_mov_b32 v162, 0
    v_mov_b32 v163, 0
    v_mov_b32 v164, 0
    v_mov_b32 v165, 0
    v_mov_b32 v166, 0
    v_mov_b32 v167, 0
    ds_read_b64 v[8:9], v41 offset:3584
    ds_read_b64 v[10:11], v41 offset:3592
    ds_read_b128 v[76:79], v40 offset:1536
    ds_read_b64 v[12:13], v41 offset:3072
    ds_read_b64 v[14:15], v41 offset:3080
    ds_read_b128 v[72:75], v40 offset:1024
    ds_read_b64 v[16:17], v41 offset:2560
    ds_read_b64 v[18:19], v41 offset:2568
    ds_read_b128 v[68:71], v40 offset:512
    ds_read_b64 v[20:21], v41 offset:2048
    ds_read_b64 v[22:23], v41 offset:2056
    ds_read_b128 v[64:67], v40 offset:0
    ds_read_b128 v[80:83], v40 offset:2048
    ds_read_b64 v[24:25], v41 offset:1536
    ds_read_b64 v[26:27], v41 offset:1544
    v_subrev_u32 v40, 64, v40
    v_subrev_u32 v41, 64, v41
    s_mov_b32 s6, 1
L_conv_66:
    s_waitcnt lgkmcnt(0)
    ds_read_b64 v[96:97], v41 offset:3584
    ds_read_b64 v[98:99], v41 offset:3592
    ds_read_b128 v[140:143], v40 offset:1536
    v_mfma_f32_16x16x32_f16 v[160:163], v[76:79], v[8:11], v[160:163]
    ds_read_b64 v[100:101], v41 offset:3072
    ds_read_b64 v[102:103], v41 offset:3080
    ds_read_b128 v[136:139], v40 offset:1024
    v_mfma_f32_16x16x32_f16 v[160:163], v[72:75], v[12:15], v[160:163]
    ds_read_b64 v[104:105], v41 offset:2560
    ds_read_b64 v[106:107], v41 offset:2568
    ds_read_b128 v[132:135], v40 offset:512
    v_mfma_f32_16x16x32_f16 v[160:163], v[68:71], v[16:19], v[160:163]
    ds_read_b64 v[108:109], v41 offset:2048
    ds_read_b64 v[110:111], v41 offset:2056
    ds_read_b128 v[128:131], v40 offset:0
    v_mfma_f32_16x16x32_f16 v[160:163], v[64:67], v[20:23], v[160:163]
    ds_read_b128 v[144:147], v40 offset:2048
    ds_read_b64 v[112:113], v41 offset:1536
    ds_read_b64 v[114:115], v41 offset:1544
    v_mfma_f32_16x16x32_f16 v[164:167], v[80:83], v[8:11], v[164:167]
    v_mfma_f32_16x16x32_f16 v[164:167], v[76:79], v[12:15], v[164:167]
    v_mfma_f32_16x16x32_f16 v[164:167], v[72:75], v[16:19], v[164:167]
    v_mfma_f32_16x16x32_f16 v[164:167], v[68:71], v[20:23], v[164:167]
    v_mfma_f32_16x16x32_f16 v[164:167], v[64:67], v[24:27], v[164:167]
    v_subrev_u32 v40, 64, v40
    v_subrev_u32 v41, 64, v41
    s_waitcnt lgkmcnt(0)
    ds_read_b64 v[8:9], v41 offset:3584
    ds_read_b64 v[10:11], v41 offset:3592
    ds_read_b128 v[76:79], v40 offset:1536
    v_mfma_f32_16x16x32_f16 v[160:163], v[140:143], v[96:99], v[160:163]
    ds_read_b64 v[12:13], v41 offset:3072
    ds_read_b64 v[14:15], v41 offset:3080
    ds_read_b128 v[72:75], v40 offset:1024
    v_mfma_f32_16x16x32_f16 v[160:163], v[136:139], v[100:103], v[160:163]
    ds_read_b64 v[16:17], v41 offset:2560
    ds_read_b64 v[18:19], v41 offset:2568
    ds_read_b128 v[68:71], v40 offset:512
    v_mfma_f32_16x16x32_f16 v[160:163], v[132:135], v[104:107], v[160:163]
    ds_read_b64 v[20:21], v41 offset:2048
    ds_read_b64 v[22:23], v41 offset:2056
    ds_read_b128 v[64:67], v40 offset:0
    v_mfma_f32_16x16x32_f16 v[160:163], v[128:131], v[108:111], v[160:163]
    ds_read_b128 v[80:83], v40 offset:2048
    ds_read_b64 v[24:25], v41 offset:1536
    ds_read_b64 v[26:27], v41 offset:1544
    v_mfma_f32_16x16x32_f16 v[164:167], v[144:147], v[96:99], v[164:167]
    v_mfma_f32_16x16x32_f16 v[164:167], v[140:143], v[100:103], v[164:167]
    v_mfma_f32_16x16x32_f16 v[164:167], v[136:139], v[104:107], v[164:167]
    v_mfma_f32_16x16x32_f16 v[164:167], v[132:135], v[108:111], v[164:167]
    v_mfma_f32_16x16x32_f16 v[164:167], v[128:131], v[112:115], v[164:167]
    v_subrev_u32 v40, 64, v40
    v_subrev_u32 v41, 64, v41
    s_sub_u32 s6, s6, 1
    s_cmp_lg_u32 s6, 0
    s_cbranch_scc1 L_conv_66
    s_waitcnt lgkmcnt(0)
    s_sub_u32 s6, s5, 0
    s_lshl_b32 s6, s6, 11
    s_add_u32 s6, s6, 131072
    v_lshl_add_u32 v2, v1, 4, s6
    ds_write_b128 v2, v[160:163] offset:0
    ds_write_b128 v2, v[164:167] offset:1024
    s_mov_b32 s76, 163660
    s_waitcnt lgkmcnt(0)
    v_mov_b32 v2, s76
    v_mov_b32 v3, 1
    s_mov_b64 s[14:15], exec
    s_mov_b64 exec, 1
    ds_add_u32 v2, v3
    s_mov_b64 exec, s[14:15]
    s_mov_b32 s6, 0
L_ls_67:
    ds_read_b32 v3, v2
    s_add_u32 s6, s6, 1
    s_cmp_gt_u32 s6, 4000000
    s_cbranch_scc1 L_ls_done_68
    s_waitcnt lgkmcnt(0)
    v_readfirstlane_b32 s7, v3
    s_cmp_ge_u32 s7, 8
    s_cbranch_scc1 L_ls_done_68
    s_branch L_ls_67
L_ls_done_68:
    s_cmp_ge_u32 s5, 2
    s_cbranch_scc1 L_cv_done_69
    s_sub_u32 s6, s5, 0
    s_lshl_b32 s6, s6, 10
    s_add_u32 s6, s6, 131072
    v_lshl_add_u32 v2, v1, 4, s6
    ds_read_b128 v[144:147], v2 offset:0
    ds_read_b128 v[148:151], v2 offset:2048
    ds_read_b128 v[152:155], v2 offset:4096
    ds_read_b128 v[156:159], v2 offset:6144
    s_waitcnt lgkmcnt(0)
    v_add_f32 v144, v144, v148
    v_add_f32 v152, v152, v156
    v_add_f32 v145, v145, v149
    v_add_f32 v153, v153, v157
    v_add_f32 v146, v146, v150
    v_add_f32 v154, v154, v158
    v_add_f32 v147, v147, v151
    v_add_f32 v155, v155, v159
    v_add_f32 v160, v144, v152
    v_add_f32 v161, v145, v153
    v_add_f32 v162, v146, v154
    v_add_f32 v163, v147, v155
    s_cmp_eq_u32 s5, 0
    s_cselect_b32 s8, 3, 4
    s_lshl_b32 s8, s8, 9
    s_lshl_b32 s6, s72, 4
    s_add_u32 s6, s6, 163584
    v_mov_b32 v2, s6
    ds_read_b64 v[8:9], v2
    v_and_b32 v2, 15, v1
    v_lshrrev_b32 v3, 4, v1
    v_lshlrev_b32 v3, 7, v3
    v_lshl_add_u32 v3, v2, 3, v3
    s_add_u32 s6, s74, 14304
    s_add_u32 s6, s6, s8
    v_add_u32 v4, s6, v3
    ds_read_b64 v[10:11], v4
    s_lshl_b32 s7, s73, 12
    s_add_u32 s7, s7, 12976128
    s_add_u32 s7, s7, s8
    s_waitcnt lgkmcnt(0)
    v_cvt_f32_f16 v20, v10
    v_cvt_f32_f16_sdwa v21, v10 dst_sel:DWORD dst_unused:UNUSED_PAD src0_sel:WORD_1
    v_cvt_f32_f16 v22, v11
    v_cvt_f32_f16_sdwa v23, v11 dst_sel:DWORD dst_unused:UNUSED_PAD src0_sel:WORD_1
    v_mul_f32 v160, v160, v8
    v_mul_f32 v161, v161, v8
    v_mul_f32 v162, v162, v8
    v_mul_f32 v163, v163, v8
    v_fma_f32 v160, v20, v9, v160
    v_fma_f32 v161, v21, v9, v161
    v_fma_f32 v162, v22, v9, v162
    v_fma_f32 v163, v23, v9, v163
    v_cvt_pk_bf16_f32 v24, v160, v161
    v_cvt_pk_bf16_f32 v25, v162, v163
    buffer_store_dwordx2 v[24:25], v3, s[52:55], s7 offen sc1
L_cv_done_69:
L_conv_done_49:
    v_add_u32 v56, 0, v58
    v_add_u32 v57, 0, v58
    ds_read_b128 v[144:147], v56 offset:0
    ds_read_b128 v[148:151], v56 offset:1024
    ds_read_b128 v[152:155], v56 offset:2048
    ds_read_b128 v[156:159], v56 offset:3072
    ds_read_b128 v[160:163], v57 offset:4096
    ds_read_b128 v[164:167], v57 offset:5120
    ds_read_b128 v[168:171], v57 offset:6144
    ds_read_b128 v[172:175], v57 offset:7168
    s_waitcnt lgkmcnt(4)
    s_waitcnt vmcnt(14)
    v_mfma_f32_16x16x32_bf16 v[64:67], v[176:179], v[144:147], 0
    v_mfma_f32_16x16x32_bf16 v[68:71], v[176:179], v[148:151], 0
    v_mfma_f32_16x16x32_bf16 v[72:75], v[176:179], v[152:155], 0
    v_mfma_f32_16x16x32_bf16 v[76:79], v[176:179], v[156:159], 0
    buffer_load_dwordx4 v[176:179], v58, s[60:63], s77 offen offset:0 sc1
    s_waitcnt vmcnt(14)
    v_mfma_f32_16x16x32_bf16 v[80:83], v[180:183], v[144:147], 0
    v_mfma_f32_16x16x32_bf16 v[84:87], v[180:183], v[148:151], 0
    v_mfma_f32_16x16x32_bf16 v[88:91], v[180:183], v[152:155], 0
    v_mfma_f32_16x16x32_bf16 v[92:95], v[180:183], v[156:159], 0
    buffer_load_dwordx4 v[180:183], v58, s[60:63], s77 offen offset:1024 sc1
    s_waitcnt vmcnt(14)
    v_mfma_f32_16x16x32_bf16 v[96:99], v[184:187], v[144:147], 0
    v_mfma_f32_16x16x32_bf16 v[100:103], v[184:187], v[148:151], 0
    v_mfma_f32_16x16x32_bf16 v[104:107], v[184:187], v[152:155], 0
    v_mfma_f32_16x16x32_bf16 v[108:111], v[184:187], v[156:159], 0
    buffer_load_dwordx4 v[184:187], v58, s[60:63], s77 offen offset:2048 sc1
    s_waitcnt vmcnt(14)
    v_mfma_f32_16x16x32_bf16 v[112:115], v[188:191], v[144:147], 0
    v_mfma_f32_16x16x32_bf16 v[116:119], v[188:191], v[148:151], 0
    v_mfma_f32_16x16x32_bf16 v[120:123], v[188:191], v[152:155], 0
    v_mfma_f32_16x16x32_bf16 v[124:127], v[188:191], v[156:159], 0
    buffer_load_dwordx4 v[188:191], v58, s[60:63], s77 offen offset:3072 sc1
    s_add_u32 s77, s77, 4096
    s_waitcnt vmcnt(14)
    v_mfma_f32_16x16x32_bf16 v[128:131], v[192:195], v[144:147], 0
    v_mfma_f32_16x16x32_bf16 v[132:135], v[192:195], v[148:151], 0
    v_mfma_f32_16x16x32_bf16 v[136:139], v[192:195], v[152:155], 0
    v_mfma_f32_16x16x32_bf16 v[140:143], v[192:195], v[156:159], 0
    buffer_load_dwordx4 v[192:195], v58, s[60:63], s77 offen offset:0 sc1
    ds_read_b128 v[144:147], v56 offset:8192
    ds_read_b128 v[148:151], v56 offset:9216
    ds_read_b128 v[152:155], v56 offset:10240
    ds_read_b128 v[156:159], v56 offset:11264
    s_waitcnt lgkmcnt(4)
    s_waitcnt vmcnt(14)
    v_mfma_f32_16x16x32_bf16 v[64:67], v[196:199], v[160:163], v[64:67]
    v_mfma_f32_16x16x32_bf16 v[68:71], v[196:199], v[164:167], v[68:71]
    v_mfma_f32_16x16x32_bf16 v[72:75], v[196:199], v[168:171], v[72:75]
    v_mfma_f32_16x16x32_bf16 v[76:79], v[196:199], v[172:175], v[76:79]
    buffer_load_dwordx4 v[196:199], v58, s[60:63], s77 offen offset:1024 sc1
    s_waitcnt vmcnt(14)
    v_mfma_f32_16x16x32_bf16 v[80:83], v[200:203], v[160:163], v[80:83]
    v_mfma_f32_16x16x32_bf16 v[84:87], v[200:203], v[164:167], v[84:87]
    v_mfma_f32_16x16x32_bf16 v[88:91], v[200:203], v[168:171], v[88:91]
    v_mfma_f32_16x16x32_bf16 v[92:95], v[200:203], v[172:175], v[92:95]
    buffer_load_dwordx4 v[200:203], v58, s[60:63], s77 offen offset:2048 sc1
    s_waitcnt vmcnt(14)
    v_mfma_f32_16x16x32_bf16 v[96:99], v[204:207], v[160:163], v[96:99]
    v_mfma_f32_16x16x32_bf16 v[100:103], v[204:207], v[164:167], v[100:103]
    v_mfma_f32_16x16x32_bf16 v[104:107], v[204:207], v[168:171], v[104:107]
    v_mfma_f32_16x16x32_bf16 v[108:111], v[204:207], v[172:175], v[108:111]
    buffer_load_dwordx4 v[204:207], v58, s[60:63], s77 offen offset:3072 sc1
    s_add_u32 s77, s77, 4096
    s_waitcnt vmcnt(14)
    v_mfma_f32_16x16x32_bf16 v[112:115], v[208:211], v[160:163], v[112:115]
    v_mfma_f32_16x16x32_bf16 v[116:119], v[208:211], v[164:167], v[116:119]
    v_mfma_f32_16x16x32_bf16 v[120:123], v[208:211], v[168:171], v[120:123]
    v_mfma_f32_16x16x32_bf16 v[124:127], v[208:211], v[172:175], v[124:127]
    buffer_load_dwordx4 v[208:211], v58, s[60:63], s77 offen offset:0 sc1
    s_waitcnt vmcnt(14)
    v_mfma_f32_16x16x32_bf16 v[128:131], v[212:215], v[160:163], v[128:131]
    v_mfma_f32_16x16x32_bf16 v[132:135], v[212:215], v[164:167], v[132:135]
    v_mfma_f32_16x16x32_bf16 v[136:139], v[212:215], v[168:171], v[136:139]
    v_mfma_f32_16x16x32_bf16 v[140:143], v[212:215], v[172:175], v[140:143]
    buffer_load_dwordx4 v[212:215], v58, s[60:63], s77 offen offset:1024 sc1
    ds_read_b128 v[160:163], v57 offset:12288
    ds_read_b128 v[164:167], v57 offset:13312
    ds_read_b128 v[168:171], v57 offset:14336
    ds_read_b128 v[172:175], v57 offset:15360
    s_waitcnt lgkmcnt(4)
    s_waitcnt vmcnt(14)
    v_mfma_f32_16x16x32_bf16 v[64:67], v[216:219], v[144:147], v[64:67]
    v_mfma_f32_16x16x32_bf16 v[68:71], v[216:219], v[148:151], v[68:71]
    v_mfma_f32_16x16x32_bf16 v[72:75], v[216:219], v[152:155], v[72:75]
    v_mfma_f32_16x16x32_bf16 v[76:79], v[216:219], v[156:159], v[76:79]
    buffer_load_dwordx4 v[216:219], v58, s[60:63], s77 offen offset:2048 sc1
    s_waitcnt vmcnt(14)
    v_mfma_f32_16x16x32_bf16 v[80:83], v[220:223], v[144:147], v[80:83]
    v_mfma_f32_16x16x32_bf16 v[84:87], v[220:223], v[148:151], v[84:87]
    v_mfma_f32_16x16x32_bf16 v[88:91], v[220:223], v[152:155], v[88:91]
    v_mfma_f32_16x16x32_bf16 v[92:95], v[220:223], v[156:159], v[92:95]
    buffer_load_dwordx4 v[220:223], v58, s[60:63], s77 offen offset:3072 sc1
    s_add_u32 s77, s77, 4096
    s_waitcnt vmcnt(14)
    v_mfma_f32_16x16x32_bf16 v[96:99], v[224:227], v[144:147], v[96:99]
    v_mfma_f32_16x16x32_bf16 v[100:103], v[224:227], v[148:151], v[100:103]
    v_mfma_f32_16x16x32_bf16 v[104:107], v[224:227], v[152:155], v[104:107]
    v_mfma_f32_16x16x32_bf16 v[108:111], v[224:227], v[156:159], v[108:111]
    buffer_load_dwordx4 v[224:227], v58, s[60:63], s77 offen offset:0 sc1
    s_waitcnt vmcnt(14)
    v_mfma_f32_16x16x32_bf16 v[112:115], v[228:231], v[144:147], v[112:115]
    v_mfma_f32_16x16x32_bf16 v[116:119], v[228:231], v[148:151], v[116:119]
    v_mfma_f32_16x16x32_bf16 v[120:123], v[228:231], v[152:155], v[120:123]
    v_mfma_f32_16x16x32_bf16 v[124:127], v[228:231], v[156:159], v[124:127]
    buffer_load_dwordx4 v[228:231], v58, s[60:63], s77 offen offset:1024 sc1
    s_waitcnt vmcnt(14)
    v_mfma_f32_16x16x32_bf16 v[128:131], v[232:235], v[144:147], v[128:131]
    v_mfma_f32_16x16x32_bf16 v[132:135], v[232:235], v[148:151], v[132:135]
    v_mfma_f32_16x16x32_bf16 v[136:139], v[232:235], v[152:155], v[136:139]
    v_mfma_f32_16x16x32_bf16 v[140:143], v[232:235], v[156:159], v[140:143]
    buffer_load_dwordx4 v[232:235], v58, s[60:63], s77 offen offset:2048 sc1
    ds_read_b128 v[144:147], v56 offset:16384
    ds_read_b128 v[148:151], v56 offset:17408
    ds_read_b128 v[152:155], v56 offset:18432
    ds_read_b128 v[156:159], v56 offset:19456
    s_waitcnt lgkmcnt(4)
    s_waitcnt vmcnt(14)
    v_mfma_f32_16x16x32_bf16 v[64:67], v[176:179], v[160:163], v[64:67]
    v_mfma_f32_16x16x32_bf16 v[68:71], v[176:179], v[164:167], v[68:71]
    v_mfma_f32_16x16x32_bf16 v[72:75], v[176:179], v[168:171], v[72:75]
    v_mfma_f32_16x16x32_bf16 v[76:79], v[176:179], v[172:175], v[76:79]
    buffer_load_dwordx4 v[176:179], v58, s[60:63], s77 offen offset:3072 sc1
    s_add_u32 s77, s77, 4096
    s_waitcnt vmcnt(14)
    v_mfma_f32_16x16x32_bf16 v[80:83], v[180:183], v[160:163], v[80:83]
    v_mfma_f32_16x16x32_bf16 v[84:87], v[180:183], v[164:167], v[84:87]
    v_mfma_f32_16x16x32_bf16 v[88:91], v[180:183], v[168:171], v[88:91]
    v_mfma_f32_16x16x32_bf16 v[92:95], v[180:183], v[172:175], v[92:95]
    buffer_load_dwordx4 v[180:183], v58, s[60:63], s77 offen offset:0 sc1
    s_waitcnt vmcnt(14)
    v_mfma_f32_16x16x32_bf16 v[96:99], v[184:187], v[160:163], v[96:99]
    v_mfma_f32_16x16x32_bf16 v[100:103], v[184:187], v[164:167], v[100:103]
    v_mfma_f32_16x16x32_bf16 v[104:107], v[184:187], v[168:171], v[104:107]
    v_mfma_f32_16x16x32_bf16 v[108:111], v[184:187], v[172:175], v[108:111]
    buffer_load_dwordx4 v[184:187], v58, s[60:63], s77 offen offset:1024 sc1
    s_waitcnt vmcnt(14)
    v_mfma_f32_16x16x32_bf16 v[112:115], v[188:191], v[160:163], v[112:115]
    v_mfma_f32_16x16x32_bf16 v[116:119], v[188:191], v[164:167], v[116:119]
    v_mfma_f32_16x16x32_bf16 v[120:123], v[188:191], v[168:171], v[120:123]
    v_mfma_f32_16x16x32_bf16 v[124:127], v[188:191], v[172:175], v[124:127]
    buffer_load_dwordx4 v[188:191], v58, s[60:63], s77 offen offset:2048 sc1
    s_waitcnt vmcnt(14)
    v_mfma_f32_16x16x32_bf16 v[128:131], v[192:195], v[160:163], v[128:131]
    v_mfma_f32_16x16x32_bf16 v[132:135], v[192:195], v[164:167], v[132:135]
    v_mfma_f32_16x16x32_bf16 v[136:139], v[192:195], v[168:171], v[136:139]
    v_mfma_f32_16x16x32_bf16 v[140:143], v[192:195], v[172:175], v[140:143]
    buffer_load_dwordx4 v[192:195], v58, s[60:63], s77 offen offset:3072 sc1
    s_add_u32 s77, s77, 4096
    ds_read_b128 v[160:163], v57 offset:20480
    ds_read_b128 v[164:167], v57 offset:21504
    ds_read_b128 v[168:171], v57 offset:22528
    ds_read_b128 v[172:175], v57 offset:23552
    s_waitcnt lgkmcnt(4)
    s_waitcnt vmcnt(14)
    v_mfma_f32_16x16x32_bf16 v[64:67], v[196:199], v[144:147], v[64:67]
    v_mfma_f32_16x16x32_bf16 v[68:71], v[196:199], v[148:151], v[68:71]
    v_mfma_f32_16x16x32_bf16 v[72:75], v[196:199], v[152:155], v[72:75]
    v_mfma_f32_16x16x32_bf16 v[76:79], v[196:199], v[156:159], v[76:79]
    buffer_load_dwordx4 v[196:199], v58, s[60:63], s77 offen offset:0 sc1
    s_waitcnt vmcnt(14)
    v_mfma_f32_16x16x32_bf16 v[80:83], v[200:203], v[144:147], v[80:83]
    v_mfma_f32_16x16x32_bf16 v[84:87], v[200:203], v[148:151], v[84:87]
    v_mfma_f32_16x16x32_bf16 v[88:91], v[200:203], v[152:155], v[88:91]
    v_mfma_f32_16x16x32_bf16 v[92:95], v[200:203], v[156:159], v[92:95]
    buffer_load_dwordx4 v[200:203], v58, s[60:63], s77 offen offset:1024 sc1
    s_waitcnt vmcnt(14)
    v_mfma_f32_16x16x32_bf16 v[96:99], v[204:207], v[144:147], v[96:99]
    v_mfma_f32_16x16x32_bf16 v[100:103], v[204:207], v[148:151], v[100:103]
    v_mfma_f32_16x16x32_bf16 v[104:107], v[204:207], v[152:155], v[104:107]
    v_mfma_f32_16x16x32_bf16 v[108:111], v[204:207], v[156:159], v[108:111]
    buffer_load_dwordx4 v[204:207], v58, s[60:63], s77 offen offset:2048 sc1
    s_waitcnt vmcnt(14)
    v_mfma_f32_16x16x32_bf16 v[112:115], v[208:211], v[144:147], v[112:115]
    v_mfma_f32_16x16x32_bf16 v[116:119], v[208:211], v[148:151], v[116:119]
    v_mfma_f32_16x16x32_bf16 v[120:123], v[208:211], v[152:155], v[120:123]
    v_mfma_f32_16x16x32_bf16 v[124:127], v[208:211], v[156:159], v[124:127]
    buffer_load_dwordx4 v[208:211], v58, s[60:63], s77 offen offset:3072 sc1
    s_add_u32 s77, s77, 4096
    s_waitcnt vmcnt(14)
    v_mfma_f32_16x16x32_bf16 v[128:131], v[212:215], v[144:147], v[128:131]
    v_mfma_f32_16x16x32_bf16 v[132:135], v[212:215], v[148:151], v[132:135]
    v_mfma_f32_16x16x32_bf16 v[136:139], v[212:215], v[152:155], v[136:139]
    v_mfma_f32_16x16x32_bf16 v[140:143], v[212:215], v[156:159], v[140:143]
    buffer_load_dwordx4 v[212:215], v58, s[60:63], s77 offen offset:0 sc1
    ds_read_b128 v[144:147], v56 offset:24576
    ds_read_b128 v[148:151], v56 offset:25600
    ds_read_b128 v[152:155], v56 offset:26624
    ds_read_b128 v[156:159], v56 offset:27648
    s_waitcnt lgkmcnt(4)
    s_waitcnt vmcnt(14)
    v_mfma_f32_16x16x32_bf16 v[64:67], v[216:219], v[160:163], v[64:67]
    v_mfma_f32_16x16x32_bf16 v[68:71], v[216:219], v[164:167], v[68:71]
    v_mfma_f32_16x16x32_bf16 v[72:75], v[216:219], v[168:171], v[72:75]
    v_mfma_f32_16x16x32_bf16 v[76:79], v[216:219], v[172:175], v[76:79]
    buffer_load_dwordx4 v[216:219], v58, s[60:63], s77 offen offset:1024 sc1
    s_waitcnt vmcnt(14)
    v_mfma_f32_16x16x32_bf16 v[80:83], v[220:223], v[160:163], v[80:83]
    v_mfma_f32_16x16x32_bf16 v[84:87], v[220:223], v[164:167], v[84:87]
    v_mfma_f32_16x16x32_bf16 v[88:91], v[220:223], v[168:171], v[88:91]
    v_mfma_f32_16x16x32_bf16 v[92:95], v[220:223], v[172:175], v[92:95]
    buffer_load_dwordx4 v[220:223], v58, s[60:63], s77 offen offset:2048 sc1
    s_waitcnt vmcnt(14)
    v_mfma_f32_16x16x32_bf16 v[96:99], v[224:227], v[160:163], v[96:99]
    v_mfma_f32_16x16x32_bf16 v[100:103], v[224:227], v[164:167], v[100:103]
    v_mfma_f32_16x16x32_bf16 v[104:107], v[224:227], v[168:171], v[104:107]
    v_mfma_f32_16x16x32_bf16 v[108:111], v[224:227], v[172:175], v[108:111]
    buffer_load_dwordx4 v[224:227], v58, s[60:63], s77 offen offset:3072 sc1
    s_add_u32 s77, s77, 4096
    s_waitcnt vmcnt(14)
    v_mfma_f32_16x16x32_bf16 v[112:115], v[228:231], v[160:163], v[112:115]
    v_mfma_f32_16x16x32_bf16 v[116:119], v[228:231], v[164:167], v[116:119]
    v_mfma_f32_16x16x32_bf16 v[120:123], v[228:231], v[168:171], v[120:123]
    v_mfma_f32_16x16x32_bf16 v[124:127], v[228:231], v[172:175], v[124:127]
    buffer_load_dwordx4 v[228:231], v58, s[60:63], s77 offen offset:0 sc1
    s_waitcnt vmcnt(14)
    v_mfma_f32_16x16x32_bf16 v[128:131], v[232:235], v[160:163], v[128:131]
    v_mfma_f32_16x16x32_bf16 v[132:135], v[232:235], v[164:167], v[132:135]
    v_mfma_f32_16x16x32_bf16 v[136:139], v[232:235], v[168:171], v[136:139]
    v_mfma_f32_16x16x32_bf16 v[140:143], v[232:235], v[172:175], v[140:143]
    buffer_load_dwordx4 v[232:235], v58, s[60:63], s77 offen offset:1024 sc1
    s_add_u32 s77, s77, 2048
    v_add_u32 v56, 24576, v56
    v_add_u32 v57, 24576, v57
    s_barrier
    s_lshr_b32 s72, s5, 1
    s_lshl_b32 s73, s72, 8
    s_add_u32 s73, s73, s2
    s_mul_i32 s74, s72, 18560
    s_add_u32 s74, s74, 73728
    s_mul_i32 s75, s72, 4608
    s_add_u32 s75, s75, 147712
    s_and_b32 s76, s5, 1
    s_lshl_b32 s76, s76, 1
    s_lshl_b32 s6, s73, 12
    s_lshl_b32 s7, s76, 10
    s_add_u32 s6, s6, s7
    s_add_u32 s6, s6, 10616824
    v_lshlrev_b32 v2, 4, v1
    buffer_load_dwordx2 v[18:19], v2, s[52:55], s6 offen offset:0 sc1
    buffer_load_dwordx4 v[20:23], v2, s[52:55], s6 offen offset:8 sc1
    buffer_load_dwordx2 v[26:27], v2, s[52:55], s6 offen offset:1024 sc1
    buffer_load_dwordx4 v[28:31], v2, s[52:55], s6 offen offset:1032 sc1
    ds_read_b128 v[160:163], v57 offset:4096
    ds_read_b128 v[164:167], v57 offset:5120
    ds_read_b128 v[168:171], v57 offset:6144
    ds_read_b128 v[172:175], v57 offset:7168
    s_waitcnt lgkmcnt(4)
    s_waitcnt vmcnt(14)
    v_mfma_f32_16x16x32_bf16 v[64:67], v[176:179], v[144:147], v[64:67]
    v_mfma_f32_16x16x32_bf16 v[68:71], v[176:179], v[148:151], v[68:71]
    v_mfma_f32_16x16x32_bf16 v[72:75], v[176:179], v[152:155], v[72:75]
    v_mfma_f32_16x16x32_bf16 v[76:79], v[176:179], v[156:159], v[76:79]
    buffer_load_dwordx4 v[176:179], v58, s[60:63], s77 offen offset:0 sc1
    s_waitcnt vmcnt(14)
    v_mfma_f32_16x16x32_bf16 v[80:83], v[180:183], v[144:147], v[80:83]
    v_mfma_f32_16x16x32_bf16 v[84:87], v[180:183], v[148:151], v[84:87]
    v_mfma_f32_16x16x32_bf16 v[88:91], v[180:183], v[152:155], v[88:91]
    v_mfma_f32_16x16x32_bf16 v[92:95], v[180:183], v[156:159], v[92:95]
    buffer_load_dwordx4 v[180:183], v58, s[60:63], s77 offen offset:1024 sc1
    s_waitcnt vmcnt(14)
    v_mfma_f32_16x16x32_bf16 v[96:99], v[184:187], v[144:147], v[96:99]
    v_mfma_f32_16x16x32_bf16 v[100:103], v[184:187], v[148:151], v[100:103]
    v_mfma_f32_16x16x32_bf16 v[104:107], v[184:187], v[152:155], v[104:107]
    v_mfma_f32_16x16x32_bf16 v[108:111], v[184:187], v[156:159], v[108:111]
    buffer_load_dwordx4 v[184:187], v58, s[60:63], s77 offen offset:2048 sc1
    s_waitcnt vmcnt(14)
    v_mfma_f32_16x16x32_bf16 v[112:115], v[188:191], v[144:147], v[112:115]
    v_mfma_f32_16x16x32_bf16 v[116:119], v[188:191], v[148:151], v[116:119]
    v_mfma_f32_16x16x32_bf16 v[120:123], v[188:191], v[152:155], v[120:123]
    v_mfma_f32_16x16x32_bf16 v[124:127], v[188:191], v[156:159], v[124:127]
    buffer_load_dwordx4 v[188:191], v58, s[60:63], s77 offen offset:3072 sc1
    s_add_u32 s77, s77, 4096
    s_waitcnt vmcnt(14)
    v_mfma_f32_16x16x32_bf16 v[128:131], v[192:195], v[144:147], v[128:131]
    v_mfma_f32_16x16x32_bf16 v[132:135], v[192:195], v[148:151], v[132:135]
    v_mfma_f32_16x16x32_bf16 v[136:139], v[192:195], v[152:155], v[136:139]
    v_mfma_f32_16x16x32_bf16 v[140:143], v[192:195], v[156:159], v[140:143]
    buffer_load_dwordx4 v[192:195], v58, s[60:63], s77 offen offset:0 sc1
    ds_read_b128 v[144:147], v56 offset:8192
    ds_read_b128 v[148:151], v56 offset:9216
    ds_read_b128 v[152:155], v56 offset:10240
    ds_read_b128 v[156:159], v56 offset:11264
    s_waitcnt lgkmcnt(4)
    s_waitcnt vmcnt(14)
    v_mfma_f32_16x16x32_bf16 v[64:67], v[196:199], v[160:163], v[64:67]
    v_mfma_f32_16x16x32_bf16 v[68:71], v[196:199], v[164:167], v[68:71]
    v_mfma_f32_16x16x32_bf16 v[72:75], v[196:199], v[168:171], v[72:75]
    v_mfma_f32_16x16x32_bf16 v[76:79], v[196:199], v[172:175], v[76:79]
    buffer_load_dwordx4 v[196:199], v58, s[60:63], s77 offen offset:1024 sc1
    s_waitcnt vmcnt(14)
    v_mfma_f32_16x16x32_bf16 v[80:83], v[200:203], v[160:163], v[80:83]
    v_mfma_f32_16x16x32_bf16 v[84:87], v[200:203], v[164:167], v[84:87]
    v_mfma_f32_16x16x32_bf16 v[88:91], v[200:203], v[168:171], v[88:91]
    v_mfma_f32_16x16x32_bf16 v[92:95], v[200:203], v[172:175], v[92:95]
    buffer_load_dwordx4 v[200:203], v58, s[60:63], s77 offen offset:2048 sc1
    s_waitcnt vmcnt(14)
    v_mfma_f32_16x16x32_bf16 v[96:99], v[204:207], v[160:163], v[96:99]
    v_mfma_f32_16x16x32_bf16 v[100:103], v[204:207], v[164:167], v[100:103]
    v_mfma_f32_16x16x32_bf16 v[104:107], v[204:207], v[168:171], v[104:107]
    v_mfma_f32_16x16x32_bf16 v[108:111], v[204:207], v[172:175], v[108:111]
    buffer_load_dwordx4 v[204:207], v58, s[60:63], s77 offen offset:3072 sc1
    s_add_u32 s77, s77, 4096
    s_waitcnt vmcnt(14)
    v_mfma_f32_16x16x32_bf16 v[112:115], v[208:211], v[160:163], v[112:115]
    v_mfma_f32_16x16x32_bf16 v[116:119], v[208:211], v[164:167], v[116:119]
    v_mfma_f32_16x16x32_bf16 v[120:123], v[208:211], v[168:171], v[120:123]
    v_mfma_f32_16x16x32_bf16 v[124:127], v[208:211], v[172:175], v[124:127]
    buffer_load_dwordx4 v[208:211], v58, s[60:63], s77 offen offset:0 sc1
    s_waitcnt vmcnt(14)
    v_mfma_f32_16x16x32_bf16 v[128:131], v[212:215], v[160:163], v[128:131]
    v_mfma_f32_16x16x32_bf16 v[132:135], v[212:215], v[164:167], v[132:135]
    v_mfma_f32_16x16x32_bf16 v[136:139], v[212:215], v[168:171], v[136:139]
    v_mfma_f32_16x16x32_bf16 v[140:143], v[212:215], v[172:175], v[140:143]
    buffer_load_dwordx4 v[212:215], v58, s[60:63], s77 offen offset:1024 sc1
    ds_read_b128 v[160:163], v57 offset:12288
    ds_read_b128 v[164:167], v57 offset:13312
    ds_read_b128 v[168:171], v57 offset:14336
    ds_read_b128 v[172:175], v57 offset:15360
    s_waitcnt lgkmcnt(4)
    s_waitcnt vmcnt(14)
    v_mfma_f32_16x16x32_bf16 v[64:67], v[216:219], v[144:147], v[64:67]
    v_mfma_f32_16x16x32_bf16 v[68:71], v[216:219], v[148:151], v[68:71]
    v_mfma_f32_16x16x32_bf16 v[72:75], v[216:219], v[152:155], v[72:75]
    v_mfma_f32_16x16x32_bf16 v[76:79], v[216:219], v[156:159], v[76:79]
    buffer_load_dwordx4 v[216:219], v58, s[60:63], s77 offen offset:2048 sc1
    s_waitcnt vmcnt(14)
    v_mfma_f32_16x16x32_bf16 v[80:83], v[220:223], v[144:147], v[80:83]
    v_mfma_f32_16x16x32_bf16 v[84:87], v[220:223], v[148:151], v[84:87]
    v_mfma_f32_16x16x32_bf16 v[88:91], v[220:223], v[152:155], v[88:91]
    v_mfma_f32_16x16x32_bf16 v[92:95], v[220:223], v[156:159], v[92:95]
    buffer_load_dwordx4 v[220:223], v58, s[60:63], s77 offen offset:3072 sc1
    s_add_u32 s77, s77, 4096
    s_waitcnt vmcnt(14)
    v_mfma_f32_16x16x32_bf16 v[96:99], v[224:227], v[144:147], v[96:99]
    v_mfma_f32_16x16x32_bf16 v[100:103], v[224:227], v[148:151], v[100:103]
    v_mfma_f32_16x16x32_bf16 v[104:107], v[224:227], v[152:155], v[104:107]
    v_mfma_f32_16x16x32_bf16 v[108:111], v[224:227], v[156:159], v[108:111]
    buffer_load_dwordx4 v[224:227], v58, s[60:63], s77 offen offset:0 sc1
    s_waitcnt vmcnt(14)
    v_mfma_f32_16x16x32_bf16 v[112:115], v[228:231], v[144:147], v[112:115]
    v_mfma_f32_16x16x32_bf16 v[116:119], v[228:231], v[148:151], v[116:119]
    v_mfma_f32_16x16x32_bf16 v[120:123], v[228:231], v[152:155], v[120:123]
    v_mfma_f32_16x16x32_bf16 v[124:127], v[228:231], v[156:159], v[124:127]
    buffer_load_dwordx4 v[228:231], v58, s[60:63], s77 offen offset:1024 sc1
    s_waitcnt vmcnt(14)
    v_mfma_f32_16x16x32_bf16 v[128:131], v[232:235], v[144:147], v[128:131]
    v_mfma_f32_16x16x32_bf16 v[132:135], v[232:235], v[148:151], v[132:135]
    v_mfma_f32_16x16x32_bf16 v[136:139], v[232:235], v[152:155], v[136:139]
    v_mfma_f32_16x16x32_bf16 v[140:143], v[232:235], v[156:159], v[140:143]
    buffer_load_dwordx4 v[232:235], v58, s[60:63], s77 offen offset:2048 sc1
    ds_read_b128 v[144:147], v56 offset:16384
    ds_read_b128 v[148:151], v56 offset:17408
    ds_read_b128 v[152:155], v56 offset:18432
    ds_read_b128 v[156:159], v56 offset:19456
    s_waitcnt lgkmcnt(4)
    s_waitcnt vmcnt(14)
    v_mfma_f32_16x16x32_bf16 v[64:67], v[176:179], v[160:163], v[64:67]
    v_mfma_f32_16x16x32_bf16 v[68:71], v[176:179], v[164:167], v[68:71]
    v_mfma_f32_16x16x32_bf16 v[72:75], v[176:179], v[168:171], v[72:75]
    v_mfma_f32_16x16x32_bf16 v[76:79], v[176:179], v[172:175], v[76:79]
    buffer_load_dwordx4 v[176:179], v58, s[60:63], s77 offen offset:3072 sc1
    s_add_u32 s77, s77, 4096
    s_waitcnt vmcnt(14)
    v_mfma_f32_16x16x32_bf16 v[80:83], v[180:183], v[160:163], v[80:83]
    v_mfma_f32_16x16x32_bf16 v[84:87], v[180:183], v[164:167], v[84:87]
    v_mfma_f32_16x16x32_bf16 v[88:91], v[180:183], v[168:171], v[88:91]
    v_mfma_f32_16x16x32_bf16 v[92:95], v[180:183], v[172:175], v[92:95]
    buffer_load_dwordx4 v[180:183], v58, s[60:63], s77 offen offset:0 sc1
    s_waitcnt vmcnt(14)
    v_mfma_f32_16x16x32_bf16 v[96:99], v[184:187], v[160:163], v[96:99]
    v_mfma_f32_16x16x32_bf16 v[100:103], v[184:187], v[164:167], v[100:103]
    v_mfma_f32_16x16x32_bf16 v[104:107], v[184:187], v[168:171], v[104:107]
    v_mfma_f32_16x16x32_bf16 v[108:111], v[184:187], v[172:175], v[108:111]
    buffer_load_dwordx4 v[184:187], v58, s[60:63], s77 offen offset:1024 sc1
    s_waitcnt vmcnt(14)
    v_mfma_f32_16x16x32_bf16 v[112:115], v[188:191], v[160:163], v[112:115]
    v_mfma_f32_16x16x32_bf16 v[116:119], v[188:191], v[164:167], v[116:119]
    v_mfma_f32_16x16x32_bf16 v[120:123], v[188:191], v[168:171], v[120:123]
    v_mfma_f32_16x16x32_bf16 v[124:127], v[188:191], v[172:175], v[124:127]
    buffer_load_dwordx4 v[188:191], v58, s[60:63], s77 offen offset:2048 sc1
    s_waitcnt vmcnt(14)
    v_mfma_f32_16x16x32_bf16 v[128:131], v[192:195], v[160:163], v[128:131]
    v_mfma_f32_16x16x32_bf16 v[132:135], v[192:195], v[164:167], v[132:135]
    v_mfma_f32_16x16x32_bf16 v[136:139], v[192:195], v[168:171], v[136:139]
    v_mfma_f32_16x16x32_bf16 v[140:143], v[192:195], v[172:175], v[140:143]
    buffer_load_dwordx4 v[192:195], v58, s[60:63], s77 offen offset:3072 sc1
    s_add_u32 s77, s77, 4096
    ds_read_b128 v[160:163], v57 offset:20480
    ds_read_b128 v[164:167], v57 offset:21504
    ds_read_b128 v[168:171], v57 offset:22528
    ds_read_b128 v[172:175], v57 offset:23552
    s_waitcnt lgkmcnt(4)
    s_waitcnt vmcnt(14)
    v_mfma_f32_16x16x32_bf16 v[64:67], v[196:199], v[144:147], v[64:67]
    v_mfma_f32_16x16x32_bf16 v[68:71], v[196:199], v[148:151], v[68:71]
    v_mfma_f32_16x16x32_bf16 v[72:75], v[196:199], v[152:155], v[72:75]
    v_mfma_f32_16x16x32_bf16 v[76:79], v[196:199], v[156:159], v[76:79]
    buffer_load_dwordx4 v[196:199], v58, s[60:63], s77 offen offset:0 sc1
    s_waitcnt vmcnt(14)
    v_mfma_f32_16x16x32_bf16 v[80:83], v[200:203], v[144:147], v[80:83]
    v_mfma_f32_16x16x32_bf16 v[84:87], v[200:203], v[148:151], v[84:87]
    v_mfma_f32_16x16x32_bf16 v[88:91], v[200:203], v[152:155], v[88:91]
    v_mfma_f32_16x16x32_bf16 v[92:95], v[200:203], v[156:159], v[92:95]
    buffer_load_dwordx4 v[200:203], v58, s[60:63], s77 offen offset:1024 sc1
    s_waitcnt vmcnt(14)
    v_mfma_f32_16x16x32_bf16 v[96:99], v[204:207], v[144:147], v[96:99]
    v_mfma_f32_16x16x32_bf16 v[100:103], v[204:207], v[148:151], v[100:103]
    v_mfma_f32_16x16x32_bf16 v[104:107], v[204:207], v[152:155], v[104:107]
    v_mfma_f32_16x16x32_bf16 v[108:111], v[204:207], v[156:159], v[108:111]
    buffer_load_dwordx4 v[204:207], v58, s[60:63], s77 offen offset:2048 sc1
    s_waitcnt vmcnt(14)
    v_mfma_f32_16x16x32_bf16 v[112:115], v[208:211], v[144:147], v[112:115]
    v_mfma_f32_16x16x32_bf16 v[116:119], v[208:211], v[148:151], v[116:119]
    v_mfma_f32_16x16x32_bf16 v[120:123], v[208:211], v[152:155], v[120:123]
    v_mfma_f32_16x16x32_bf16 v[124:127], v[208:211], v[156:159], v[124:127]
    buffer_load_dwordx4 v[208:211], v58, s[60:63], s77 offen offset:3072 sc1
    s_add_u32 s77, s77, 4096
    s_waitcnt vmcnt(14)
    v_mfma_f32_16x16x32_bf16 v[128:131], v[212:215], v[144:147], v[128:131]
    v_mfma_f32_16x16x32_bf16 v[132:135], v[212:215], v[148:151], v[132:135]
    v_mfma_f32_16x16x32_bf16 v[136:139], v[212:215], v[152:155], v[136:139]
    v_mfma_f32_16x16x32_bf16 v[140:143], v[212:215], v[156:159], v[140:143]
    buffer_load_dwordx4 v[212:215], v58, s[60:63], s77 offen offset:0 sc1
    ds_read_b128 v[144:147], v56 offset:24576
    ds_read_b128 v[148:151], v56 offset:25600
    ds_read_b128 v[152:155], v56 offset:26624
    ds_read_b128 v[156:159], v56 offset:27648
    s_waitcnt lgkmcnt(4)
    s_waitcnt vmcnt(14)
    v_mfma_f32_16x16x32_bf16 v[64:67], v[216:219], v[160:163], v[64:67]
    v_mfma_f32_16x16x32_bf16 v[68:71], v[216:219], v[164:167], v[68:71]
    v_mfma_f32_16x16x32_bf16 v[72:75], v[216:219], v[168:171], v[72:75]
    v_mfma_f32_16x16x32_bf16 v[76:79], v[216:219], v[172:175], v[76:79]
    buffer_load_dwordx4 v[216:219], v58, s[60:63], s77 offen offset:1024 sc1
    s_waitcnt vmcnt(14)
    v_mfma_f32_16x16x32_bf16 v[80:83], v[220:223], v[160:163], v[80:83]
    v_mfma_f32_16x16x32_bf16 v[84:87], v[220:223], v[164:167], v[84:87]
    v_mfma_f32_16x16x32_bf16 v[88:91], v[220:223], v[168:171], v[88:91]
    v_mfma_f32_16x16x32_bf16 v[92:95], v[220:223], v[172:175], v[92:95]
    buffer_load_dwordx4 v[220:223], v58, s[60:63], s77 offen offset:2048 sc1
    s_waitcnt vmcnt(14)
    v_mfma_f32_16x16x32_bf16 v[96:99], v[224:227], v[160:163], v[96:99]
    v_mfma_f32_16x16x32_bf16 v[100:103], v[224:227], v[164:167], v[100:103]
    v_mfma_f32_16x16x32_bf16 v[104:107], v[224:227], v[168:171], v[104:107]
    v_mfma_f32_16x16x32_bf16 v[108:111], v[224:227], v[172:175], v[108:111]
    buffer_load_dwordx4 v[224:227], v58, s[60:63], s77 offen offset:3072 sc1
    s_add_u32 s77, s77, 4096
    s_waitcnt vmcnt(14)
    v_mfma_f32_16x16x32_bf16 v[112:115], v[228:231], v[160:163], v[112:115]
    v_mfma_f32_16x16x32_bf16 v[116:119], v[228:231], v[164:167], v[116:119]
    v_mfma_f32_16x16x32_bf16 v[120:123], v[228:231], v[168:171], v[120:123]
    v_mfma_f32_16x16x32_bf16 v[124:127], v[228:231], v[172:175], v[124:127]
    buffer_load_dwordx4 v[228:231], v58, s[60:63], s77 offen offset:0 sc1
    s_waitcnt vmcnt(14)
    v_mfma_f32_16x16x32_bf16 v[128:131], v[232:235], v[160:163], v[128:131]
    v_mfma_f32_16x16x32_bf16 v[132:135], v[232:235], v[164:167], v[132:135]
    v_mfma_f32_16x16x32_bf16 v[136:139], v[232:235], v[168:171], v[136:139]
    v_mfma_f32_16x16x32_bf16 v[140:143], v[232:235], v[172:175], v[140:143]
    buffer_load_dwordx4 v[232:235], v58, s[60:63], s77 offen offset:1024 sc1
    s_add_u32 s77, s77, 2048
    v_add_u32 v56, 24576, v56
    v_add_u32 v57, 24576, v57
    ds_read_b128 v[160:163], v57 offset:4096
    ds_read_b128 v[164:167], v57 offset:5120
    ds_read_b128 v[168:171], v57 offset:6144
    ds_read_b128 v[172:175], v57 offset:7168
    s_waitcnt lgkmcnt(4)
    s_waitcnt vmcnt(14)
    v_mfma_f32_16x16x32_bf16 v[64:67], v[176:179], v[144:147], v[64:67]
    v_mfma_f32_16x16x32_bf16 v[68:71], v[176:179], v[148:151], v[68:71]
    v_mfma_f32_16x16x32_bf16 v[72:75], v[176:179], v[152:155], v[72:75]
    v_mfma_f32_16x16x32_bf16 v[76:79], v[176:179], v[156:159], v[76:79]
    buffer_load_dwordx4 v[176:179], v58, s[60:63], s77 offen offset:0 sc1
    s_waitcnt vmcnt(14)
    v_mfma_f32_16x16x32_bf16 v[80:83], v[180:183], v[144:147], v[80:83]
    v_mfma_f32_16x16x32_bf16 v[84:87], v[180:183], v[148:151], v[84:87]
    v_mfma_f32_16x16x32_bf16 v[88:91], v[180:183], v[152:155], v[88:91]
    v_mfma_f32_16x16x32_bf16 v[92:95], v[180:183], v[156:159], v[92:95]
    buffer_load_dwordx4 v[180:183], v58, s[60:63], s77 offen offset:1024 sc1
    s_waitcnt vmcnt(14)
    v_mfma_f32_16x16x32_bf16 v[96:99], v[184:187], v[144:147], v[96:99]
    v_mfma_f32_16x16x32_bf16 v[100:103], v[184:187], v[148:151], v[100:103]
    v_mfma_f32_16x16x32_bf16 v[104:107], v[184:187], v[152:155], v[104:107]
    v_mfma_f32_16x16x32_bf16 v[108:111], v[184:187], v[156:159], v[108:111]
    buffer_load_dwordx4 v[184:187], v58, s[60:63], s77 offen offset:2048 sc1
    s_waitcnt vmcnt(14)
    v_mfma_f32_16x16x32_bf16 v[112:115], v[188:191], v[144:147], v[112:115]
    v_mfma_f32_16x16x32_bf16 v[116:119], v[188:191], v[148:151], v[116:119]
    v_mfma_f32_16x16x32_bf16 v[120:123], v[188:191], v[152:155], v[120:123]
    v_mfma_f32_16x16x32_bf16 v[124:127], v[188:191], v[156:159], v[124:127]
    buffer_load_dwordx4 v[188:191], v58, s[60:63], s77 offen offset:3072 sc1
    s_add_u32 s77, s77, 4096
    s_waitcnt vmcnt(14)
    v_mfma_f32_16x16x32_bf16 v[128:131], v[192:195], v[144:147], v[128:131]
    v_mfma_f32_16x16x32_bf16 v[132:135], v[192:195], v[148:151], v[132:135]
    v_mfma_f32_16x16x32_bf16 v[136:139], v[192:195], v[152:155], v[136:139]
    v_mfma_f32_16x16x32_bf16 v[140:143], v[192:195], v[156:159], v[140:143]
    buffer_load_dwordx4 v[192:195], v58, s[60:63], s77 offen offset:0 sc1
    ds_read_b128 v[144:147], v56 offset:8192
    ds_read_b128 v[148:151], v56 offset:9216
    ds_read_b128 v[152:155], v56 offset:10240
    ds_read_b128 v[156:159], v56 offset:11264
    s_waitcnt lgkmcnt(4)
    s_waitcnt vmcnt(14)
    v_mfma_f32_16x16x32_bf16 v[64:67], v[196:199], v[160:163], v[64:67]
    v_mfma_f32_16x16x32_bf16 v[68:71], v[196:199], v[164:167], v[68:71]
    v_mfma_f32_16x16x32_bf16 v[72:75], v[196:199], v[168:171], v[72:75]
    v_mfma_f32_16x16x32_bf16 v[76:79], v[196:199], v[172:175], v[76:79]
    buffer_load_dwordx4 v[196:199], v58, s[60:63], s77 offen offset:1024 sc1
    s_waitcnt vmcnt(14)
    v_mfma_f32_16x16x32_bf16 v[80:83], v[200:203], v[160:163], v[80:83]
    v_mfma_f32_16x16x32_bf16 v[84:87], v[200:203], v[164:167], v[84:87]
    v_mfma_f32_16x16x32_bf16 v[88:91], v[200:203], v[168:171], v[88:91]
    v_mfma_f32_16x16x32_bf16 v[92:95], v[200:203], v[172:175], v[92:95]
    buffer_load_dwordx4 v[200:203], v58, s[60:63], s77 offen offset:2048 sc1
    s_waitcnt vmcnt(14)
    v_mfma_f32_16x16x32_bf16 v[96:99], v[204:207], v[160:163], v[96:99]
    v_mfma_f32_16x16x32_bf16 v[100:103], v[204:207], v[164:167], v[100:103]
    v_mfma_f32_16x16x32_bf16 v[104:107], v[204:207], v[168:171], v[104:107]
    v_mfma_f32_16x16x32_bf16 v[108:111], v[204:207], v[172:175], v[108:111]
    buffer_load_dwordx4 v[204:207], v58, s[60:63], s77 offen offset:3072 sc1
    s_add_u32 s77, s77, 4096
    s_waitcnt vmcnt(14)
    v_mfma_f32_16x16x32_bf16 v[112:115], v[208:211], v[160:163], v[112:115]
    v_mfma_f32_16x16x32_bf16 v[116:119], v[208:211], v[164:167], v[116:119]
    v_mfma_f32_16x16x32_bf16 v[120:123], v[208:211], v[168:171], v[120:123]
    v_mfma_f32_16x16x32_bf16 v[124:127], v[208:211], v[172:175], v[124:127]
    buffer_load_dwordx4 v[208:211], v58, s[60:63], s77 offen offset:0 sc1
    s_waitcnt vmcnt(14)
    v_mfma_f32_16x16x32_bf16 v[128:131], v[212:215], v[160:163], v[128:131]
    v_mfma_f32_16x16x32_bf16 v[132:135], v[212:215], v[164:167], v[132:135]
    v_mfma_f32_16x16x32_bf16 v[136:139], v[212:215], v[168:171], v[136:139]
    v_mfma_f32_16x16x32_bf16 v[140:143], v[212:215], v[172:175], v[140:143]
    buffer_load_dwordx4 v[212:215], v58, s[60:63], s77 offen offset:1024 sc1
    ds_read_b128 v[160:163], v57 offset:12288
    ds_read_b128 v[164:167], v57 offset:13312
    ds_read_b128 v[168:171], v57 offset:14336
    ds_read_b128 v[172:175], v57 offset:15360
    s_waitcnt lgkmcnt(4)
    s_waitcnt vmcnt(14)
    v_mfma_f32_16x16x32_bf16 v[64:67], v[216:219], v[144:147], v[64:67]
    v_mfma_f32_16x16x32_bf16 v[68:71], v[216:219], v[148:151], v[68:71]
    v_mfma_f32_16x16x32_bf16 v[72:75], v[216:219], v[152:155], v[72:75]
    v_mfma_f32_16x16x32_bf16 v[76:79], v[216:219], v[156:159], v[76:79]
    buffer_load_dwordx4 v[216:219], v58, s[60:63], s77 offen offset:2048 sc1
    s_waitcnt vmcnt(14)
    v_mfma_f32_16x16x32_bf16 v[80:83], v[220:223], v[144:147], v[80:83]
    v_mfma_f32_16x16x32_bf16 v[84:87], v[220:223], v[148:151], v[84:87]
    v_mfma_f32_16x16x32_bf16 v[88:91], v[220:223], v[152:155], v[88:91]
    v_mfma_f32_16x16x32_bf16 v[92:95], v[220:223], v[156:159], v[92:95]
    buffer_load_dwordx4 v[220:223], v58, s[60:63], s77 offen offset:3072 sc1
    s_add_u32 s77, s77, 4096
    s_waitcnt vmcnt(14)
    v_mfma_f32_16x16x32_bf16 v[96:99], v[224:227], v[144:147], v[96:99]
    v_mfma_f32_16x16x32_bf16 v[100:103], v[224:227], v[148:151], v[100:103]
    v_mfma_f32_16x16x32_bf16 v[104:107], v[224:227], v[152:155], v[104:107]
    v_mfma_f32_16x16x32_bf16 v[108:111], v[224:227], v[156:159], v[108:111]
    buffer_load_dwordx4 v[224:227], v58, s[60:63], s77 offen offset:0 sc1
    s_waitcnt vmcnt(14)
    v_mfma_f32_16x16x32_bf16 v[112:115], v[228:231], v[144:147], v[112:115]
    v_mfma_f32_16x16x32_bf16 v[116:119], v[228:231], v[148:151], v[116:119]
    v_mfma_f32_16x16x32_bf16 v[120:123], v[228:231], v[152:155], v[120:123]
    v_mfma_f32_16x16x32_bf16 v[124:127], v[228:231], v[156:159], v[124:127]
    buffer_load_dwordx4 v[228:231], v58, s[60:63], s77 offen offset:1024 sc1
    s_waitcnt vmcnt(14)
    v_mfma_f32_16x16x32_bf16 v[128:131], v[232:235], v[144:147], v[128:131]
    v_mfma_f32_16x16x32_bf16 v[132:135], v[232:235], v[148:151], v[132:135]
    v_mfma_f32_16x16x32_bf16 v[136:139], v[232:235], v[152:155], v[136:139]
    v_mfma_f32_16x16x32_bf16 v[140:143], v[232:235], v[156:159], v[140:143]
    buffer_load_dwordx4 v[232:235], v58, s[60:63], s77 offen offset:2048 sc1
    ds_read_b128 v[144:147], v56 offset:16384
    ds_read_b128 v[148:151], v56 offset:17408
    ds_read_b128 v[152:155], v56 offset:18432
    ds_read_b128 v[156:159], v56 offset:19456
    s_waitcnt lgkmcnt(4)
    s_waitcnt vmcnt(14)
    v_mfma_f32_16x16x32_bf16 v[64:67], v[176:179], v[160:163], v[64:67]
    v_mfma_f32_16x16x32_bf16 v[68:71], v[176:179], v[164:167], v[68:71]
    v_mfma_f32_16x16x32_bf16 v[72:75], v[176:179], v[168:171], v[72:75]
    v_mfma_f32_16x16x32_bf16 v[76:79], v[176:179], v[172:175], v[76:79]
    s_waitcnt vmcnt(13)
    v_mfma_f32_16x16x32_bf16 v[80:83], v[180:183], v[160:163], v[80:83]
    v_mfma_f32_16x16x32_bf16 v[84:87], v[180:183], v[164:167], v[84:87]
    v_mfma_f32_16x16x32_bf16 v[88:91], v[180:183], v[168:171], v[88:91]
    v_mfma_f32_16x16x32_bf16 v[92:95], v[180:183], v[172:175], v[92:95]
    s_waitcnt vmcnt(12)
    v_mfma_f32_16x16x32_bf16 v[96:99], v[184:187], v[160:163], v[96:99]
    v_mfma_f32_16x16x32_bf16 v[100:103], v[184:187], v[164:167], v[100:103]
    v_mfma_f32_16x16x32_bf16 v[104:107], v[184:187], v[168:171], v[104:107]
    v_mfma_f32_16x16x32_bf16 v[108:111], v[184:187], v[172:175], v[108:111]
    s_waitcnt vmcnt(11)
    v_mfma_f32_16x16x32_bf16 v[112:115], v[188:191], v[160:163], v[112:115]
    v_mfma_f32_16x16x32_bf16 v[116:119], v[188:191], v[164:167], v[116:119]
    v_mfma_f32_16x16x32_bf16 v[120:123], v[188:191], v[168:171], v[120:123]
    v_mfma_f32_16x16x32_bf16 v[124:127], v[188:191], v[172:175], v[124:127]
    s_waitcnt vmcnt(10)
    v_mfma_f32_16x16x32_bf16 v[128:131], v[192:195], v[160:163], v[128:131]
    v_mfma_f32_16x16x32_bf16 v[132:135], v[192:195], v[164:167], v[132:135]
    v_mfma_f32_16x16x32_bf16 v[136:139], v[192:195], v[168:171], v[136:139]
    v_mfma_f32_16x16x32_bf16 v[140:143], v[192:195], v[172:175], v[140:143]
    ds_read_b128 v[160:163], v57 offset:20480
    ds_read_b128 v[164:167], v57 offset:21504
    ds_read_b128 v[168:171], v57 offset:22528
    ds_read_b128 v[172:175], v57 offset:23552
    s_waitcnt lgkmcnt(4)
    s_waitcnt vmcnt(9)
    v_mfma_f32_16x16x32_bf16 v[64:67], v[196:199], v[144:147], v[64:67]
    v_mfma_f32_16x16x32_bf16 v[68:71], v[196:199], v[148:151], v[68:71]
    v_mfma_f32_16x16x32_bf16 v[72:75], v[196:199], v[152:155], v[72:75]
    v_mfma_f32_16x16x32_bf16 v[76:79], v[196:199], v[156:159], v[76:79]
    s_waitcnt vmcnt(8)
    v_mfma_f32_16x16x32_bf16 v[80:83], v[200:203], v[144:147], v[80:83]
    v_mfma_f32_16x16x32_bf16 v[84:87], v[200:203], v[148:151], v[84:87]
    v_mfma_f32_16x16x32_bf16 v[88:91], v[200:203], v[152:155], v[88:91]
    v_mfma_f32_16x16x32_bf16 v[92:95], v[200:203], v[156:159], v[92:95]
    s_waitcnt vmcnt(7)
    v_mfma_f32_16x16x32_bf16 v[96:99], v[204:207], v[144:147], v[96:99]
    v_mfma_f32_16x16x32_bf16 v[100:103], v[204:207], v[148:151], v[100:103]
    v_mfma_f32_16x16x32_bf16 v[104:107], v[204:207], v[152:155], v[104:107]
    v_mfma_f32_16x16x32_bf16 v[108:111], v[204:207], v[156:159], v[108:111]
    s_waitcnt vmcnt(6)
    v_mfma_f32_16x16x32_bf16 v[112:115], v[208:211], v[144:147], v[112:115]
    v_mfma_f32_16x16x32_bf16 v[116:119], v[208:211], v[148:151], v[116:119]
    v_mfma_f32_16x16x32_bf16 v[120:123], v[208:211], v[152:155], v[120:123]
    v_mfma_f32_16x16x32_bf16 v[124:127], v[208:211], v[156:159], v[124:127]
    s_waitcnt vmcnt(5)
    v_mfma_f32_16x16x32_bf16 v[128:131], v[212:215], v[144:147], v[128:131]
    v_mfma_f32_16x16x32_bf16 v[132:135], v[212:215], v[148:151], v[132:135]
    v_mfma_f32_16x16x32_bf16 v[136:139], v[212:215], v[152:155], v[136:139]
    v_mfma_f32_16x16x32_bf16 v[140:143], v[212:215], v[156:159], v[140:143]
    s_waitcnt lgkmcnt(0)
    s_waitcnt vmcnt(4)
    v_mfma_f32_16x16x32_bf16 v[64:67], v[216:219], v[160:163], v[64:67]
    v_mfma_f32_16x16x32_bf16 v[68:71], v[216:219], v[164:167], v[68:71]
    v_mfma_f32_16x16x32_bf16 v[72:75], v[216:219], v[168:171], v[72:75]
    v_mfma_f32_16x16x32_bf16 v[76:79], v[216:219], v[172:175], v[76:79]
    s_waitcnt vmcnt(3)
    v_mfma_f32_16x16x32_bf16 v[80:83], v[220:223], v[160:163], v[80:83]
    v_mfma_f32_16x16x32_bf16 v[84:87], v[220:223], v[164:167], v[84:87]
    v_mfma_f32_16x16x32_bf16 v[88:91], v[220:223], v[168:171], v[88:91]
    v_mfma_f32_16x16x32_bf16 v[92:95], v[220:223], v[172:175], v[92:95]
    s_waitcnt vmcnt(2)
    v_mfma_f32_16x16x32_bf16 v[96:99], v[224:227], v[160:163], v[96:99]
    v_mfma_f32_16x16x32_bf16 v[100:103], v[224:227], v[164:167], v[100:103]
    v_mfma_f32_16x16x32_bf16 v[104:107], v[224:227], v[168:171], v[104:107]
    v_mfma_f32_16x16x32_bf16 v[108:111], v[224:227], v[172:175], v[108:111]
    s_waitcnt vmcnt(1)
    v_mfma_f32_16x16x32_bf16 v[112:115], v[228:231], v[160:163], v[112:115]
    v_mfma_f32_16x16x32_bf16 v[116:119], v[228:231], v[164:167], v[116:119]
    v_mfma_f32_16x16x32_bf16 v[120:123], v[228:231], v[168:171], v[120:123]
    v_mfma_f32_16x16x32_bf16 v[124:127], v[228:231], v[172:175], v[124:127]
    s_waitcnt vmcnt(0)
    v_mfma_f32_16x16x32_bf16 v[128:131], v[232:235], v[160:163], v[128:131]
    v_mfma_f32_16x16x32_bf16 v[132:135], v[232:235], v[164:167], v[132:135]
    v_mfma_f32_16x16x32_bf16 v[136:139], v[232:235], v[168:171], v[136:139]
    v_mfma_f32_16x16x32_bf16 v[140:143], v[232:235], v[172:175], v[140:143]
    s_add_u32 s77, s77, 3072
    s_mul_i32 s72, s4, 9
    s_lshr_b32 s72, s72, 1
    s_lshl_b32 s73, s3, 3
    s_add_u32 s73, s73, s4
    s_mul_i32 s73, s73, 73728
    s_add_u32 s73, s73, 15335424
    s_add_u32 s6, s72, s5
    s_sub_u32 s7, s6, 36
    s_min_u32 s6, s6, s7
    s_lshl_b32 s6, s6, 11
    s_add_u32 s6, s6, s73
    s_cmp_gt_u32 s5, 4
    s_cbranch_scc1 L_st_71
    s_cmp_lg_u32 s5, 0
    s_cbranch_scc1 L_own_70
    s_and_b32 s7, s4, 1
    s_cmp_eq_u32 s7, 0
    s_cbranch_scc1 L_own_70
L_st_71:
    v_cvt_pk_bf16_f32 v144, v64, v65
    v_cvt_pk_bf16_f32 v145, v66, v67
    v_cvt_pk_bf16_f32 v146, v68, v69
    v_cvt_pk_bf16_f32 v147, v70, v71
    buffer_store_dwordx4 v[144:147], v58, s[52:55], s6 offen offset:0 sc1
L_own_70:
    s_cmp_gt_u32 s5, 4
    s_cbranch_scc1 L_st_73
    s_cmp_lg_u32 s5, 4
    s_cbranch_scc1 L_own_72
    s_and_b32 s7, s4, 1
    s_cmp_eq_u32 s7, 1
    s_cbranch_scc1 L_own_72
L_st_73:
    v_cvt_pk_bf16_f32 v148, v72, v73
    v_cvt_pk_bf16_f32 v149, v74, v75
    v_cvt_pk_bf16_f32 v150, v76, v77
    v_cvt_pk_bf16_f32 v151, v78, v79
    buffer_store_dwordx4 v[148:151], v58, s[52:55], s6 offen offset:1024 sc1
L_own_72:
    s_add_u32 s6, s72, s5
    s_add_u32 s6, s6, 8
    s_sub_u32 s7, s6, 36
    s_min_u32 s6, s6, s7
    s_lshl_b32 s6, s6, 11
    s_add_u32 s6, s6, s73
    v_cvt_pk_bf16_f32 v152, v80, v81
    v_cvt_pk_bf16_f32 v153, v82, v83
    v_cvt_pk_bf16_f32 v154, v84, v85
    v_cvt_pk_bf16_f32 v155, v86, v87
    buffer_store_dwordx4 v[152:155], v58, s[52:55], s6 offen offset:0 sc1
    v_cvt_pk_bf16_f32 v156, v88, v89
    v_cvt_pk_bf16_f32 v157, v90, v91
    v_cvt_pk_bf16_f32 v158, v92, v93
    v_cvt_pk_bf16_f32 v159, v94, v95
    buffer_store_dwordx4 v[156:159], v58, s[52:55], s6 offen offset:1024 sc1
    s_add_u32 s6, s72, s5
    s_add_u32 s6, s6, 16
    s_sub_u32 s7, s6, 36
    s_min_u32 s6, s6, s7
    s_lshl_b32 s6, s6, 11
    s_add_u32 s6, s6, s73
    v_cvt_pk_bf16_f32 v144, v96, v97
    v_cvt_pk_bf16_f32 v145, v98, v99
    v_cvt_pk_bf16_f32 v146, v100, v101
    v_cvt_pk_bf16_f32 v147, v102, v103
    buffer_store_dwordx4 v[144:147], v58, s[52:55], s6 offen offset:0 sc1
    v_cvt_pk_bf16_f32 v148, v104, v105
    v_cvt_pk_bf16_f32 v149, v106, v107
    v_cvt_pk_bf16_f32 v150, v108, v109
    v_cvt_pk_bf16_f32 v151, v110, v111
    buffer_store_dwordx4 v[148:151], v58, s[52:55], s6 offen offset:1024 sc1
    s_add_u32 s6, s72, s5
    s_add_u32 s6, s6, 24
    s_sub_u32 s7, s6, 36
    s_min_u32 s6, s6, s7
    s_lshl_b32 s6, s6, 11
    s_add_u32 s6, s6, s73
    v_cvt_pk_bf16_f32 v152, v112, v113
    v_cvt_pk_bf16_f32 v153, v114, v115
    v_cvt_pk_bf16_f32 v154, v116, v117
    v_cvt_pk_bf16_f32 v155, v118, v119
    buffer_store_dwordx4 v[152:155], v58, s[52:55], s6 offen offset:0 sc1
    v_cvt_pk_bf16_f32 v156, v120, v121
    v_cvt_pk_bf16_f32 v157, v122, v123
    v_cvt_pk_bf16_f32 v158, v124, v125
    v_cvt_pk_bf16_f32 v159, v126, v127
    buffer_store_dwordx4 v[156:159], v58, s[52:55], s6 offen offset:1024 sc1
    s_add_u32 s6, s72, s5
    s_add_u32 s6, s6, 32
    s_sub_u32 s7, s6, 36
    s_min_u32 s6, s6, s7
    s_lshl_b32 s6, s6, 11
    s_add_u32 s6, s6, s73
    v_cvt_pk_bf16_f32 v144, v128, v129
    v_cvt_pk_bf16_f32 v145, v130, v131
    v_cvt_pk_bf16_f32 v146, v132, v133
    v_cvt_pk_bf16_f32 v147, v134, v135
    buffer_store_dwordx4 v[144:147], v58, s[52:55], s6 offen offset:0 sc1
    v_cvt_pk_bf16_f32 v148, v136, v137
    v_cvt_pk_bf16_f32 v149, v138, v139
    v_cvt_pk_bf16_f32 v150, v140, v141
    v_cvt_pk_bf16_f32 v151, v142, v143
    buffer_store_dwordx4 v[148:151], v58, s[52:55], s6 offen offset:1024 sc1
    v_mov_b32 v240, v64
    v_mov_b32 v241, v65
    v_mov_b32 v242, v66
    v_mov_b32 v243, v67
    v_mov_b32 v244, v68
    v_mov_b32 v245, v69
    v_mov_b32 v246, v70
    v_mov_b32 v247, v71
    v_mov_b32 v248, v72
    v_mov_b32 v249, v73
    v_mov_b32 v250, v74
    v_mov_b32 v251, v75
    v_mov_b32 v252, v76
    v_mov_b32 v253, v77
    v_mov_b32 v254, v78
    v_mov_b32 v255, v79
    s_lshr_b32 s72, s5, 1
    s_lshl_b32 s73, s72, 8
    s_add_u32 s73, s73, s2
    s_mul_i32 s74, s72, 18560
    s_add_u32 s74, s74, 73728
    s_mul_i32 s75, s72, 4608
    s_add_u32 s75, s75, 147712
    s_and_b32 s76, s5, 1
    s_lshl_b32 s76, s76, 1
    s_lshl_b32 s6, s76, 10
    s_add_u32 s6, s6, s74
    s_add_u32 s6, s6, 384
    v_lshl_add_u32 v2, v1, 4, s6
    s_cmp_lg_u32 s76, 0
    s_cbranch_scc1 L_ub_nz_74
    v_cmp_eq_u32 vcc, 0, v1
    s_nop 1
    v_cndmask_b32 v18, v18, 0, vcc
    v_cndmask_b32 v19, v19, 0, vcc
    v_mov_b32 v128, 0
    v_mov_b32 v129, 0
    v_mov_b32 v130, 0
    v_mov_b32 v131, 0
    v_lshlrev_b32 v3, 4, v1
    v_add_u32 v3, s74, v3
    v_cmp_gt_u32 vcc, 24, v1
    s_and_saveexec_b64 s[14:15], vcc
    ds_write_b128 v3, v[128:131] offset:0
    ds_write_b128 v3, v[128:131] offset:4640
    ds_write_b128 v3, v[128:131] offset:9280
    ds_write_b128 v3, v[128:131] offset:13920
    s_mov_b64 exec, s[14:15]
L_ub_nz_74:
    v_alignbyte_b32 v128, v19, v18, 2
    v_alignbyte_b32 v129, v20, v19, 2
    v_alignbyte_b32 v130, v21, v20, 2
    v_alignbyte_b32 v131, v22, v21, 2
    v_mov_b32 v136, v129
    v_mov_b32 v137, v130
    v_mov_b32 v138, v131
    v_alignbyte_b32 v139, v23, v22, 2
    v_mov_b32 v132, v19
    v_mov_b32 v133, v20
    v_mov_b32 v134, v21
    v_mov_b32 v135, v22
    ds_write_b128 v2, v[128:131] offset:0
    ds_write_b128 v2, v[132:135] offset:4640
    ds_write_b128 v2, v[136:139] offset:9280
    ds_write_b128 v2, v[20:23] offset:13920
    v_alignbyte_b32 v140, v27, v26, 2
    v_alignbyte_b32 v141, v28, v27, 2
    v_alignbyte_b32 v142, v29, v28, 2
    v_alignbyte_b32 v143, v30, v29, 2
    v_mov_b32 v148, v141
    v_mov_b32 v149, v142
    v_mov_b32 v150, v143
    v_alignbyte_b32 v151, v31, v30, 2
    v_mov_b32 v144, v27
    v_mov_b32 v145, v28
    v_mov_b32 v146, v29
    v_mov_b32 v147, v30
    ds_write_b128 v2, v[140:143] offset:1024
    ds_write_b128 v2, v[144:147] offset:5664
    ds_write_b128 v2, v[148:151] offset:10304
    ds_write_b128 v2, v[28:31] offset:14944
    s_waitcnt vmcnt(0)
    v_mov_b32 v2, 163664
    v_mov_b32 v3, 1
    s_mov_b64 s[14:15], exec
    s_mov_b64 exec, 1
    ds_add_rtn_u32 v4, v2, v3
    s_waitcnt lgkmcnt(0)
    v_readfirstlane_b32 s6, v4
    s_cmp_lg_u32 s6, 3
    s_cbranch_scc1 L_cs_75
    s_lshl_b32 s6, s3, 7
    s_add_u32 s6, s6, 34217984
    v_mov_b32 v2, 0
    buffer_atomic_add v3, v2, s[52:55], s6 offen sc1
L_cs_75:
    s_mov_b64 exec, s[14:15]
    s_lshr_b32 s76, s5, 1
    s_lshl_b32 s76, s76, 2
    s_add_u32 s76, s76, 163652
    s_waitcnt lgkmcnt(0)
    v_mov_b32 v2, s76
    v_mov_b32 v3, 1
    s_mov_b64 s[14:15], exec
    s_mov_b64 exec, 1
    ds_add_u32 v2, v3
    s_mov_b64 exec, s[14:15]
    s_mov_b32 s6, 0
L_ls_76:
    ds_read_b32 v3, v2
    s_add_u32 s6, s6, 1
    s_cmp_gt_u32 s6, 4000000
    s_cbranch_scc1 L_ls_done_77
    s_waitcnt lgkmcnt(0)
    v_readfirstlane_b32 s7, v3
    s_cmp_ge_u32 s7, 2
    s_cbranch_scc1 L_ls_done_77
    s_branch L_ls_76
L_ls_done_77:
    s_lshr_b32 s72, s5, 1
    s_lshl_b32 s73, s72, 8
    s_add_u32 s73, s73, s2
    s_mul_i32 s74, s72, 18560
    s_add_u32 s74, s74, 73728
    s_mul_i32 s75, s72, 4608
    s_add_u32 s75, s75, 147712
    s_bitcmp1_b32 s5, 0
    s_cbranch_scc1 L_odd_78
    v_and_b32 v2, 15, v1
    v_lshrrev_b32 v3, 4, v1
    v_and_b32 v4, 3, v2
    v_lshrrev_b32 v5, 2, v2
    v_mul_u32_u24 v4, 4640, v4
    v_lshl_add_u32 v4, v5, 7, v4
    v_lshl_add_u32 v4, v3, 4, v4
    s_add_u32 s6, s74, 448
    v_add_u32 v40, s6, v4
    v_lshlrev_b32 v4, 4, v3
    v_lshlrev_b32 v5, 3, v2
    v_sub_u32 v4, v4, v5
    s_add_u32 s6, s75, 568
    v_add_u32 v41, s6, v4
    v_mov_b32 v160, 0
    v_mov_b32 v161, 0
    v_mov_b32 v162, 0
    v_mov_b32 v163, 0
    v_mov_b32 v164, 0
    v_mov_b32 v165, 0
    v_mov_b32 v166, 0
    v_mov_b32 v167, 0
    v_mov_b32 v168, 0
    v_mov_b32 v169, 0
    v_mov_b32 v170, 0
    v_mov_b32 v171, 0
    v_mov_b32 v172, 0
    v_mov_b32 v173, 0
    v_mov_b32 v174, 0
    v_mov_b32 v175, 0
    ds_read_b64 v[8:9], v41 offset:3584
    ds_read_b64 v[10:11], v41 offset:3592
    ds_read_b128 v[64:67], v40 offset:0
    ds_read_b128 v[76:79], v40 offset:1536
    ds_read_b64 v[12:13], v41 offset:3072
    ds_read_b64 v[14:15], v41 offset:3080
    ds_read_b128 v[72:75], v40 offset:1024
    ds_read_b64 v[16:17], v41 offset:2560
    ds_read_b64 v[18:19], v41 offset:2568
    ds_read_b128 v[68:71], v40 offset:512
    ds_read_b64 v[20:21], v41 offset:2048
    ds_read_b64 v[22:23], v41 offset:2056
    ds_read_b128 v[80:83], v40 offset:2048
    ds_read_b64 v[24:25], v41 offset:1536
    ds_read_b64 v[26:27], v41 offset:1544
    ds_read_b128 v[92:95], v40 offset:3584
    ds_read_b128 v[88:91], v40 offset:3072
    ds_read_b128 v[84:87], v40 offset:2560
    ds_read_b64 v[28:29], v41 offset:1024
    ds_read_b64 v[30:31], v41 offset:1032
    ds_read_b64 v[32:33], v41 offset:512
    ds_read_b64 v[34:35], v41 offset:520
    ds_read_b64 v[36:37], v41 offset:0
    ds_read_b64 v[38:39], v41 offset:8
    v_subrev_u32 v40, 64, v40
    v_subrev_u32 v41, 64, v41
    s_mov_b32 s6, 4
L_conv_80:
    s_waitcnt lgkmcnt(0)
    ds_read_b64 v[96:97], v41 offset:3584
    ds_read_b64 v[98:99], v41 offset:3592
    v_mfma_f32_16x16x32_f16 v[160:163], v[64:67], v[8:11], v[160:163]
    ds_read_b128 v[128:131], v40 offset:0
    ds_read_b128 v[140:143], v40 offset:1536
    v_mfma_f32_16x16x32_f16 v[164:167], v[76:79], v[8:11], v[164:167]
    ds_read_b64 v[100:101], v41 offset:3072
    ds_read_b64 v[102:103], v41 offset:3080
    v_mfma_f32_16x16x32_f16 v[164:167], v[72:75], v[12:15], v[164:167]
    ds_read_b128 v[136:139], v40 offset:1024
    ds_read_b64 v[104:105], v41 offset:2560
    v_mfma_f32_16x16x32_f16 v[164:167], v[68:71], v[16:19], v[164:167]
    ds_read_b64 v[106:107], v41 offset:2568
    ds_read_b128 v[132:135], v40 offset:512
    v_mfma_f32_16x16x32_f16 v[164:167], v[64:67], v[20:23], v[164:167]
    ds_read_b64 v[108:109], v41 offset:2048
    ds_read_b64 v[110:111], v41 offset:2056
    v_mfma_f32_16x16x32_f16 v[168:171], v[80:83], v[8:11], v[168:171]
    ds_read_b128 v[144:147], v40 offset:2048
    ds_read_b64 v[112:113], v41 offset:1536
    v_mfma_f32_16x16x32_f16 v[168:171], v[76:79], v[12:15], v[168:171]
    ds_read_b64 v[114:115], v41 offset:1544
    ds_read_b128 v[156:159], v40 offset:3584
    v_mfma_f32_16x16x32_f16 v[168:171], v[72:75], v[16:19], v[168:171]
    ds_read_b128 v[152:155], v40 offset:3072
    ds_read_b128 v[148:151], v40 offset:2560
    v_mfma_f32_16x16x32_f16 v[168:171], v[68:71], v[20:23], v[168:171]
    ds_read_b64 v[116:117], v41 offset:1024
    ds_read_b64 v[118:119], v41 offset:1032
    v_mfma_f32_16x16x32_f16 v[168:171], v[64:67], v[24:27], v[168:171]
    ds_read_b64 v[120:121], v41 offset:512
    ds_read_b64 v[122:123], v41 offset:520
    v_mfma_f32_16x16x32_f16 v[172:175], v[92:95], v[8:11], v[172:175]
    ds_read_b64 v[124:125], v41 offset:0
    ds_read_b64 v[126:127], v41 offset:8
    v_mfma_f32_16x16x32_f16 v[172:175], v[88:91], v[12:15], v[172:175]
    v_mfma_f32_16x16x32_f16 v[172:175], v[84:87], v[16:19], v[172:175]
    v_mfma_f32_16x16x32_f16 v[172:175], v[80:83], v[20:23], v[172:175]
    v_mfma_f32_16x16x32_f16 v[172:175], v[76:79], v[24:27], v[172:175]
    v_mfma_f32_16x16x32_f16 v[172:175], v[72:75], v[28:31], v[172:175]
    v_mfma_f32_16x16x32_f16 v[172:175], v[68:71], v[32:35], v[172:175]
    v_mfma_f32_16x16x32_f16 v[172:175], v[64:67], v[36:39], v[172:175]
    v_subrev_u32 v40, 64, v40
    v_subrev_u32 v41, 64, v41
    s_waitcnt lgkmcnt(0)
    ds_read_b64 v[8:9], v41 offset:3584
    ds_read_b64 v[10:11], v41 offset:3592
    v_mfma_f32_16x16x32_f16 v[160:163], v[128:131], v[96:99], v[160:163]
    ds_read_b128 v[64:67], v40 offset:0
    ds_read_b128 v[76:79], v40 offset:1536
    v_mfma_f32_16x16x32_f16 v[164:167], v[140:143], v[96:99], v[164:167]
    ds_read_b64 v[12:13], v41 offset:3072
    ds_read_b64 v[14:15], v41 offset:3080
    v_mfma_f32_16x16x32_f16 v[164:167], v[136:139], v[100:103], v[164:167]
    ds_read_b128 v[72:75], v40 offset:1024
    ds_read_b64 v[16:17], v41 offset:2560
    v_mfma_f32_16x16x32_f16 v[164:167], v[132:135], v[104:107], v[164:167]
    ds_read_b64 v[18:19], v41 offset:2568
    ds_read_b128 v[68:71], v40 offset:512
    v_mfma_f32_16x16x32_f16 v[164:167], v[128:131], v[108:111], v[164:167]
    ds_read_b64 v[20:21], v41 offset:2048
    ds_read_b64 v[22:23], v41 offset:2056
    v_mfma_f32_16x16x32_f16 v[168:171], v[144:147], v[96:99], v[168:171]
    ds_read_b128 v[80:83], v40 offset:2048
    ds_read_b64 v[24:25], v41 offset:1536
    v_mfma_f32_16x16x32_f16 v[168:171], v[140:143], v[100:103], v[168:171]
    ds_read_b64 v[26:27], v41 offset:1544
    ds_read_b128 v[92:95], v40 offset:3584
    v_mfma_f32_16x16x32_f16 v[168:171], v[136:139], v[104:107], v[168:171]
    ds_read_b128 v[88:91], v40 offset:3072
    ds_read_b128 v[84:87], v40 offset:2560
    v_mfma_f32_16x16x32_f16 v[168:171], v[132:135], v[108:111], v[168:171]
    ds_read_b64 v[28:29], v41 offset:1024
    ds_read_b64 v[30:31], v41 offset:1032
    v_mfma_f32_16x16x32_f16 v[168:171], v[128:131], v[112:115], v[168:171]
    ds_read_b64 v[32:33], v41 offset:512
    ds_read_b64 v[34:35], v41 offset:520
    v_mfma_f32_16x16x32_f16 v[172:175], v[156:159], v[96:99], v[172:175]
    ds_read_b64 v[36:37], v41 offset:0
    ds_read_b64 v[38:39], v41 offset:8
    v_mfma_f32_16x16x32_f16 v[172:175], v[152:155], v[100:103], v[172:175]
    v_mfma_f32_16x16x32_f16 v[172:175], v[148:151], v[104:107], v[172:175]
    v_mfma_f32_16x16x32_f16 v[172:175], v[144:147], v[108:111], v[172:175]
    v_mfma_f32_16x16x32_f16 v[172:175], v[140:143], v[112:115], v[172:175]
    v_mfma_f32_16x16x32_f16 v[172:175], v[136:139], v[116:119], v[172:175]
    v_mfma_f32_16x16x32_f16 v[172:175], v[132:135], v[120:123], v[172:175]
    v_mfma_f32_16x16x32_f16 v[172:175], v[128:131], v[124:127], v[172:175]
    v_subrev_u32 v40, 64, v40
    v_subrev_u32 v41, 64, v41
    s_sub_u32 s6, s6, 1
    s_cmp_lg_u32 s6, 0
    s_cbranch_scc1 L_conv_80
    s_waitcnt lgkmcnt(0)
    s_lshl_b32 s6, s72, 4
    s_add_u32 s6, s6, 163584
    v_mov_b32 v2, s6
    ds_read_b64 v[8:9], v2
    v_and_b32 v2, 15, v1
    v_lshrrev_b32 v3, 4, v1
    v_lshlrev_b32 v3, 7, v3
    v_lshl_add_u32 v3, v2, 3, v3
    s_add_u32 s6, s74, 14304
    v_add_u32 v4, s6, v3
    ds_read_b64 v[10:11], v4 offset:0
    ds_read_b64 v[12:13], v4 offset:1536
    ds_read_b64 v[14:15], v4 offset:2048
    ds_read_b64 v[16:17], v4 offset:3584
    s_lshl_b32 s7, s73, 12
    s_add_u32 s7, s7, 12976128
    s_waitcnt lgkmcnt(0)
    v_cvt_f32_f16 v20, v10
    v_cvt_f32_f16_sdwa v21, v10 dst_sel:DWORD dst_unused:UNUSED_PAD src0_sel:WORD_1
    v_cvt_f32_f16 v22, v11
    v_cvt_f32_f16_sdwa v23, v11 dst_sel:DWORD dst_unused:UNUSED_PAD src0_sel:WORD_1
    v_mul_f32 v160, v160, v8
    v_mul_f32 v161, v161, v8
    v_mul_f32 v162, v162, v8
    v_mul_f32 v163, v163, v8
    v_fma_f32 v160, v20, v9, v160
    v_fma_f32 v161, v21, v9, v161
    v_fma_f32 v162, v22, v9, v162
    v_fma_f32 v163, v23, v9, v163
    v_cvt_pk_bf16_f32 v24, v160, v161
    v_cvt_pk_bf16_f32 v25, v162, v163
    buffer_store_dwordx2 v[24:25], v3, s[52:55], s7 offen offset:0 sc1
    v_cvt_f32_f16 v28, v12
    v_cvt_f32_f16_sdwa v29, v12 dst_sel:DWORD dst_unused:UNUSED_PAD src0_sel:WORD_1
    v_cvt_f32_f16 v30, v13
    v_cvt_f32_f16_sdwa v31, v13 dst_sel:DWORD dst_unused:UNUSED_PAD src0_sel:WORD_1
    v_mul_f32 v164, v164, v8
    v_mul_f32 v165, v165, v8
    v_mul_f32 v166, v166, v8
    v_mul_f32 v167, v167, v8
    v_fma_f32 v164, v28, v9, v164
    v_fma_f32 v165, v29, v9, v165
    v_fma_f32 v166, v30, v9, v166
    v_fma_f32 v167, v31, v9, v167
    v_cvt_pk_bf16_f32 v32, v164, v165
    v_cvt_pk_bf16_f32 v33, v166, v167
    buffer_store_dwordx2 v[32:33], v3, s[52:55], s7 offen offset:1536 sc1
    v_cvt_f32_f16 v20, v14
    v_cvt_f32_f16_sdwa v21, v14 dst_sel:DWORD dst_unused:UNUSED_PAD src0_sel:WORD_1
    v_cvt_f32_f16 v22, v15
    v_cvt_f32_f16_sdwa v23, v15 dst_sel:DWORD dst_unused:UNUSED_PAD src0_sel:WORD_1
    v_mul_f32 v168, v168, v8
    v_mul_f32 v169, v169, v8
    v_mul_f32 v170, v170, v8
    v_mul_f32 v171, v171, v8
    v_fma_f32 v168, v20, v9, v168
    v_fma_f32 v169, v21, v9, v169
    v_fma_f32 v170, v22, v9, v170
    v_fma_f32 v171, v23, v9, v171
    v_cvt_pk_bf16_f32 v24, v168, v169
    v_cvt_pk_bf16_f32 v25, v170, v171
    buffer_store_dwordx2 v[24:25], v3, s[52:55], s7 offen offset:2048 sc1
    v_cvt_f32_f16 v28, v16
    v_cvt_f32_f16_sdwa v29, v16 dst_sel:DWORD dst_unused:UNUSED_PAD src0_sel:WORD_1
    v_cvt_f32_f16 v30, v17
    v_cvt_f32_f16_sdwa v31, v17 dst_sel:DWORD dst_unused:UNUSED_PAD src0_sel:WORD_1
    v_mul_f32 v172, v172, v8
    v_mul_f32 v173, v173, v8
    v_mul_f32 v174, v174, v8
    v_mul_f32 v175, v175, v8
    v_fma_f32 v172, v28, v9, v172
    v_fma_f32 v173, v29, v9, v173
    v_fma_f32 v174, v30, v9, v174
    v_fma_f32 v175, v31, v9, v175
    v_cvt_pk_bf16_f32 v32, v172, v173
    v_cvt_pk_bf16_f32 v33, v174, v175
    buffer_store_dwordx2 v[32:33], v3, s[52:55], s7 offen offset:3584 sc1
    s_branch L_convAB_79
L_odd_78:
    v_and_b32 v2, 15, v1
    v_lshrrev_b32 v3, 4, v1
    v_and_b32 v4, 3, v2
    v_lshrrev_b32 v5, 2, v2
    v_mul_u32_u24 v4, 4640, v4
    v_lshl_add_u32 v4, v5, 7, v4
    v_lshl_add_u32 v4, v3, 4, v4
    s_add_u32 s6, s74, 448
    v_add_u32 v40, s6, v4
    v_lshlrev_b32 v4, 4, v3
    v_lshlrev_b32 v5, 3, v2
    v_sub_u32 v4, v4, v5
    s_add_u32 s6, s75, 568
    v_add_u32 v41, s6, v4
    v_mov_b32 v160, 0
    v_mov_b32 v161, 0
    v_mov_b32 v162, 0
    v_mov_b32 v163, 0
    v_mov_b32 v164, 0
    v_mov_b32 v165, 0
    v_mov_b32 v166, 0
    v_mov_b32 v167, 0
    v_mov_b32 v168, 0
    v_mov_b32 v169, 0
    v_mov_b32 v170, 0
    v_mov_b32 v171, 0
    v_mov_b32 v172, 0
    v_mov_b32 v173, 0
    v_mov_b32 v174, 0
    v_mov_b32 v175, 0
    ds_read_b64 v[8:9], v41 offset:3584
    ds_read_b64 v[10:11], v41 offset:3592
    ds_read_b128 v[68:71], v40 offset:512
    ds_read_b64 v[12:13], v41 offset:3072
    ds_read_b64 v[14:15], v41 offset:3080
    ds_read_b128 v[64:67], v40 offset:0
    ds_read_b128 v[72:75], v40 offset:1024
    ds_read_b64 v[16:17], v41 offset:2560
    ds_read_b64 v[18:19], v41 offset:2568
    ds_read_b128 v[84:87], v40 offset:2560
    ds_read_b128 v[80:83], v40 offset:2048
    ds_read_b128 v[76:79], v40 offset:1536
    ds_read_b64 v[20:21], v41 offset:2048
    ds_read_b64 v[22:23], v41 offset:2056
    ds_read_b64 v[24:25], v41 offset:1536
    ds_read_b64 v[26:27], v41 offset:1544
    ds_read_b64 v[28:29], v41 offset:1024
    ds_read_b64 v[30:31], v41 offset:1032
    ds_read_b128 v[88:91], v40 offset:3072
    ds_read_b64 v[32:33], v41 offset:512
    ds_read_b64 v[34:35], v41 offset:520
    v_subrev_u32 v40, 64, v40
    v_subrev_u32 v41, 64, v41
    s_mov_b32 s6, 4
L_conv_81:
    s_waitcnt lgkmcnt(0)
    ds_read_b64 v[96:97], v41 offset:3584
    ds_read_b64 v[98:99], v41 offset:3592
    v_mfma_f32_16x16x32_f16 v[160:163], v[68:71], v[8:11], v[160:163]
    ds_read_b128 v[132:135], v40 offset:512
    ds_read_b64 v[100:101], v41 offset:3072
    v_mfma_f32_16x16x32_f16 v[160:163], v[64:67], v[12:15], v[160:163]
    ds_read_b64 v[102:103], v41 offset:3080
    ds_read_b128 v[128:131], v40 offset:0
    v_mfma_f32_16x16x32_f16 v[164:167], v[72:75], v[8:11], v[164:167]
    ds_read_b128 v[136:139], v40 offset:1024
    ds_read_b64 v[104:105], v41 offset:2560
    v_mfma_f32_16x16x32_f16 v[164:167], v[68:71], v[12:15], v[164:167]
    ds_read_b64 v[106:107], v41 offset:2568
    ds_read_b128 v[148:151], v40 offset:2560
    v_mfma_f32_16x16x32_f16 v[164:167], v[64:67], v[16:19], v[164:167]
    ds_read_b128 v[144:147], v40 offset:2048
    ds_read_b128 v[140:143], v40 offset:1536
    v_mfma_f32_16x16x32_f16 v[168:171], v[84:87], v[8:11], v[168:171]
    ds_read_b64 v[108:109], v41 offset:2048
    ds_read_b64 v[110:111], v41 offset:2056
    v_mfma_f32_16x16x32_f16 v[168:171], v[80:83], v[12:15], v[168:171]
    ds_read_b64 v[112:113], v41 offset:1536
    ds_read_b64 v[114:115], v41 offset:1544
    v_mfma_f32_16x16x32_f16 v[168:171], v[76:79], v[16:19], v[168:171]
    ds_read_b64 v[116:117], v41 offset:1024
    ds_read_b64 v[118:119], v41 offset:1032
    v_mfma_f32_16x16x32_f16 v[168:171], v[72:75], v[20:23], v[168:171]
    ds_read_b128 v[152:155], v40 offset:3072
    ds_read_b64 v[120:121], v41 offset:512
    v_mfma_f32_16x16x32_f16 v[168:171], v[68:71], v[24:27], v[168:171]
    ds_read_b64 v[122:123], v41 offset:520
    v_mfma_f32_16x16x32_f16 v[168:171], v[64:67], v[28:31], v[168:171]
    v_mfma_f32_16x16x32_f16 v[172:175], v[88:91], v[8:11], v[172:175]
    v_mfma_f32_16x16x32_f16 v[172:175], v[84:87], v[12:15], v[172:175]
    v_mfma_f32_16x16x32_f16 v[172:175], v[80:83], v[16:19], v[172:175]
    v_mfma_f32_16x16x32_f16 v[172:175], v[76:79], v[20:23], v[172:175]
    v_mfma_f32_16x16x32_f16 v[172:175], v[72:75], v[24:27], v[172:175]
    v_mfma_f32_16x16x32_f16 v[172:175], v[68:71], v[28:31], v[172:175]
    v_mfma_f32_16x16x32_f16 v[172:175], v[64:67], v[32:35], v[172:175]
    v_subrev_u32 v40, 64, v40
    v_subrev_u32 v41, 64, v41
    s_waitcnt lgkmcnt(0)
    ds_read_b64 v[8:9], v41 offset:3584
    ds_read_b64 v[10:11], v41 offset:3592
    v_mfma_f32_16x16x32_f16 v[160:163], v[132:135], v[96:99], v[160:163]
    ds_read_b128 v[68:71], v40 offset:512
    ds_read_b64 v[12:13], v41 offset:3072
    v_mfma_f32_16x16x32_f16 v[160:163], v[128:131], v[100:103], v[160:163]
    ds_read_b64 v[14:15], v41 offset:3080
    ds_read_b128 v[64:67], v40 offset:0
    v_mfma_f32_16x16x32_f16 v[164:167], v[136:139], v[96:99], v[164:167]
    ds_read_b128 v[72:75], v40 offset:1024
    ds_read_b64 v[16:17], v41 offset:2560
    v_mfma_f32_16x16x32_f16 v[164:167], v[132:135], v[100:103], v[164:167]
    ds_read_b64 v[18:19], v41 offset:2568
    ds_read_b128 v[84:87], v40 offset:2560
    v_mfma_f32_16x16x32_f16 v[164:167], v[128:131], v[104:107], v[164:167]
    ds_read_b128 v[80:83], v40 offset:2048
    ds_read_b128 v[76:79], v40 offset:1536
    v_mfma_f32_16x16x32_f16 v[168:171], v[148:151], v[96:99], v[168:171]
    ds_read_b64 v[20:21], v41 offset:2048
    ds_read_b64 v[22:23], v41 offset:2056
    v_mfma_f32_16x16x32_f16 v[168:171], v[144:147], v[100:103], v[168:171]
    ds_read_b64 v[24:25], v41 offset:1536
    ds_read_b64 v[26:27], v41 offset:1544
    v_mfma_f32_16x16x32_f16 v[168:171], v[140:143], v[104:107], v[168:171]
    ds_read_b64 v[28:29], v41 offset:1024
    ds_read_b64 v[30:31], v41 offset:1032
    v_mfma_f32_16x16x32_f16 v[168:171], v[136:139], v[108:111], v[168:171]
    ds_read_b128 v[88:91], v40 offset:3072
    ds_read_b64 v[32:33], v41 offset:512
    v_mfma_f32_16x16x32_f16 v[168:171], v[132:135], v[112:115], v[168:171]
    ds_read_b64 v[34:35], v41 offset:520
    v_mfma_f32_16x16x32_f16 v[168:171], v[128:131], v[116:119], v[168:171]
    v_mfma_f32_16x16x32_f16 v[172:175], v[152:155], v[96:99], v[172:175]
    v_mfma_f32_16x16x32_f16 v[172:175], v[148:151], v[100:103], v[172:175]
    v_mfma_f32_16x16x32_f16 v[172:175], v[144:147], v[104:107], v[172:175]
    v_mfma_f32_16x16x32_f16 v[172:175], v[140:143], v[108:111], v[172:175]
    v_mfma_f32_16x16x32_f16 v[172:175], v[136:139], v[112:115], v[172:175]
    v_mfma_f32_16x16x32_f16 v[172:175], v[132:135], v[116:119], v[172:175]
    v_mfma_f32_16x16x32_f16 v[172:175], v[128:131], v[120:123], v[172:175]
    v_subrev_u32 v40, 64, v40
    v_subrev_u32 v41, 64, v41
    s_sub_u32 s6, s6, 1
    s_cmp_lg_u32 s6, 0
    s_cbranch_scc1 L_conv_81
    s_waitcnt lgkmcnt(0)
    s_lshl_b32 s6, s72, 4
    s_add_u32 s6, s6, 163584
    v_mov_b32 v2, s6
    ds_read_b64 v[8:9], v2
    v_and_b32 v2, 15, v1
    v_lshrrev_b32 v3, 4, v1
    v_lshlrev_b32 v3, 7, v3
    v_lshl_add_u32 v3, v2, 3, v3
    s_add_u32 s6, s74, 14304
    v_add_u32 v4, s6, v3
    ds_read_b64 v[10:11], v4 offset:512
    ds_read_b64 v[12:13], v4 offset:1024
    ds_read_b64 v[14:15], v4 offset:2560
    ds_read_b64 v[16:17], v4 offset:3072
    s_lshl_b32 s7, s73, 12
    s_add_u32 s7, s7, 12976128
    s_waitcnt lgkmcnt(0)
    v_cvt_f32_f16 v20, v10
    v_cvt_f32_f16_sdwa v21, v10 dst_sel:DWORD dst_unused:UNUSED_PAD src0_sel:WORD_1
    v_cvt_f32_f16 v22, v11
    v_cvt_f32_f16_sdwa v23, v11 dst_sel:DWORD dst_unused:UNUSED_PAD src0_sel:WORD_1
    v_mul_f32 v160, v160, v8
    v_mul_f32 v161, v161, v8
    v_mul_f32 v162, v162, v8
    v_mul_f32 v163, v163, v8
    v_fma_f32 v160, v20, v9, v160
    v_fma_f32 v161, v21, v9, v161
    v_fma_f32 v162, v22, v9, v162
    v_fma_f32 v163, v23, v9, v163
    v_cvt_pk_bf16_f32 v24, v160, v161
    v_cvt_pk_bf16_f32 v25, v162, v163
    buffer_store_dwordx2 v[24:25], v3, s[52:55], s7 offen offset:512 sc1
    v_cvt_f32_f16 v28, v12
    v_cvt_f32_f16_sdwa v29, v12 dst_sel:DWORD dst_unused:UNUSED_PAD src0_sel:WORD_1
    v_cvt_f32_f16 v30, v13
    v_cvt_f32_f16_sdwa v31, v13 dst_sel:DWORD dst_unused:UNUSED_PAD src0_sel:WORD_1
    v_mul_f32 v164, v164, v8
    v_mul_f32 v165, v165, v8
    v_mul_f32 v166, v166, v8
    v_mul_f32 v167, v167, v8
    v_fma_f32 v164, v28, v9, v164
    v_fma_f32 v165, v29, v9, v165
    v_fma_f32 v166, v30, v9, v166
    v_fma_f32 v167, v31, v9, v167
    v_cvt_pk_bf16_f32 v32, v164, v165
    v_cvt_pk_bf16_f32 v33, v166, v167
    buffer_store_dwordx2 v[32:33], v3, s[52:55], s7 offen offset:1024 sc1
    v_cvt_f32_f16 v20, v14
    v_cvt_f32_f16_sdwa v21, v14 dst_sel:DWORD dst_unused:UNUSED_PAD src0_sel:WORD_1
    v_cvt_f32_f16 v22, v15
    v_cvt_f32_f16_sdwa v23, v15 dst_sel:DWORD dst_unused:UNUSED_PAD src0_sel:WORD_1
    v_mul_f32 v168, v168, v8
    v_mul_f32 v169, v169, v8
    v_mul_f32 v170, v170, v8
    v_mul_f32 v171, v171, v8
    v_fma_f32 v168, v20, v9, v168
    v_fma_f32 v169, v21, v9, v169
    v_fma_f32 v170, v22, v9, v170
    v_fma_f32 v171, v23, v9, v171
    v_cvt_pk_bf16_f32 v24, v168, v169
    v_cvt_pk_bf16_f32 v25, v170, v171
    buffer_store_dwordx2 v[24:25], v3, s[52:55], s7 offen offset:2560 sc1
    v_cvt_f32_f16 v28, v16
    v_cvt_f32_f16_sdwa v29, v16 dst_sel:DWORD dst_unused:UNUSED_PAD src0_sel:WORD_1
    v_cvt_f32_f16 v30, v17
    v_cvt_f32_f16_sdwa v31, v17 dst_sel:DWORD dst_unused:UNUSED_PAD src0_sel:WORD_1
    v_mul_f32 v172, v172, v8
    v_mul_f32 v173, v173, v8
    v_mul_f32 v174, v174, v8
    v_mul_f32 v175, v175, v8
    v_fma_f32 v172, v28, v9, v172
    v_fma_f32 v173, v29, v9, v173
    v_fma_f32 v174, v30, v9, v174
    v_fma_f32 v175, v31, v9, v175
    v_cvt_pk_bf16_f32 v32, v172, v173
    v_cvt_pk_bf16_f32 v33, v174, v175
    buffer_store_dwordx2 v[32:33], v3, s[52:55], s7 offen offset:3072 sc1
L_convAB_79:
    s_mul_i32 s72, s4, 9
    s_lshr_b32 s72, s72, 1
    s_add_u32 s74, s72, s5
    s_and_b32 s75, s4, 1
    v_and_b32 v2, 15, v1
    v_lshrrev_b32 v3, 4, v1
    s_lshl_b32 s6, s3, 6
    v_add_u32 v4, s6, v2
    v_mul_u32_u24 v4, 1152, v4
    s_lshl_b32 s6, s74, 5
    v_lshl_add_u32 v4, v3, 3, v4
    v_add_u32 v59, s6, v4
    s_mov_b32 s6, 0
    buffer_load_dwordx2 v[144:145], v59, s[48:51], s6 offen
    s_mov_b32 s6, 18432
    buffer_load_dwordx2 v[146:147], v59, s[48:51], s6 offen
    s_mov_b32 s6, 36864
    buffer_load_dwordx2 v[148:149], v59, s[48:51], s6 offen
    s_mov_b32 s6, 55296
    buffer_load_dwordx2 v[150:151], v59, s[48:51], s6 offen
    s_lshl_b32 s6, s74, 5
    v_lshl_add_u32 v4, v3, 3, s6
    global_load_dwordx2 v[6:7], v4, s[38:39]
    v_lshlrev_b32 v3, 14, v3
    v_lshl_add_u32 v60, v2, 1, v3
    s_lshl_b32 s6, s74, 16
    s_lshl_b32 s7, s3, 7
    s_add_u32 s6, s6, s7
    s_add_u32 s76, s6, 12976128
    s_waitcnt vmcnt(5)
    v_mov_b32 v2, 163648
    v_mov_b32 v3, 1
    s_mov_b64 s[14:15], exec
    s_mov_b64 exec, 1
    ds_add_rtn_u32 v4, v2, v3
    s_waitcnt lgkmcnt(0)
    v_readfirstlane_b32 s6, v4
    s_cmp_lg_u32 s6, 3
    s_cbranch_scc1 L_cs_82
    s_and_b32 s6, s2, 7
    s_lshl_b32 s6, s6, 7
    s_add_u32 s6, s6, 34213888
    v_mov_b32 v2, 0
    buffer_atomic_add v3, v2, s[52:55], s6 offen sc1
L_cs_82:
    s_mov_b64 exec, s[14:15]
    s_lshl_b32 s6, s3, 7
    v_mov_b32 v2, s6
    s_mov_b32 s7, 34217984
    s_mov_b32 s6, 0
L_wcl_83:
    buffer_load_dword v3, v2, s[52:55], s7 offen sc1
    s_add_u32 s6, s6, 1
    s_cmp_gt_u32 s6, 2000000
    s_cbranch_scc1 L_wcl_d_84
    s_waitcnt vmcnt(0)
    v_cmp_gt_u32 vcc, 8, v3
    s_nop 4
    s_cbranch_vccz L_wcl_d_84
    s_sleep 6
    s_branch L_wcl_83
L_wcl_d_84:
    v_mov_b32 v8, 0x00003f80
    v_mov_b32 v9, 0x3f800000
    s_mul_i32 s6, s3, 589824
    s_lshl_b32 s7, s74, 11
    s_add_u32 s6, s6, s7
    s_add_u32 s78, s6, 15335424
    s_mov_b32 s79, 0
    s_add_u32 s6, s4, 1
    s_and_b32 s6, s6, 7
    s_mul_i32 s6, s6, 9
    s_lshr_b32 s6, s6, 1
    s_add_u32 s7, s74, 36
    s_sub_u32 s7, s7, s6
    s_sub_u32 s6, s7, 36
    s_min_u32 s7, s7, s6
    s_and_b32 s6, s7, 7
    s_cmp_lt_u32 s6, 4
    s_cselect_b32 s6, 1, 0
    s_cmp_ge_u32 s7, 32
    s_cselect_b32 s6, 1, s6
    s_lshl_b32 s6, s6, 1
    s_or_b32 s79, s79, s6
    s_add_u32 s6, s4, 2
    s_and_b32 s6, s6, 7
    s_mul_i32 s6, s6, 9
    s_lshr_b32 s6, s6, 1
    s_add_u32 s7, s74, 36
    s_sub_u32 s7, s7, s6
    s_sub_u32 s6, s7, 36
    s_min_u32 s7, s7, s6
    s_and_b32 s6, s7, 7
    s_cmp_lt_u32 s6, 4
    s_cselect_b32 s6, 1, 0
    s_cmp_ge_u32 s7, 32
    s_cselect_b32 s6, 1, s6
    s_lshl_b32 s6, s6, 2
    s_or_b32 s79, s79, s6
    s_add_u32 s6, s4, 3
    s_and_b32 s6, s6, 7
    s_mul_i32 s6, s6, 9
    s_lshr_b32 s6, s6, 1
    s_add_u32 s7, s74, 36
    s_sub_u32 s7, s7, s6
    s_sub_u32 s6, s7, 36
    s_min_u32 s7, s7, s6
    s_and_b32 s6, s7, 7
    s_cmp_lt_u32 s6, 4
    s_cselect_b32 s6, 1, 0
    s_cmp_ge_u32 s7, 32
    s_cselect_b32 s6, 1, s6
    s_lshl_b32 s6, s6, 3
    s_or_b32 s79, s79, s6
    s_add_u32 s6, s4, 4
    s_and_b32 s6, s6, 7
    s_mul_i32 s6, s6, 9
    s_lshr_b32 s6, s6, 1
    s_add_u32 s7, s74, 36
    s_sub_u32 s7, s7, s6
    s_sub_u32 s6, s7, 36
    s_min_u32 s7, s7, s6
    s_and_b32 s6, s7, 7
    s_cmp_lt_u32 s6, 4
    s_cselect_b32 s6, 1, 0
    s_cmp_ge_u32 s7, 32
    s_cselect_b32 s6, 1, s6
    s_lshl_b32 s6, s6, 4
    s_or_b32 s79, s79, s6
    s_add_u32 s6, s4, 5
    s_and_b32 s6, s6, 7
    s_mul_i32 s6, s6, 9
    s_lshr_b32 s6, s6, 1
    s_add_u32 s7, s74, 36
    s_sub_u32 s7, s7, s6
    s_sub_u32 s6, s7, 36
    s_min_u32 s7, s7, s6
    s_and_b32 s6, s7, 7
    s_cmp_lt_u32 s6, 4
    s_cselect_b32 s6, 1, 0
    s_cmp_ge_u32 s7, 32
    s_cselect_b32 s6, 1, s6
    s_lshl_b32 s6, s6, 5
    s_or_b32 s79, s79, s6
    s_add_u32 s6, s4, 6
    s_and_b32 s6, s6, 7
    s_mul_i32 s6, s6, 9
    s_lshr_b32 s6, s6, 1
    s_add_u32 s7, s74, 36
    s_sub_u32 s7, s7, s6
    s_sub_u32 s6, s7, 36
    s_min_u32 s7, s7, s6
    s_and_b32 s6, s7, 7
    s_cmp_lt_u32 s6, 4
    s_cselect_b32 s6, 1, 0
    s_cmp_ge_u32 s7, 32
    s_cselect_b32 s6, 1, s6
    s_lshl_b32 s6, s6, 6
    s_or_b32 s79, s79, s6
    s_add_u32 s6, s4, 7
    s_and_b32 s6, s6, 7
    s_mul_i32 s6, s6, 9
    s_lshr_b32 s6, s6, 1
    s_add_u32 s7, s74, 36
    s_sub_u32 s7, s7, s6
    s_sub_u32 s6, s7, 36
    s_min_u32 s7, s7, s6
    s_and_b32 s6, s7, 7
    s_cmp_lt_u32 s6, 4
    s_cselect_b32 s6, 1, 0
    s_cmp_ge_u32 s7, 32
    s_cselect_b32 s6, 1, s6
    s_lshl_b32 s6, s6, 7
    s_or_b32 s79, s79, s6
    s_mov_b32 s10, 268435456
    s_cmp_eq_u32 s5, 0
    s_cselect_b32 s8, s75, 0
    s_xor_b32 s9, s75, 1
    s_cmp_eq_u32 s5, 4
    s_cselect_b32 s9, s9, 0
    s_lshl_b32 s8, s8, 28
    s_lshl_b32 s9, s9, 28
    s_add_u32 s6, s4, 1
    s_and_b32 s6, s6, 7
    s_mul_i32 s6, s6, 73728
    s_add_u32 s6, s6, s78
    s_bitcmp1_b32 s79, 1
    s_cselect_b32 s6, s6, s10
    s_or_b32 s7, s6, s8
    buffer_load_dwordx4 v[168:171], v58, s[52:55], s7 offen offset:0 sc1
    s_or_b32 s7, s6, s9
    buffer_load_dwordx4 v[172:175], v58, s[52:55], s7 offen offset:1024 sc1
    s_add_u32 s6, s4, 2
    s_and_b32 s6, s6, 7
    s_mul_i32 s6, s6, 73728
    s_add_u32 s6, s6, s78
    s_bitcmp1_b32 s79, 2
    s_cselect_b32 s6, s6, s10
    s_or_b32 s7, s6, s8
    buffer_load_dwordx4 v[176:179], v58, s[52:55], s7 offen offset:0 sc1
    s_or_b32 s7, s6, s9
    buffer_load_dwordx4 v[180:183], v58, s[52:55], s7 offen offset:1024 sc1
    s_add_u32 s6, s4, 3
    s_and_b32 s6, s6, 7
    s_mul_i32 s6, s6, 73728
    s_add_u32 s6, s6, s78
    s_bitcmp1_b32 s79, 3
    s_cselect_b32 s6, s6, s10
    s_or_b32 s7, s6, s8
    buffer_load_dwordx4 v[184:187], v58, s[52:55], s7 offen offset:0 sc1
    s_or_b32 s7, s6, s9
    buffer_load_dwordx4 v[188:191], v58, s[52:55], s7 offen offset:1024 sc1
    s_add_u32 s6, s4, 4
    s_and_b32 s6, s6, 7
    s_mul_i32 s6, s6, 73728
    s_add_u32 s6, s6, s78
    s_bitcmp1_b32 s79, 4
    s_cselect_b32 s6, s6, s10
    s_or_b32 s7, s6, s8
    buffer_load_dwordx4 v[192:195], v58, s[52:55], s7 offen offset:0 sc1
    s_or_b32 s7, s6, s9
    buffer_load_dwordx4 v[196:199], v58, s[52:55], s7 offen offset:1024 sc1
    s_add_u32 s6, s4, 5
    s_and_b32 s6, s6, 7
    s_mul_i32 s6, s6, 73728
    s_add_u32 s6, s6, s78
    s_bitcmp1_b32 s79, 5
    s_cselect_b32 s6, s6, s10
    s_or_b32 s7, s6, s8
    buffer_load_dwordx4 v[200:203], v58, s[52:55], s7 offen offset:0 sc1
    s_or_b32 s7, s6, s9
    buffer_load_dwordx4 v[204:207], v58, s[52:55], s7 offen offset:1024 sc1
    s_add_u32 s6, s4, 6
    s_and_b32 s6, s6, 7
    s_mul_i32 s6, s6, 73728
    s_add_u32 s6, s6, s78
    s_bitcmp1_b32 s79, 6
    s_cselect_b32 s6, s6, s10
    s_or_b32 s7, s6, s8
    buffer_load_dwordx4 v[208:211], v58, s[52:55], s7 offen offset:0 sc1
    s_or_b32 s7, s6, s9
    buffer_load_dwordx4 v[212:215], v58, s[52:55], s7 offen offset:1024 sc1
    s_add_u32 s6, s4, 7
    s_and_b32 s6, s6, 7
    s_mul_i32 s6, s6, 73728
    s_add_u32 s6, s6, s78
    s_bitcmp1_b32 s79, 7
    s_cselect_b32 s6, s6, s10
    s_or_b32 s7, s6, s8
    buffer_load_dwordx4 v[216:219], v58, s[52:55], s7 offen offset:0 sc1
    s_or_b32 s7, s6, s9
    buffer_load_dwordx4 v[220:223], v58, s[52:55], s7 offen offset:1024 sc1
    s_waitcnt vmcnt(0)
    v_dot2_f32_bf16 v240, v168, v8, v240
    v_dot2_f32_bf16 v241, v168, v9, v241
    v_dot2_f32_bf16 v242, v169, v8, v242
    v_dot2_f32_bf16 v243, v169, v9, v243
    v_dot2_f32_bf16 v244, v170, v8, v244
    v_dot2_f32_bf16 v245, v170, v9, v245
    v_dot2_f32_bf16 v246, v171, v8, v246
    v_dot2_f32_bf16 v247, v171, v9, v247
    v_dot2_f32_bf16 v248, v172, v8, v248
    v_dot2_f32_bf16 v249, v172, v9, v249
    v_dot2_f32_bf16 v250, v173, v8, v250
    v_dot2_f32_bf16 v251, v173, v9, v251
    v_dot2_f32_bf16 v252, v174, v8, v252
    v_dot2_f32_bf16 v253, v174, v9, v253
    v_dot2_f32_bf16 v254, v175, v8, v254
    v_dot2_f32_bf16 v255, v175, v9, v255
    v_dot2_f32_bf16 v240, v176, v8, v240
    v_dot2_f32_bf16 v241, v176, v9, v241
    v_dot2_f32_bf16 v242, v177, v8, v242
    v_dot2_f32_bf16 v243, v177, v9, v243
    v_dot2_f32_bf16 v244, v178, v8, v244
    v_dot2_f32_bf16 v245, v178, v9, v245
    v_dot2_f32_bf16 v246, v179, v8, v246
    v_dot2_f32_bf16 v247, v179, v9, v247
    v_dot2_f32_bf16 v248, v180, v8, v248
    v_dot2_f32_bf16 v249, v180, v9, v249
    v_dot2_f32_bf16 v250, v181, v8, v250
    v_dot2_f32_bf16 v251, v181, v9, v251
    v_dot2_f32_bf16 v252, v182, v8, v252
    v_dot2_f32_bf16 v253, v182, v9, v253
    v_dot2_f32_bf16 v254, v183, v8, v254
    v_dot2_f32_bf16 v255, v183, v9, v255
    v_dot2_f32_bf16 v240, v184, v8, v240
    v_dot2_f32_bf16 v241, v184, v9, v241
    v_dot2_f32_bf16 v242, v185, v8, v242
    v_dot2_f32_bf16 v243, v185, v9, v243
    v_dot2_f32_bf16 v244, v186, v8, v244
    v_dot2_f32_bf16 v245, v186, v9, v245
    v_dot2_f32_bf16 v246, v187, v8, v246
    v_dot2_f32_bf16 v247, v187, v9, v247
    v_dot2_f32_bf16 v248, v188, v8, v248
    v_dot2_f32_bf16 v249, v188, v9, v249
    v_dot2_f32_bf16 v250, v189, v8, v250
    v_dot2_f32_bf16 v251, v189, v9, v251
    v_dot2_f32_bf16 v252, v190, v8, v252
    v_dot2_f32_bf16 v253, v190, v9, v253
    v_dot2_f32_bf16 v254, v191, v8, v254
    v_dot2_f32_bf16 v255, v191, v9, v255
    v_dot2_f32_bf16 v240, v192, v8, v240
    v_dot2_f32_bf16 v241, v192, v9, v241
    v_dot2_f32_bf16 v242, v193, v8, v242
    v_dot2_f32_bf16 v243, v193, v9, v243
    v_dot2_f32_bf16 v244, v194, v8, v244
    v_dot2_f32_bf16 v245, v194, v9, v245
    v_dot2_f32_bf16 v246, v195, v8, v246
    v_dot2_f32_bf16 v247, v195, v9, v247
    v_dot2_f32_bf16 v248, v196, v8, v248
    v_dot2_f32_bf16 v249, v196, v9, v249
    v_dot2_f32_bf16 v250, v197, v8, v250
    v_dot2_f32_bf16 v251, v197, v9, v251
    v_dot2_f32_bf16 v252, v198, v8, v252
    v_dot2_f32_bf16 v253, v198, v9, v253
    v_dot2_f32_bf16 v254, v199, v8, v254
    v_dot2_f32_bf16 v255, v199, v9, v255
    v_dot2_f32_bf16 v240, v200, v8, v240
    v_dot2_f32_bf16 v241, v200, v9, v241
    v_dot2_f32_bf16 v242, v201, v8, v242
    v_dot2_f32_bf16 v243, v201, v9, v243
    v_dot2_f32_bf16 v244, v202, v8, v244
    v_dot2_f32_bf16 v245, v202, v9, v245
    v_dot2_f32_bf16 v246, v203, v8, v246
    v_dot2_f32_bf16 v247, v203, v9, v247
    v_dot2_f32_bf16 v248, v204, v8, v248
    v_dot2_f32_bf16 v249, v204, v9, v249
    v_dot2_f32_bf16 v250, v205, v8, v250
    v_dot2_f32_bf16 v251, v205, v9, v251
    v_dot2_f32_bf16 v252, v206, v8, v252
    v_dot2_f32_bf16 v253, v206, v9, v253
    v_dot2_f32_bf16 v254, v207, v8, v254
    v_dot2_f32_bf16 v255, v207, v9, v255
    v_dot2_f32_bf16 v240, v208, v8, v240
    v_dot2_f32_bf16 v241, v208, v9, v241
    v_dot2_f32_bf16 v242, v209, v8, v242
    v_dot2_f32_bf16 v243, v209, v9, v243
    v_dot2_f32_bf16 v244, v210, v8, v244
    v_dot2_f32_bf16 v245, v210, v9, v245
    v_dot2_f32_bf16 v246, v211, v8, v246
    v_dot2_f32_bf16 v247, v211, v9, v247
    v_dot2_f32_bf16 v248, v212, v8, v248
    v_dot2_f32_bf16 v249, v212, v9, v249
    v_dot2_f32_bf16 v250, v213, v8, v250
    v_dot2_f32_bf16 v251, v213, v9, v251
    v_dot2_f32_bf16 v252, v214, v8, v252
    v_dot2_f32_bf16 v253, v214, v9, v253
    v_dot2_f32_bf16 v254, v215, v8, v254
    v_dot2_f32_bf16 v255, v215, v9, v255
    v_dot2_f32_bf16 v240, v216, v8, v240
    v_dot2_f32_bf16 v241, v216, v9, v241
    v_dot2_f32_bf16 v242, v217, v8, v242
    v_dot2_f32_bf16 v243, v217, v9, v243
    v_dot2_f32_bf16 v244, v218, v8, v244
    v_dot2_f32_bf16 v245, v218, v9, v245
    v_dot2_f32_bf16 v246, v219, v8, v246
    v_dot2_f32_bf16 v247, v219, v9, v247
    v_dot2_f32_bf16 v248, v220, v8, v248
    v_dot2_f32_bf16 v249, v220, v9, v249
    v_dot2_f32_bf16 v250, v221, v8, v250
    v_dot2_f32_bf16 v251, v221, v9, v251
    v_dot2_f32_bf16 v252, v222, v8, v252
    v_dot2_f32_bf16 v253, v222, v9, v253
    v_dot2_f32_bf16 v254, v223, v8, v254
    v_dot2_f32_bf16 v255, v223, v9, v255
    s_branch L_fin_41
L_n5_40:
    v_and_b32 v2, 15, v1
    v_lshrrev_b32 v3, 4, v1
    v_xor_b32 v2, v2, v3
    v_lshl_add_u32 v4, v3, 4, v2
    v_lshlrev_b32 v56, 4, v4
    v_xor_b32 v2, 4, v2
    v_lshl_add_u32 v4, v3, 4, v2
    v_lshlrev_b32 v57, 4, v4
    v_lshlrev_b32 v3, 4, v3
    s_lshl_b32 s6, s5, 8
    s_add_u32 s6, s6, 161280
    v_add_u32 v4, s6, v3
    ds_read_b128 v[64:67], v4 offset:0
    ds_read_b128 v[68:71], v4 offset:0
    ds_read_b128 v[72:75], v4 offset:0
    ds_read_b128 v[76:79], v4 offset:0
    ds_read_b128 v[80:83], v4 offset:64
    ds_read_b128 v[84:87], v4 offset:64
    ds_read_b128 v[88:91], v4 offset:64
    ds_read_b128 v[92:95], v4 offset:64
    ds_read_b128 v[96:99], v4 offset:128
    ds_read_b128 v[100:103], v4 offset:128
    ds_read_b128 v[104:107], v4 offset:128
    ds_read_b128 v[108:111], v4 offset:128
    ds_read_b128 v[112:115], v4 offset:192
    ds_read_b128 v[116:119], v4 offset:192
    ds_read_b128 v[120:123], v4 offset:192
    ds_read_b128 v[124:127], v4 offset:192
    ds_read_b128 v[144:147], v56 offset:0
    ds_read_b128 v[148:151], v56 offset:1024
    ds_read_b128 v[152:155], v56 offset:2048
    ds_read_b128 v[156:159], v56 offset:3072
    s_waitcnt vmcnt(4)
    ds_read_b64_tr_b16 v[176:177], v216 offset:0
    ds_read_b64_tr_b16 v[178:179], v216 offset:512
    ds_read_b64_tr_b16 v[180:181], v217 offset:0
    ds_read_b64_tr_b16 v[182:183], v217 offset:512
    ds_read_b64_tr_b16 v[184:185], v218 offset:0
    ds_read_b64_tr_b16 v[186:187], v218 offset:512
    ds_read_b64_tr_b16 v[188:189], v219 offset:0
    ds_read_b64_tr_b16 v[190:191], v219 offset:512
    s_waitcnt lgkmcnt(0)
    s_add_u32 m0, s80, 0
    s_nop 0
    buffer_load_dwordx4 v222, s[56:59], s81 offen lds
    s_add_u32 m0, s80, 1024
    s_add_u32 s7, s81, 73728
    buffer_load_dwordx4 v223, s[56:59], s7 offen lds
    s_add_u32 m0, s80, 2048
    s_add_u32 s7, s81, 147456
    buffer_load_dwordx4 v222, s[56:59], s7 offen lds
    s_add_u32 m0, s80, 3072
    s_add_u32 s7, s81, 221184
    buffer_load_dwordx4 v223, s[56:59], s7 offen lds
    s_add_u32 s81, s81, 294912
    s_mov_b32 s78, 7
L_g1_85:
    s_waitcnt vmcnt(4)
    ds_read_b64_tr_b16 v[196:197], v216 offset:4096
    v_mfma_f32_16x16x32_bf16 v[64:67], v[176:179], v[144:147], v[64:67]
    ds_read_b64_tr_b16 v[198:199], v216 offset:4608
    v_mfma_f32_16x16x32_bf16 v[68:71], v[176:179], v[148:151], v[68:71]
    ds_read_b64_tr_b16 v[200:201], v217 offset:4096
    v_mfma_f32_16x16x32_bf16 v[72:75], v[176:179], v[152:155], v[72:75]
    ds_read_b64_tr_b16 v[202:203], v217 offset:4608
    v_mfma_f32_16x16x32_bf16 v[76:79], v[176:179], v[156:159], v[76:79]
    ds_read_b64_tr_b16 v[204:205], v218 offset:4096
    v_mfma_f32_16x16x32_bf16 v[80:83], v[180:183], v[144:147], v[80:83]
    ds_read_b64_tr_b16 v[206:207], v218 offset:4608
    v_mfma_f32_16x16x32_bf16 v[84:87], v[180:183], v[148:151], v[84:87]
    ds_read_b64_tr_b16 v[208:209], v219 offset:4096
    v_mfma_f32_16x16x32_bf16 v[88:91], v[180:183], v[152:155], v[88:91]
    ds_read_b64_tr_b16 v[210:211], v219 offset:4608
    v_mfma_f32_16x16x32_bf16 v[92:95], v[180:183], v[156:159], v[92:95]
    ds_read_b128 v[160:163], v57 offset:4096
    v_mfma_f32_16x16x32_bf16 v[96:99], v[184:187], v[144:147], v[96:99]
    ds_read_b128 v[164:167], v57 offset:5120
    v_mfma_f32_16x16x32_bf16 v[100:103], v[184:187], v[148:151], v[100:103]
    ds_read_b128 v[168:171], v57 offset:6144
    v_mfma_f32_16x16x32_bf16 v[104:107], v[184:187], v[152:155], v[104:107]
    ds_read_b128 v[172:175], v57 offset:7168
    v_mfma_f32_16x16x32_bf16 v[108:111], v[184:187], v[156:159], v[108:111]
    v_mfma_f32_16x16x32_bf16 v[112:115], v[188:191], v[144:147], v[112:115]
    s_waitcnt lgkmcnt(0)
    s_add_u32 m0, s80, 4096
    s_nop 0
    buffer_load_dwordx4 v222, s[56:59], s81 offen lds
    s_add_u32 m0, s80, 5120
    s_add_u32 s7, s81, 73728
    buffer_load_dwordx4 v223, s[56:59], s7 offen lds
    s_add_u32 m0, s80, 6144
    s_add_u32 s7, s81, 147456
    buffer_load_dwordx4 v222, s[56:59], s7 offen lds
    s_add_u32 m0, s80, 7168
    s_add_u32 s7, s81, 221184
    buffer_load_dwordx4 v223, s[56:59], s7 offen lds
    s_add_u32 s81, s81, 294912
    v_mfma_f32_16x16x32_bf16 v[116:119], v[188:191], v[148:151], v[116:119]
    v_mfma_f32_16x16x32_bf16 v[120:123], v[188:191], v[152:155], v[120:123]
    v_mfma_f32_16x16x32_bf16 v[124:127], v[188:191], v[156:159], v[124:127]
    s_waitcnt lgkmcnt(0)
    s_waitcnt vmcnt(4)
    ds_read_b64_tr_b16 v[176:177], v216 offset:0
    v_mfma_f32_16x16x32_bf16 v[64:67], v[196:199], v[160:163], v[64:67]
    ds_read_b64_tr_b16 v[178:179], v216 offset:512
    v_mfma_f32_16x16x32_bf16 v[68:71], v[196:199], v[164:167], v[68:71]
    ds_read_b64_tr_b16 v[180:181], v217 offset:0
    v_mfma_f32_16x16x32_bf16 v[72:75], v[196:199], v[168:171], v[72:75]
    ds_read_b64_tr_b16 v[182:183], v217 offset:512
    v_mfma_f32_16x16x32_bf16 v[76:79], v[196:199], v[172:175], v[76:79]
    ds_read_b64_tr_b16 v[184:185], v218 offset:0
    v_mfma_f32_16x16x32_bf16 v[80:83], v[200:203], v[160:163], v[80:83]
    ds_read_b64_tr_b16 v[186:187], v218 offset:512
    v_mfma_f32_16x16x32_bf16 v[84:87], v[200:203], v[164:167], v[84:87]
    ds_read_b64_tr_b16 v[188:189], v219 offset:0
    v_mfma_f32_16x16x32_bf16 v[88:91], v[200:203], v[168:171], v[88:91]
    ds_read_b64_tr_b16 v[190:191], v219 offset:512
    v_mfma_f32_16x16x32_bf16 v[92:95], v[200:203], v[172:175], v[92:95]
    ds_read_b128 v[144:147], v56 offset:8192
    v_mfma_f32_16x16x32_bf16 v[96:99], v[204:207], v[160:163], v[96:99]
    ds_read_b128 v[148:151], v56 offset:9216
    v_mfma_f32_16x16x32_bf16 v[100:103], v[204:207], v[164:167], v[100:103]
    ds_read_b128 v[152:155], v56 offset:10240
    v_mfma_f32_16x16x32_bf16 v[104:107], v[204:207], v[168:171], v[104:107]
    ds_read_b128 v[156:159], v56 offset:11264
    v_mfma_f32_16x16x32_bf16 v[108:111], v[204:207], v[172:175], v[108:111]
    v_mfma_f32_16x16x32_bf16 v[112:115], v[208:211], v[160:163], v[112:115]
    s_waitcnt lgkmcnt(0)
    s_add_u32 m0, s80, 0
    s_nop 0
    buffer_load_dwordx4 v222, s[56:59], s81 offen lds
    s_add_u32 m0, s80, 1024
    s_add_u32 s7, s81, 73728
    buffer_load_dwordx4 v223, s[56:59], s7 offen lds
    s_add_u32 m0, s80, 2048
    s_add_u32 s7, s81, 147456
    buffer_load_dwordx4 v222, s[56:59], s7 offen lds
    s_add_u32 m0, s80, 3072
    s_add_u32 s7, s81, 221184
    buffer_load_dwordx4 v223, s[56:59], s7 offen lds
    s_add_u32 s81, s81, 294912
    v_mfma_f32_16x16x32_bf16 v[116:119], v[208:211], v[164:167], v[116:119]
    v_mfma_f32_16x16x32_bf16 v[120:123], v[208:211], v[168:171], v[120:123]
    v_mfma_f32_16x16x32_bf16 v[124:127], v[208:211], v[172:175], v[124:127]
    s_waitcnt lgkmcnt(0)
    v_add_u32 v56, 8192, v56
    v_add_u32 v57, 8192, v57
    s_sub_u32 s78, s78, 1
    s_cmp_lg_u32 s78, 1
    s_cbranch_scc1 L_hk_86
    v_and_b32 v2, 3, v1
    v_lshlrev_b32 v2, 6, v2
    v_add_u32 v63, 0, v2
    buffer_load_dword v62, v63, s[68:71], 0 offen sc1
L_hk_86:
    s_cmp_lg_u32 s78, 0
    s_cbranch_scc1 L_g1_85
    s_waitcnt vmcnt(4)
    ds_read_b64_tr_b16 v[196:197], v216 offset:4096
    v_mfma_f32_16x16x32_bf16 v[64:67], v[176:179], v[144:147], v[64:67]
    ds_read_b64_tr_b16 v[198:199], v216 offset:4608
    v_mfma_f32_16x16x32_bf16 v[68:71], v[176:179], v[148:151], v[68:71]
    ds_read_b64_tr_b16 v[200:201], v217 offset:4096
    v_mfma_f32_16x16x32_bf16 v[72:75], v[176:179], v[152:155], v[72:75]
    ds_read_b64_tr_b16 v[202:203], v217 offset:4608
    v_mfma_f32_16x16x32_bf16 v[76:79], v[176:179], v[156:159], v[76:79]
    ds_read_b64_tr_b16 v[204:205], v218 offset:4096
    v_mfma_f32_16x16x32_bf16 v[80:83], v[180:183], v[144:147], v[80:83]
    ds_read_b64_tr_b16 v[206:207], v218 offset:4608
    v_mfma_f32_16x16x32_bf16 v[84:87], v[180:183], v[148:151], v[84:87]
    ds_read_b64_tr_b16 v[208:209], v219 offset:4096
    v_mfma_f32_16x16x32_bf16 v[88:91], v[180:183], v[152:155], v[88:91]
    ds_read_b64_tr_b16 v[210:211], v219 offset:4608
    v_mfma_f32_16x16x32_bf16 v[92:95], v[180:183], v[156:159], v[92:95]
    ds_read_b128 v[160:163], v57 offset:4096
    v_mfma_f32_16x16x32_bf16 v[96:99], v[184:187], v[144:147], v[96:99]
    ds_read_b128 v[164:167], v57 offset:5120
    v_mfma_f32_16x16x32_bf16 v[100:103], v[184:187], v[148:151], v[100:103]
    ds_read_b128 v[168:171], v57 offset:6144
    v_mfma_f32_16x16x32_bf16 v[104:107], v[184:187], v[152:155], v[104:107]
    ds_read_b128 v[172:175], v57 offset:7168
    v_mfma_f32_16x16x32_bf16 v[108:111], v[184:187], v[156:159], v[108:111]
    v_mfma_f32_16x16x32_bf16 v[112:115], v[188:191], v[144:147], v[112:115]
    s_waitcnt lgkmcnt(0)
    s_add_u32 m0, s80, 4096
    s_nop 0
    buffer_load_dwordx4 v222, s[56:59], s81 offen lds
    s_add_u32 m0, s80, 5120
    s_add_u32 s7, s81, 73728
    buffer_load_dwordx4 v223, s[56:59], s7 offen lds
    s_add_u32 m0, s80, 6144
    s_add_u32 s7, s81, 147456
    buffer_load_dwordx4 v222, s[56:59], s7 offen lds
    s_add_u32 m0, s80, 7168
    s_add_u32 s7, s81, 221184
    buffer_load_dwordx4 v223, s[56:59], s7 offen lds
    s_add_u32 s81, s81, 294912
    v_mfma_f32_16x16x32_bf16 v[116:119], v[188:191], v[148:151], v[116:119]
    v_mfma_f32_16x16x32_bf16 v[120:123], v[188:191], v[152:155], v[120:123]
    v_mfma_f32_16x16x32_bf16 v[124:127], v[188:191], v[156:159], v[124:127]
    s_waitcnt lgkmcnt(0)
    s_waitcnt vmcnt(4)
    ds_read_b64_tr_b16 v[176:177], v216 offset:0
    v_mfma_f32_16x16x32_bf16 v[64:67], v[196:199], v[160:163], v[64:67]
    ds_read_b64_tr_b16 v[178:179], v216 offset:512
    v_mfma_f32_16x16x32_bf16 v[68:71], v[196:199], v[164:167], v[68:71]
    ds_read_b64_tr_b16 v[180:181], v217 offset:0
    v_mfma_f32_16x16x32_bf16 v[72:75], v[196:199], v[168:171], v[72:75]
    ds_read_b64_tr_b16 v[182:183], v217 offset:512
    v_mfma_f32_16x16x32_bf16 v[76:79], v[196:199], v[172:175], v[76:79]
    ds_read_b64_tr_b16 v[184:185], v218 offset:0
    v_mfma_f32_16x16x32_bf16 v[80:83], v[200:203], v[160:163], v[80:83]
    ds_read_b64_tr_b16 v[186:187], v218 offset:512
    v_mfma_f32_16x16x32_bf16 v[84:87], v[200:203], v[164:167], v[84:87]
    ds_read_b64_tr_b16 v[188:189], v219 offset:0
    v_mfma_f32_16x16x32_bf16 v[88:91], v[200:203], v[168:171], v[88:91]
    ds_read_b64_tr_b16 v[190:191], v219 offset:512
    v_mfma_f32_16x16x32_bf16 v[92:95], v[200:203], v[172:175], v[92:95]
    ds_read_b128 v[144:147], v56 offset:8192
    v_mfma_f32_16x16x32_bf16 v[96:99], v[204:207], v[160:163], v[96:99]
    ds_read_b128 v[148:151], v56 offset:9216
    v_mfma_f32_16x16x32_bf16 v[100:103], v[204:207], v[164:167], v[100:103]
    ds_read_b128 v[152:155], v56 offset:10240
    v_mfma_f32_16x16x32_bf16 v[104:107], v[204:207], v[168:171], v[104:107]
    ds_read_b128 v[156:159], v56 offset:11264
    v_mfma_f32_16x16x32_bf16 v[108:111], v[204:207], v[172:175], v[108:111]
    v_mfma_f32_16x16x32_bf16 v[112:115], v[208:211], v[160:163], v[112:115]
    v_mfma_f32_16x16x32_bf16 v[116:119], v[208:211], v[164:167], v[116:119]
    v_mfma_f32_16x16x32_bf16 v[120:123], v[208:211], v[168:171], v[120:123]
    v_mfma_f32_16x16x32_bf16 v[124:127], v[208:211], v[172:175], v[124:127]
    s_waitcnt lgkmcnt(0)
    v_add_u32 v56, 8192, v56
    v_add_u32 v57, 8192, v57
    s_waitcnt vmcnt(0)
    ds_read_b64_tr_b16 v[196:197], v216 offset:4096
    v_mfma_f32_16x16x32_bf16 v[64:67], v[176:179], v[144:147], v[64:67]
    ds_read_b64_tr_b16 v[198:199], v216 offset:4608
    v_mfma_f32_16x16x32_bf16 v[68:71], v[176:179], v[148:151], v[68:71]
    ds_read_b64_tr_b16 v[200:201], v217 offset:4096
    v_mfma_f32_16x16x32_bf16 v[72:75], v[176:179], v[152:155], v[72:75]
    ds_read_b64_tr_b16 v[202:203], v217 offset:4608
    v_mfma_f32_16x16x32_bf16 v[76:79], v[176:179], v[156:159], v[76:79]
    ds_read_b64_tr_b16 v[204:205], v218 offset:4096
    v_mfma_f32_16x16x32_bf16 v[80:83], v[180:183], v[144:147], v[80:83]
    ds_read_b64_tr_b16 v[206:207], v218 offset:4608
    v_mfma_f32_16x16x32_bf16 v[84:87], v[180:183], v[148:151], v[84:87]
    ds_read_b64_tr_b16 v[208:209], v219 offset:4096
    v_mfma_f32_16x16x32_bf16 v[88:91], v[180:183], v[152:155], v[88:91]
    ds_read_b64_tr_b16 v[210:211], v219 offset:4608
    v_mfma_f32_16x16x32_bf16 v[92:95], v[180:183], v[156:159], v[92:95]
    ds_read_b128 v[160:163], v57 offset:4096
    v_mfma_f32_16x16x32_bf16 v[96:99], v[184:187], v[144:147], v[96:99]
    ds_read_b128 v[164:167], v57 offset:5120
    v_mfma_f32_16x16x32_bf16 v[100:103], v[184:187], v[148:151], v[100:103]
    ds_read_b128 v[168:171], v57 offset:6144
    v_mfma_f32_16x16x32_bf16 v[104:107], v[184:187], v[152:155], v[104:107]
    ds_read_b128 v[172:175], v57 offset:7168
    v_mfma_f32_16x16x32_bf16 v[108:111], v[184:187], v[156:159], v[108:111]
    v_mfma_f32_16x16x32_bf16 v[112:115], v[188:191], v[144:147], v[112:115]
    v_mfma_f32_16x16x32_bf16 v[116:119], v[188:191], v[148:151], v[116:119]
    v_mfma_f32_16x16x32_bf16 v[120:123], v[188:191], v[152:155], v[120:123]
    v_mfma_f32_16x16x32_bf16 v[124:127], v[188:191], v[156:159], v[124:127]
    s_waitcnt lgkmcnt(0)
    v_mfma_f32_16x16x32_bf16 v[64:67], v[196:199], v[160:163], v[64:67]
    v_mfma_f32_16x16x32_bf16 v[68:71], v[196:199], v[164:167], v[68:71]
    v_mfma_f32_16x16x32_bf16 v[72:75], v[196:199], v[168:171], v[72:75]
    v_mfma_f32_16x16x32_bf16 v[76:79], v[196:199], v[172:175], v[76:79]
    v_mfma_f32_16x16x32_bf16 v[80:83], v[200:203], v[160:163], v[80:83]
    v_mfma_f32_16x16x32_bf16 v[84:87], v[200:203], v[164:167], v[84:87]
    v_mfma_f32_16x16x32_bf16 v[88:91], v[200:203], v[168:171], v[88:91]
    v_mfma_f32_16x16x32_bf16 v[92:95], v[200:203], v[172:175], v[92:95]
    v_mfma_f32_16x16x32_bf16 v[96:99], v[204:207], v[160:163], v[96:99]
    v_mfma_f32_16x16x32_bf16 v[100:103], v[204:207], v[164:167], v[100:103]
    v_mfma_f32_16x16x32_bf16 v[104:107], v[204:207], v[168:171], v[104:107]
    v_mfma_f32_16x16x32_bf16 v[108:111], v[204:207], v[172:175], v[108:111]
    v_mfma_f32_16x16x32_bf16 v[112:115], v[208:211], v[160:163], v[112:115]
    v_mfma_f32_16x16x32_bf16 v[116:119], v[208:211], v[164:167], v[116:119]
    v_mfma_f32_16x16x32_bf16 v[120:123], v[208:211], v[168:171], v[120:123]
    v_mfma_f32_16x16x32_bf16 v[124:127], v[208:211], v[172:175], v[124:127]
    s_waitcnt lgkmcnt(0)
    s_mov_b32 s6, 0
    v_cmp_gt_u32 vcc, 64, v62
    s_nop 4
    s_cbranch_vccz L_pc_done_88
    buffer_load_dword v62, v63, s[68:71], 0 offen sc1
L_pc_87:
    s_waitcnt vmcnt(0)
    v_cmp_gt_u32 vcc, 64, v62
    s_nop 4
    s_cbranch_vccz L_pc_done_88
    s_add_u32 s6, s6, 1
    s_cmp_gt_u32 s6, 2000000
    s_cbranch_scc1 L_pc_done_88
    s_sleep 2
    buffer_load_dword v62, v63, s[68:71], 0 offen sc1
    s_branch L_pc_87
L_pc_done_88:
    s_lshr_b32 s6, s2, 3
    s_and_b32 s6, s6, 15
    s_mul_i32 s6, s6, 4608
    s_add_u32 s6, s6, s77
    v_lshlrev_b32 v2, 7, v1
    v_cmp_gt_u32 vcc, 36, v1
    s_and_saveexec_b64 s[14:15], vcc
    buffer_load_dword v61, v2, s[52:55], s6 offen sc1
    s_mov_b64 exec, s[14:15]
    s_add_u32 s62, s77, 73728
    buffer_load_dwordx4 v[176:179], v58, s[60:63], s77 offen offset:0 sc1
    buffer_load_dwordx4 v[180:183], v58, s[60:63], s77 offen offset:1024 sc1
    buffer_load_dwordx4 v[184:187], v58, s[60:63], s77 offen offset:2048 sc1
    buffer_load_dwordx4 v[188:191], v58, s[60:63], s77 offen offset:3072 sc1
    s_add_u32 s77, s77, 4096
    buffer_load_dwordx4 v[192:195], v58, s[60:63], s77 offen offset:0 sc1
    buffer_load_dwordx4 v[196:199], v58, s[60:63], s77 offen offset:1024 sc1
    buffer_load_dwordx4 v[200:203], v58, s[60:63], s77 offen offset:2048 sc1
    buffer_load_dwordx4 v[204:207], v58, s[60:63], s77 offen offset:3072 sc1
    s_add_u32 s77, s77, 4096
    buffer_load_dwordx4 v[208:211], v58, s[60:63], s77 offen offset:0 sc1
    s_add_u32 s77, s77, 1024
    v_mov_b32 v12, 0xbdd2d3e8
    s_barrier
    v_mul_f32 v8, v64, v64
    v_mul_f32 v9, v65, v65
    v_mul_f32 v10, v66, v66
    v_mul_f32 v11, v67, v67
    v_fmaak_f32 v8, v8, v12, 0xc0135761
    v_fmaak_f32 v9, v9, v12, 0xc0135761
    v_fmaak_f32 v10, v10, v12, 0xc0135761
    v_fmaak_f32 v11, v11, v12, 0xc0135761
    v_mul_f32 v8, v64, v8
    v_mul_f32 v9, v65, v9
    v_mul_f32 v10, v66, v10
    v_mul_f32 v11, v67, v11
    v_exp_f32 v8, v8
    v_exp_f32 v9, v9
    v_exp_f32 v10, v10
    v_exp_f32 v11, v11
    v_add_f32 v8, 1.0, v8
    v_add_f32 v9, 1.0, v9
    v_add_f32 v10, 1.0, v10
    v_add_f32 v11, 1.0, v11
    v_rcp_f32 v8, v8
    v_rcp_f32 v9, v9
    v_rcp_f32 v10, v10
    v_rcp_f32 v11, v11
    v_mul_f32 v64, v64, v8
    v_mul_f32 v65, v65, v9
    v_mul_f32 v66, v66, v10
    v_mul_f32 v67, v67, v11
    v_cvt_pk_bf16_f32 v64, v64, v65
    v_cvt_pk_bf16_f32 v65, v66, v67
    v_mul_f32 v8, v80, v80
    v_mul_f32 v9, v81, v81
    v_mul_f32 v10, v82, v82
    v_mul_f32 v11, v83, v83
    v_fmaak_f32 v8, v8, v12, 0xc0135761
    v_fmaak_f32 v9, v9, v12, 0xc0135761
    v_fmaak_f32 v10, v10, v12, 0xc0135761
    v_fmaak_f32 v11, v11, v12, 0xc0135761
    v_mul_f32 v8, v80, v8
    v_mul_f32 v9, v81, v9
    v_mul_f32 v10, v82, v10
    v_mul_f32 v11, v83, v11
    v_exp_f32 v8, v8
    v_exp_f32 v9, v9
    v_exp_f32 v10, v10
    v_exp_f32 v11, v11
    v_add_f32 v8, 1.0, v8
    v_add_f32 v9, 1.0, v9
    v_add_f32 v10, 1.0, v10
    v_add_f32 v11, 1.0, v11
    v_rcp_f32 v8, v8
    v_rcp_f32 v9, v9
    v_rcp_f32 v10, v10
    v_rcp_f32 v11, v11
    v_mul_f32 v80, v80, v8
    v_mul_f32 v81, v81, v9
    v_mul_f32 v82, v82, v10
    v_mul_f32 v83, v83, v11
    v_cvt_pk_bf16_f32 v66, v80, v81
    v_cvt_pk_bf16_f32 v67, v82, v83
    v_mul_f32 v8, v68, v68
    v_mul_f32 v9, v69, v69
    v_mul_f32 v10, v70, v70
    v_mul_f32 v11, v71, v71
    v_fmaak_f32 v8, v8, v12, 0xc0135761
    v_fmaak_f32 v9, v9, v12, 0xc0135761
    v_fmaak_f32 v10, v10, v12, 0xc0135761
    v_fmaak_f32 v11, v11, v12, 0xc0135761
    v_mul_f32 v8, v68, v8
    v_mul_f32 v9, v69, v9
    v_mul_f32 v10, v70, v10
    v_mul_f32 v11, v71, v11
    v_exp_f32 v8, v8
    v_exp_f32 v9, v9
    v_exp_f32 v10, v10
    v_exp_f32 v11, v11
    v_add_f32 v8, 1.0, v8
    v_add_f32 v9, 1.0, v9
    v_add_f32 v10, 1.0, v10
    v_add_f32 v11, 1.0, v11
    v_rcp_f32 v8, v8
    v_rcp_f32 v9, v9
    v_rcp_f32 v10, v10
    v_rcp_f32 v11, v11
    v_mul_f32 v68, v68, v8
    v_mul_f32 v69, v69, v9
    v_mul_f32 v70, v70, v10
    v_mul_f32 v71, v71, v11
    v_cvt_pk_bf16_f32 v68, v68, v69
    v_cvt_pk_bf16_f32 v69, v70, v71
    v_mul_f32 v8, v84, v84
    v_mul_f32 v9, v85, v85
    v_mul_f32 v10, v86, v86
    v_mul_f32 v11, v87, v87
    v_fmaak_f32 v8, v8, v12, 0xc0135761
    v_fmaak_f32 v9, v9, v12, 0xc0135761
    v_fmaak_f32 v10, v10, v12, 0xc0135761
    v_fmaak_f32 v11, v11, v12, 0xc0135761
    v_mul_f32 v8, v84, v8
    v_mul_f32 v9, v85, v9
    v_mul_f32 v10, v86, v10
    v_mul_f32 v11, v87, v11
    v_exp_f32 v8, v8
    v_exp_f32 v9, v9
    v_exp_f32 v10, v10
    v_exp_f32 v11, v11
    v_add_f32 v8, 1.0, v8
    v_add_f32 v9, 1.0, v9
    v_add_f32 v10, 1.0, v10
    v_add_f32 v11, 1.0, v11
    v_rcp_f32 v8, v8
    v_rcp_f32 v9, v9
    v_rcp_f32 v10, v10
    v_rcp_f32 v11, v11
    v_mul_f32 v84, v84, v8
    v_mul_f32 v85, v85, v9
    v_mul_f32 v86, v86, v10
    v_mul_f32 v87, v87, v11
    v_cvt_pk_bf16_f32 v70, v84, v85
    v_cvt_pk_bf16_f32 v71, v86, v87
    v_mul_f32 v8, v72, v72
    v_mul_f32 v9, v73, v73
    v_mul_f32 v10, v74, v74
    v_mul_f32 v11, v75, v75
    v_fmaak_f32 v8, v8, v12, 0xc0135761
    v_fmaak_f32 v9, v9, v12, 0xc0135761
    v_fmaak_f32 v10, v10, v12, 0xc0135761
    v_fmaak_f32 v11, v11, v12, 0xc0135761
    v_mul_f32 v8, v72, v8
    v_mul_f32 v9, v73, v9
    v_mul_f32 v10, v74, v10
    v_mul_f32 v11, v75, v11
    v_exp_f32 v8, v8
    v_exp_f32 v9, v9
    v_exp_f32 v10, v10
    v_exp_f32 v11, v11
    v_add_f32 v8, 1.0, v8
    v_add_f32 v9, 1.0, v9
    v_add_f32 v10, 1.0, v10
    v_add_f32 v11, 1.0, v11
    v_rcp_f32 v8, v8
    v_rcp_f32 v9, v9
    v_rcp_f32 v10, v10
    v_rcp_f32 v11, v11
    v_mul_f32 v72, v72, v8
    v_mul_f32 v73, v73, v9
    v_mul_f32 v74, v74, v10
    v_mul_f32 v75, v75, v11
    v_cvt_pk_bf16_f32 v72, v72, v73
    v_cvt_pk_bf16_f32 v73, v74, v75
    v_mul_f32 v8, v88, v88
    v_mul_f32 v9, v89, v89
    v_mul_f32 v10, v90, v90
    v_mul_f32 v11, v91, v91
    v_fmaak_f32 v8, v8, v12, 0xc0135761
    v_fmaak_f32 v9, v9, v12, 0xc0135761
    v_fmaak_f32 v10, v10, v12, 0xc0135761
    v_fmaak_f32 v11, v11, v12, 0xc0135761
    v_mul_f32 v8, v88, v8
    v_mul_f32 v9, v89, v9
    v_mul_f32 v10, v90, v10
    v_mul_f32 v11, v91, v11
    v_exp_f32 v8, v8
    v_exp_f32 v9, v9
    v_exp_f32 v10, v10
    v_exp_f32 v11, v11
    v_add_f32 v8, 1.0, v8
    v_add_f32 v9, 1.0, v9
    v_add_f32 v10, 1.0, v10
    v_add_f32 v11, 1.0, v11
    v_rcp_f32 v8, v8
    v_rcp_f32 v9, v9
    v_rcp_f32 v10, v10
    v_rcp_f32 v11, v11
    v_mul_f32 v88, v88, v8
    v_mul_f32 v89, v89, v9
    v_mul_f32 v90, v90, v10
    v_mul_f32 v91, v91, v11
    v_cvt_pk_bf16_f32 v74, v88, v89
    v_cvt_pk_bf16_f32 v75, v90, v91
    v_mul_f32 v8, v76, v76
    v_mul_f32 v9, v77, v77
    v_mul_f32 v10, v78, v78
    v_mul_f32 v11, v79, v79
    v_fmaak_f32 v8, v8, v12, 0xc0135761
    v_fmaak_f32 v9, v9, v12, 0xc0135761
    v_fmaak_f32 v10, v10, v12, 0xc0135761
    v_fmaak_f32 v11, v11, v12, 0xc0135761
    v_mul_f32 v8, v76, v8
    v_mul_f32 v9, v77, v9
    v_mul_f32 v10, v78, v10
    v_mul_f32 v11, v79, v11
    v_exp_f32 v8, v8
    v_exp_f32 v9, v9
    v_exp_f32 v10, v10
    v_exp_f32 v11, v11
    v_add_f32 v8, 1.0, v8
    v_add_f32 v9, 1.0, v9
    v_add_f32 v10, 1.0, v10
    v_add_f32 v11, 1.0, v11
    v_rcp_f32 v8, v8
    v_rcp_f32 v9, v9
    v_rcp_f32 v10, v10
    v_rcp_f32 v11, v11
    v_mul_f32 v76, v76, v8
    v_mul_f32 v77, v77, v9
    v_mul_f32 v78, v78, v10
    v_mul_f32 v79, v79, v11
    v_cvt_pk_bf16_f32 v76, v76, v77
    v_cvt_pk_bf16_f32 v77, v78, v79
    v_mul_f32 v8, v92, v92
    v_mul_f32 v9, v93, v93
    v_mul_f32 v10, v94, v94
    v_mul_f32 v11, v95, v95
    v_fmaak_f32 v8, v8, v12, 0xc0135761
    v_fmaak_f32 v9, v9, v12, 0xc0135761
    v_fmaak_f32 v10, v10, v12, 0xc0135761
    v_fmaak_f32 v11, v11, v12, 0xc0135761
    v_mul_f32 v8, v92, v8
    v_mul_f32 v9, v93, v9
    v_mul_f32 v10, v94, v10
    v_mul_f32 v11, v95, v11
    v_exp_f32 v8, v8
    v_exp_f32 v9, v9
    v_exp_f32 v10, v10
    v_exp_f32 v11, v11
    v_add_f32 v8, 1.0, v8
    v_add_f32 v9, 1.0, v9
    v_add_f32 v10, 1.0, v10
    v_add_f32 v11, 1.0, v11
    v_rcp_f32 v8, v8
    v_rcp_f32 v9, v9
    v_rcp_f32 v10, v10
    v_rcp_f32 v11, v11
    v_mul_f32 v92, v92, v8
    v_mul_f32 v93, v93, v9
    v_mul_f32 v94, v94, v10
    v_mul_f32 v95, v95, v11
    v_cvt_pk_bf16_f32 v78, v92, v93
    v_cvt_pk_bf16_f32 v79, v94, v95
    v_mul_f32 v8, v96, v96
    v_mul_f32 v9, v97, v97
    v_mul_f32 v10, v98, v98
    v_mul_f32 v11, v99, v99
    v_fmaak_f32 v8, v8, v12, 0xc0135761
    v_fmaak_f32 v9, v9, v12, 0xc0135761
    v_fmaak_f32 v10, v10, v12, 0xc0135761
    v_fmaak_f32 v11, v11, v12, 0xc0135761
    v_mul_f32 v8, v96, v8
    v_mul_f32 v9, v97, v9
    v_mul_f32 v10, v98, v10
    v_mul_f32 v11, v99, v11
    v_exp_f32 v8, v8
    v_exp_f32 v9, v9
    v_exp_f32 v10, v10
    v_exp_f32 v11, v11
    v_add_f32 v8, 1.0, v8
    v_add_f32 v9, 1.0, v9
    v_add_f32 v10, 1.0, v10
    v_add_f32 v11, 1.0, v11
    v_rcp_f32 v8, v8
    v_rcp_f32 v9, v9
    v_rcp_f32 v10, v10
    v_rcp_f32 v11, v11
    v_mul_f32 v96, v96, v8
    v_mul_f32 v97, v97, v9
    v_mul_f32 v98, v98, v10
    v_mul_f32 v99, v99, v11
    v_cvt_pk_bf16_f32 v96, v96, v97
    v_cvt_pk_bf16_f32 v97, v98, v99
    v_mul_f32 v8, v112, v112
    v_mul_f32 v9, v113, v113
    v_mul_f32 v10, v114, v114
    v_mul_f32 v11, v115, v115
    v_fmaak_f32 v8, v8, v12, 0xc0135761
    v_fmaak_f32 v9, v9, v12, 0xc0135761
    v_fmaak_f32 v10, v10, v12, 0xc0135761
    v_fmaak_f32 v11, v11, v12, 0xc0135761
    v_mul_f32 v8, v112, v8
    v_mul_f32 v9, v113, v9
    v_mul_f32 v10, v114, v10
    v_mul_f32 v11, v115, v11
    v_exp_f32 v8, v8
    v_exp_f32 v9, v9
    v_exp_f32 v10, v10
    v_exp_f32 v11, v11
    v_add_f32 v8, 1.0, v8
    v_add_f32 v9, 1.0, v9
    v_add_f32 v10, 1.0, v10
    v_add_f32 v11, 1.0, v11
    v_rcp_f32 v8, v8
    v_rcp_f32 v9, v9
    v_rcp_f32 v10, v10
    v_rcp_f32 v11, v11
    v_mul_f32 v112, v112, v8
    v_mul_f32 v113, v113, v9
    v_mul_f32 v114, v114, v10
    v_mul_f32 v115, v115, v11
    v_cvt_pk_bf16_f32 v98, v112, v113
    v_cvt_pk_bf16_f32 v99, v114, v115
    v_mul_f32 v8, v100, v100
    v_mul_f32 v9, v101, v101
    v_mul_f32 v10, v102, v102
    v_mul_f32 v11, v103, v103
    v_fmaak_f32 v8, v8, v12, 0xc0135761
    v_fmaak_f32 v9, v9, v12, 0xc0135761
    v_fmaak_f32 v10, v10, v12, 0xc0135761
    v_fmaak_f32 v11, v11, v12, 0xc0135761
    v_mul_f32 v8, v100, v8
    v_mul_f32 v9, v101, v9
    v_mul_f32 v10, v102, v10
    v_mul_f32 v11, v103, v11
    v_exp_f32 v8, v8
    v_exp_f32 v9, v9
    v_exp_f32 v10, v10
    v_exp_f32 v11, v11
    v_add_f32 v8, 1.0, v8
    v_add_f32 v9, 1.0, v9
    v_add_f32 v10, 1.0, v10
    v_add_f32 v11, 1.0, v11
    v_rcp_f32 v8, v8
    v_rcp_f32 v9, v9
    v_rcp_f32 v10, v10
    v_rcp_f32 v11, v11
    v_mul_f32 v100, v100, v8
    v_mul_f32 v101, v101, v9
    v_mul_f32 v102, v102, v10
    v_mul_f32 v103, v103, v11
    v_cvt_pk_bf16_f32 v100, v100, v101
    v_cvt_pk_bf16_f32 v101, v102, v103
    v_mul_f32 v8, v116, v116
    v_mul_f32 v9, v117, v117
    v_mul_f32 v10, v118, v118
    v_mul_f32 v11, v119, v119
    v_fmaak_f32 v8, v8, v12, 0xc0135761
    v_fmaak_f32 v9, v9, v12, 0xc0135761
    v_fmaak_f32 v10, v10, v12, 0xc0135761
    v_fmaak_f32 v11, v11, v12, 0xc0135761
    v_mul_f32 v8, v116, v8
    v_mul_f32 v9, v117, v9
    v_mul_f32 v10, v118, v10
    v_mul_f32 v11, v119, v11
    v_exp_f32 v8, v8
    v_exp_f32 v9, v9
    v_exp_f32 v10, v10
    v_exp_f32 v11, v11
    v_add_f32 v8, 1.0, v8
    v_add_f32 v9, 1.0, v9
    v_add_f32 v10, 1.0, v10
    v_add_f32 v11, 1.0, v11
    v_rcp_f32 v8, v8
    v_rcp_f32 v9, v9
    v_rcp_f32 v10, v10
    v_rcp_f32 v11, v11
    v_mul_f32 v116, v116, v8
    v_mul_f32 v117, v117, v9
    v_mul_f32 v118, v118, v10
    v_mul_f32 v119, v119, v11
    v_cvt_pk_bf16_f32 v102, v116, v117
    v_cvt_pk_bf16_f32 v103, v118, v119
    v_mul_f32 v8, v104, v104
    v_mul_f32 v9, v105, v105
    v_mul_f32 v10, v106, v106
    v_mul_f32 v11, v107, v107
    v_fmaak_f32 v8, v8, v12, 0xc0135761
    v_fmaak_f32 v9, v9, v12, 0xc0135761
    v_fmaak_f32 v10, v10, v12, 0xc0135761
    v_fmaak_f32 v11, v11, v12, 0xc0135761
    v_mul_f32 v8, v104, v8
    v_mul_f32 v9, v105, v9
    v_mul_f32 v10, v106, v10
    v_mul_f32 v11, v107, v11
    v_exp_f32 v8, v8
    v_exp_f32 v9, v9
    v_exp_f32 v10, v10
    v_exp_f32 v11, v11
    v_add_f32 v8, 1.0, v8
    v_add_f32 v9, 1.0, v9
    v_add_f32 v10, 1.0, v10
    v_add_f32 v11, 1.0, v11
    v_rcp_f32 v8, v8
    v_rcp_f32 v9, v9
    v_rcp_f32 v10, v10
    v_rcp_f32 v11, v11
    v_mul_f32 v104, v104, v8
    v_mul_f32 v105, v105, v9
    v_mul_f32 v106, v106, v10
    v_mul_f32 v107, v107, v11
    v_cvt_pk_bf16_f32 v104, v104, v105
    v_cvt_pk_bf16_f32 v105, v106, v107
    v_mul_f32 v8, v120, v120
    v_mul_f32 v9, v121, v121
    v_mul_f32 v10, v122, v122
    v_mul_f32 v11, v123, v123
    v_fmaak_f32 v8, v8, v12, 0xc0135761
    v_fmaak_f32 v9, v9, v12, 0xc0135761
    v_fmaak_f32 v10, v10, v12, 0xc0135761
    v_fmaak_f32 v11, v11, v12, 0xc0135761
    v_mul_f32 v8, v120, v8
    v_mul_f32 v9, v121, v9
    v_mul_f32 v10, v122, v10
    v_mul_f32 v11, v123, v11
    v_exp_f32 v8, v8
    v_exp_f32 v9, v9
    v_exp_f32 v10, v10
    v_exp_f32 v11, v11
    v_add_f32 v8, 1.0, v8
    v_add_f32 v9, 1.0, v9
    v_add_f32 v10, 1.0, v10
    v_add_f32 v11, 1.0, v11
    v_rcp_f32 v8, v8
    v_rcp_f32 v9, v9
    v_rcp_f32 v10, v10
    v_rcp_f32 v11, v11
    v_mul_f32 v120, v120, v8
    v_mul_f32 v121, v121, v9
    v_mul_f32 v122, v122, v10
    v_mul_f32 v123, v123, v11
    v_cvt_pk_bf16_f32 v106, v120, v121
    v_cvt_pk_bf16_f32 v107, v122, v123
    v_mul_f32 v8, v108, v108
    v_mul_f32 v9, v109, v109
    v_mul_f32 v10, v110, v110
    v_mul_f32 v11, v111, v111
    v_fmaak_f32 v8, v8, v12, 0xc0135761
    v_fmaak_f32 v9, v9, v12, 0xc0135761
    v_fmaak_f32 v10, v10, v12, 0xc0135761
    v_fmaak_f32 v11, v11, v12, 0xc0135761
    v_mul_f32 v8, v108, v8
    v_mul_f32 v9, v109, v9
    v_mul_f32 v10, v110, v10
    v_mul_f32 v11, v111, v11
    v_exp_f32 v8, v8
    v_exp_f32 v9, v9
    v_exp_f32 v10, v10
    v_exp_f32 v11, v11
    v_add_f32 v8, 1.0, v8
    v_add_f32 v9, 1.0, v9
    v_add_f32 v10, 1.0, v10
    v_add_f32 v11, 1.0, v11
    v_rcp_f32 v8, v8
    v_rcp_f32 v9, v9
    v_rcp_f32 v10, v10
    v_rcp_f32 v11, v11
    v_mul_f32 v108, v108, v8
    v_mul_f32 v109, v109, v9
    v_mul_f32 v110, v110, v10
    v_mul_f32 v111, v111, v11
    v_cvt_pk_bf16_f32 v108, v108, v109
    v_cvt_pk_bf16_f32 v109, v110, v111
    v_mul_f32 v8, v124, v124
    v_mul_f32 v9, v125, v125
    v_mul_f32 v10, v126, v126
    v_mul_f32 v11, v127, v127
    v_fmaak_f32 v8, v8, v12, 0xc0135761
    v_fmaak_f32 v9, v9, v12, 0xc0135761
    v_fmaak_f32 v10, v10, v12, 0xc0135761
    v_fmaak_f32 v11, v11, v12, 0xc0135761
    v_mul_f32 v8, v124, v8
    v_mul_f32 v9, v125, v9
    v_mul_f32 v10, v126, v10
    v_mul_f32 v11, v127, v11
    v_exp_f32 v8, v8
    v_exp_f32 v9, v9
    v_exp_f32 v10, v10
    v_exp_f32 v11, v11
    v_add_f32 v8, 1.0, v8
    v_add_f32 v9, 1.0, v9
    v_add_f32 v10, 1.0, v10
    v_add_f32 v11, 1.0, v11
    v_rcp_f32 v8, v8
    v_rcp_f32 v9, v9
    v_rcp_f32 v10, v10
    v_rcp_f32 v11, v11
    v_mul_f32 v124, v124, v8
    v_mul_f32 v125, v125, v9
    v_mul_f32 v126, v126, v10
    v_mul_f32 v127, v127, v11
    v_cvt_pk_bf16_f32 v110, v124, v125
    v_cvt_pk_bf16_f32 v111, v126, v127
    s_lshl_b32 s6, s5, 13
    v_add_u32 v2, s6, v58
    ds_write_b128 v2, v[64:67] offset:0
    ds_write_b128 v2, v[68:71] offset:1024
    ds_write_b128 v2, v[72:75] offset:2048
    ds_write_b128 v2, v[76:79] offset:3072
    ds_write_b128 v2, v[96:99] offset:4096
    ds_write_b128 v2, v[100:103] offset:5120
    ds_write_b128 v2, v[104:107] offset:6144
    ds_write_b128 v2, v[108:111] offset:7168
    s_waitcnt lgkmcnt(0)
    s_barrier
    v_add_u32 v56, 0, v58
    v_add_u32 v57, 0, v58
    ds_read_b128 v[144:147], v56 offset:0
    ds_read_b128 v[148:151], v56 offset:1024
    ds_read_b128 v[152:155], v56 offset:2048
    ds_read_b128 v[156:159], v56 offset:3072
    ds_read_b128 v[160:163], v57 offset:4096
    ds_read_b128 v[164:167], v57 offset:5120
    ds_read_b128 v[168:171], v57 offset:6144
    ds_read_b128 v[172:175], v57 offset:7168
    s_waitcnt lgkmcnt(4)
    s_waitcnt vmcnt(8)
    v_mfma_f32_16x16x32_bf16 v[80:83], v[176:179], v[144:147], 0
    v_mfma_f32_16x16x32_bf16 v[84:87], v[176:179], v[148:151], 0
    v_mfma_f32_16x16x32_bf16 v[88:91], v[176:179], v[152:155], 0
    v_mfma_f32_16x16x32_bf16 v[92:95], v[176:179], v[156:159], 0
    buffer_load_dwordx4 v[176:179], v58, s[60:63], s77 offen offset:0 sc1
    s_waitcnt vmcnt(8)
    v_mfma_f32_16x16x32_bf16 v[96:99], v[180:183], v[144:147], 0
    v_mfma_f32_16x16x32_bf16 v[100:103], v[180:183], v[148:151], 0
    v_mfma_f32_16x16x32_bf16 v[104:107], v[180:183], v[152:155], 0
    v_mfma_f32_16x16x32_bf16 v[108:111], v[180:183], v[156:159], 0
    buffer_load_dwordx4 v[180:183], v58, s[60:63], s77 offen offset:1024 sc1
    s_waitcnt vmcnt(8)
    v_mfma_f32_16x16x32_bf16 v[112:115], v[184:187], v[144:147], 0
    v_mfma_f32_16x16x32_bf16 v[116:119], v[184:187], v[148:151], 0
    v_mfma_f32_16x16x32_bf16 v[120:123], v[184:187], v[152:155], 0
    v_mfma_f32_16x16x32_bf16 v[124:127], v[184:187], v[156:159], 0
    buffer_load_dwordx4 v[184:187], v58, s[60:63], s77 offen offset:2048 sc1
    ds_read_b128 v[144:147], v56 offset:8192
    ds_read_b128 v[148:151], v56 offset:9216
    ds_read_b128 v[152:155], v56 offset:10240
    ds_read_b128 v[156:159], v56 offset:11264
    s_waitcnt lgkmcnt(4)
    s_waitcnt vmcnt(8)
    v_mfma_f32_16x16x32_bf16 v[80:83], v[188:191], v[160:163], v[80:83]
    v_mfma_f32_16x16x32_bf16 v[84:87], v[188:191], v[164:167], v[84:87]
    v_mfma_f32_16x16x32_bf16 v[88:91], v[188:191], v[168:171], v[88:91]
    v_mfma_f32_16x16x32_bf16 v[92:95], v[188:191], v[172:175], v[92:95]
    buffer_load_dwordx4 v[188:191], v58, s[60:63], s77 offen offset:3072 sc1
    s_add_u32 s77, s77, 4096
    s_waitcnt vmcnt(8)
    v_mfma_f32_16x16x32_bf16 v[96:99], v[192:195], v[160:163], v[96:99]
    v_mfma_f32_16x16x32_bf16 v[100:103], v[192:195], v[164:167], v[100:103]
    v_mfma_f32_16x16x32_bf16 v[104:107], v[192:195], v[168:171], v[104:107]
    v_mfma_f32_16x16x32_bf16 v[108:111], v[192:195], v[172:175], v[108:111]
    buffer_load_dwordx4 v[192:195], v58, s[60:63], s77 offen offset:0 sc1
    s_waitcnt vmcnt(8)
    v_mfma_f32_16x16x32_bf16 v[112:115], v[196:199], v[160:163], v[112:115]
    v_mfma_f32_16x16x32_bf16 v[116:119], v[196:199], v[164:167], v[116:119]
    v_mfma_f32_16x16x32_bf16 v[120:123], v[196:199], v[168:171], v[120:123]
    v_mfma_f32_16x16x32_bf16 v[124:127], v[196:199], v[172:175], v[124:127]
    buffer_load_dwordx4 v[196:199], v58, s[60:63], s77 offen offset:1024 sc1
    ds_read_b128 v[160:163], v57 offset:12288
    ds_read_b128 v[164:167], v57 offset:13312
    ds_read_b128 v[168:171], v57 offset:14336
    ds_read_b128 v[172:175], v57 offset:15360
    s_waitcnt lgkmcnt(4)
    s_waitcnt vmcnt(8)
    v_mfma_f32_16x16x32_bf16 v[80:83], v[200:203], v[144:147], v[80:83]
    v_mfma_f32_16x16x32_bf16 v[84:87], v[200:203], v[148:151], v[84:87]
    v_mfma_f32_16x16x32_bf16 v[88:91], v[200:203], v[152:155], v[88:91]
    v_mfma_f32_16x16x32_bf16 v[92:95], v[200:203], v[156:159], v[92:95]
    buffer_load_dwordx4 v[200:203], v58, s[60:63], s77 offen offset:2048 sc1
    s_waitcnt vmcnt(8)
    v_mfma_f32_16x16x32_bf16 v[96:99], v[204:207], v[144:147], v[96:99]
    v_mfma_f32_16x16x32_bf16 v[100:103], v[204:207], v[148:151], v[100:103]
    v_mfma_f32_16x16x32_bf16 v[104:107], v[204:207], v[152:155], v[104:107]
    v_mfma_f32_16x16x32_bf16 v[108:111], v[204:207], v[156:159], v[108:111]
    buffer_load_dwordx4 v[204:207], v58, s[60:63], s77 offen offset:3072 sc1
    s_add_u32 s77, s77, 4096
    s_waitcnt vmcnt(8)
    v_mfma_f32_16x16x32_bf16 v[112:115], v[208:211], v[144:147], v[112:115]
    v_mfma_f32_16x16x32_bf16 v[116:119], v[208:211], v[148:151], v[116:119]
    v_mfma_f32_16x16x32_bf16 v[120:123], v[208:211], v[152:155], v[120:123]
    v_mfma_f32_16x16x32_bf16 v[124:127], v[208:211], v[156:159], v[124:127]
    buffer_load_dwordx4 v[208:211], v58, s[60:63], s77 offen offset:0 sc1
    ds_read_b128 v[144:147], v56 offset:16384
    ds_read_b128 v[148:151], v56 offset:17408
    ds_read_b128 v[152:155], v56 offset:18432
    ds_read_b128 v[156:159], v56 offset:19456
    s_waitcnt lgkmcnt(4)
    s_waitcnt vmcnt(8)
    v_mfma_f32_16x16x32_bf16 v[80:83], v[176:179], v[160:163], v[80:83]
    v_mfma_f32_16x16x32_bf16 v[84:87], v[176:179], v[164:167], v[84:87]
    v_mfma_f32_16x16x32_bf16 v[88:91], v[176:179], v[168:171], v[88:91]
    v_mfma_f32_16x16x32_bf16 v[92:95], v[176:179], v[172:175], v[92:95]
    buffer_load_dwordx4 v[176:179], v58, s[60:63], s77 offen offset:1024 sc1
    s_waitcnt vmcnt(8)
    v_mfma_f32_16x16x32_bf16 v[96:99], v[180:183], v[160:163], v[96:99]
    v_mfma_f32_16x16x32_bf16 v[100:103], v[180:183], v[164:167], v[100:103]
    v_mfma_f32_16x16x32_bf16 v[104:107], v[180:183], v[168:171], v[104:107]
    v_mfma_f32_16x16x32_bf16 v[108:111], v[180:183], v[172:175], v[108:111]
    buffer_load_dwordx4 v[180:183], v58, s[60:63], s77 offen offset:2048 sc1
    s_waitcnt vmcnt(8)
    v_mfma_f32_16x16x32_bf16 v[112:115], v[184:187], v[160:163], v[112:115]
    v_mfma_f32_16x16x32_bf16 v[116:119], v[184:187], v[164:167], v[116:119]
    v_mfma_f32_16x16x32_bf16 v[120:123], v[184:187], v[168:171], v[120:123]
    v_mfma_f32_16x16x32_bf16 v[124:127], v[184:187], v[172:175], v[124:127]
    buffer_load_dwordx4 v[184:187], v58, s[60:63], s77 offen offset:3072 sc1
    s_add_u32 s77, s77, 4096
    ds_read_b128 v[160:163], v57 offset:20480
    ds_read_b128 v[164:167], v57 offset:21504
    ds_read_b128 v[168:171], v57 offset:22528
    ds_read_b128 v[172:175], v57 offset:23552
    s_waitcnt lgkmcnt(4)
    s_waitcnt vmcnt(8)
    v_mfma_f32_16x16x32_bf16 v[80:83], v[188:191], v[144:147], v[80:83]
    v_mfma_f32_16x16x32_bf16 v[84:87], v[188:191], v[148:151], v[84:87]
    v_mfma_f32_16x16x32_bf16 v[88:91], v[188:191], v[152:155], v[88:91]
    v_mfma_f32_16x16x32_bf16 v[92:95], v[188:191], v[156:159], v[92:95]
    buffer_load_dwordx4 v[188:191], v58, s[60:63], s77 offen offset:0 sc1
    s_waitcnt vmcnt(8)
    v_mfma_f32_16x16x32_bf16 v[96:99], v[192:195], v[144:147], v[96:99]
    v_mfma_f32_16x16x32_bf16 v[100:103], v[192:195], v[148:151], v[100:103]
    v_mfma_f32_16x16x32_bf16 v[104:107], v[192:195], v[152:155], v[104:107]
    v_mfma_f32_16x16x32_bf16 v[108:111], v[192:195], v[156:159], v[108:111]
    buffer_load_dwordx4 v[192:195], v58, s[60:63], s77 offen offset:1024 sc1
    s_waitcnt vmcnt(8)
    v_mfma_f32_16x16x32_bf16 v[112:115], v[196:199], v[144:147], v[112:115]
    v_mfma_f32_16x16x32_bf16 v[116:119], v[196:199], v[148:151], v[116:119]
    v_mfma_f32_16x16x32_bf16 v[120:123], v[196:199], v[152:155], v[120:123]
    v_mfma_f32_16x16x32_bf16 v[124:127], v[196:199], v[156:159], v[124:127]
    buffer_load_dwordx4 v[196:199], v58, s[60:63], s77 offen offset:2048 sc1
    ds_read_b128 v[144:147], v56 offset:24576
    ds_read_b128 v[148:151], v56 offset:25600
    ds_read_b128 v[152:155], v56 offset:26624
    ds_read_b128 v[156:159], v56 offset:27648
    s_waitcnt lgkmcnt(4)
    s_waitcnt vmcnt(8)
    v_mfma_f32_16x16x32_bf16 v[80:83], v[200:203], v[160:163], v[80:83]
    v_mfma_f32_16x16x32_bf16 v[84:87], v[200:203], v[164:167], v[84:87]
    v_mfma_f32_16x16x32_bf16 v[88:91], v[200:203], v[168:171], v[88:91]
    v_mfma_f32_16x16x32_bf16 v[92:95], v[200:203], v[172:175], v[92:95]
    buffer_load_dwordx4 v[200:203], v58, s[60:63], s77 offen offset:3072 sc1
    s_add_u32 s77, s77, 4096
    s_waitcnt vmcnt(8)
    v_mfma_f32_16x16x32_bf16 v[96:99], v[204:207], v[160:163], v[96:99]
    v_mfma_f32_16x16x32_bf16 v[100:103], v[204:207], v[164:167], v[100:103]
    v_mfma_f32_16x16x32_bf16 v[104:107], v[204:207], v[168:171], v[104:107]
    v_mfma_f32_16x16x32_bf16 v[108:111], v[204:207], v[172:175], v[108:111]
    buffer_load_dwordx4 v[204:207], v58, s[60:63], s77 offen offset:0 sc1
    s_waitcnt vmcnt(8)
    v_mfma_f32_16x16x32_bf16 v[112:115], v[208:211], v[160:163], v[112:115]
    v_mfma_f32_16x16x32_bf16 v[116:119], v[208:211], v[164:167], v[116:119]
    v_mfma_f32_16x16x32_bf16 v[120:123], v[208:211], v[168:171], v[120:123]
    v_mfma_f32_16x16x32_bf16 v[124:127], v[208:211], v[172:175], v[124:127]
    buffer_load_dwordx4 v[208:211], v58, s[60:63], s77 offen offset:1024 sc1
    s_add_u32 s77, s77, 2048
    v_add_u32 v56, 24576, v56
    v_add_u32 v57, 24576, v57
    ds_read_b128 v[160:163], v57 offset:4096
    ds_read_b128 v[164:167], v57 offset:5120
    ds_read_b128 v[168:171], v57 offset:6144
    ds_read_b128 v[172:175], v57 offset:7168
    s_waitcnt lgkmcnt(4)
    s_waitcnt vmcnt(8)
    v_mfma_f32_16x16x32_bf16 v[80:83], v[176:179], v[144:147], v[80:83]
    v_mfma_f32_16x16x32_bf16 v[84:87], v[176:179], v[148:151], v[84:87]
    v_mfma_f32_16x16x32_bf16 v[88:91], v[176:179], v[152:155], v[88:91]
    v_mfma_f32_16x16x32_bf16 v[92:95], v[176:179], v[156:159], v[92:95]
    buffer_load_dwordx4 v[176:179], v58, s[60:63], s77 offen offset:0 sc1
    s_waitcnt vmcnt(8)
    v_mfma_f32_16x16x32_bf16 v[96:99], v[180:183], v[144:147], v[96:99]
    v_mfma_f32_16x16x32_bf16 v[100:103], v[180:183], v[148:151], v[100:103]
    v_mfma_f32_16x16x32_bf16 v[104:107], v[180:183], v[152:155], v[104:107]
    v_mfma_f32_16x16x32_bf16 v[108:111], v[180:183], v[156:159], v[108:111]
    buffer_load_dwordx4 v[180:183], v58, s[60:63], s77 offen offset:1024 sc1
    s_waitcnt vmcnt(8)
    v_mfma_f32_16x16x32_bf16 v[112:115], v[184:187], v[144:147], v[112:115]
    v_mfma_f32_16x16x32_bf16 v[116:119], v[184:187], v[148:151], v[116:119]
    v_mfma_f32_16x16x32_bf16 v[120:123], v[184:187], v[152:155], v[120:123]
    v_mfma_f32_16x16x32_bf16 v[124:127], v[184:187], v[156:159], v[124:127]
    buffer_load_dwordx4 v[184:187], v58, s[60:63], s77 offen offset:2048 sc1
    ds_read_b128 v[144:147], v56 offset:8192
    ds_read_b128 v[148:151], v56 offset:9216
    ds_read_b128 v[152:155], v56 offset:10240
    ds_read_b128 v[156:159], v56 offset:11264
    s_waitcnt lgkmcnt(4)
    s_waitcnt vmcnt(8)
    v_mfma_f32_16x16x32_bf16 v[80:83], v[188:191], v[160:163], v[80:83]
    v_mfma_f32_16x16x32_bf16 v[84:87], v[188:191], v[164:167], v[84:87]
    v_mfma_f32_16x16x32_bf16 v[88:91], v[188:191], v[168:171], v[88:91]
    v_mfma_f32_16x16x32_bf16 v[92:95], v[188:191], v[172:175], v[92:95]
    buffer_load_dwordx4 v[188:191], v58, s[60:63], s77 offen offset:3072 sc1
    s_add_u32 s77, s77, 4096
    s_waitcnt vmcnt(8)
    v_mfma_f32_16x16x32_bf16 v[96:99], v[192:195], v[160:163], v[96:99]
    v_mfma_f32_16x16x32_bf16 v[100:103], v[192:195], v[164:167], v[100:103]
    v_mfma_f32_16x16x32_bf16 v[104:107], v[192:195], v[168:171], v[104:107]
    v_mfma_f32_16x16x32_bf16 v[108:111], v[192:195], v[172:175], v[108:111]
    buffer_load_dwordx4 v[192:195], v58, s[60:63], s77 offen offset:0 sc1
    s_waitcnt vmcnt(8)
    v_mfma_f32_16x16x32_bf16 v[112:115], v[196:199], v[160:163], v[112:115]
    v_mfma_f32_16x16x32_bf16 v[116:119], v[196:199], v[164:167], v[116:119]
    v_mfma_f32_16x16x32_bf16 v[120:123], v[196:199], v[168:171], v[120:123]
    v_mfma_f32_16x16x32_bf16 v[124:127], v[196:199], v[172:175], v[124:127]
    buffer_load_dwordx4 v[196:199], v58, s[60:63], s77 offen offset:1024 sc1
    ds_read_b128 v[160:163], v57 offset:12288
    ds_read_b128 v[164:167], v57 offset:13312
    ds_read_b128 v[168:171], v57 offset:14336
    ds_read_b128 v[172:175], v57 offset:15360
    s_waitcnt lgkmcnt(4)
    s_waitcnt vmcnt(8)
    v_mfma_f32_16x16x32_bf16 v[80:83], v[200:203], v[144:147], v[80:83]
    v_mfma_f32_16x16x32_bf16 v[84:87], v[200:203], v[148:151], v[84:87]
    v_mfma_f32_16x16x32_bf16 v[88:91], v[200:203], v[152:155], v[88:91]
    v_mfma_f32_16x16x32_bf16 v[92:95], v[200:203], v[156:159], v[92:95]
    buffer_load_dwordx4 v[200:203], v58, s[60:63], s77 offen offset:2048 sc1
    s_waitcnt vmcnt(8)
    v_mfma_f32_16x16x32_bf16 v[96:99], v[204:207], v[144:147], v[96:99]
    v_mfma_f32_16x16x32_bf16 v[100:103], v[204:207], v[148:151], v[100:103]
    v_mfma_f32_16x16x32_bf16 v[104:107], v[204:207], v[152:155], v[104:107]
    v_mfma_f32_16x16x32_bf16 v[108:111], v[204:207], v[156:159], v[108:111]
    buffer_load_dwordx4 v[204:207], v58, s[60:63], s77 offen offset:3072 sc1
    s_add_u32 s77, s77, 4096
    s_waitcnt vmcnt(8)
    v_mfma_f32_16x16x32_bf16 v[112:115], v[208:211], v[144:147], v[112:115]
    v_mfma_f32_16x16x32_bf16 v[116:119], v[208:211], v[148:151], v[116:119]
    v_mfma_f32_16x16x32_bf16 v[120:123], v[208:211], v[152:155], v[120:123]
    v_mfma_f32_16x16x32_bf16 v[124:127], v[208:211], v[156:159], v[124:127]
    buffer_load_dwordx4 v[208:211], v58, s[60:63], s77 offen offset:0 sc1
    ds_read_b128 v[144:147], v56 offset:16384
    ds_read_b128 v[148:151], v56 offset:17408
    ds_read_b128 v[152:155], v56 offset:18432
    ds_read_b128 v[156:159], v56 offset:19456
    s_waitcnt lgkmcnt(4)
    s_waitcnt vmcnt(8)
    v_mfma_f32_16x16x32_bf16 v[80:83], v[176:179], v[160:163], v[80:83]
    v_mfma_f32_16x16x32_bf16 v[84:87], v[176:179], v[164:167], v[84:87]
    v_mfma_f32_16x16x32_bf16 v[88:91], v[176:179], v[168:171], v[88:91]
    v_mfma_f32_16x16x32_bf16 v[92:95], v[176:179], v[172:175], v[92:95]
    buffer_load_dwordx4 v[176:179], v58, s[60:63], s77 offen offset:1024 sc1
    s_waitcnt vmcnt(8)
    v_mfma_f32_16x16x32_bf16 v[96:99], v[180:183], v[160:163], v[96:99]
    v_mfma_f32_16x16x32_bf16 v[100:103], v[180:183], v[164:167], v[100:103]
    v_mfma_f32_16x16x32_bf16 v[104:107], v[180:183], v[168:171], v[104:107]
    v_mfma_f32_16x16x32_bf16 v[108:111], v[180:183], v[172:175], v[108:111]
    buffer_load_dwordx4 v[180:183], v58, s[60:63], s77 offen offset:2048 sc1
    s_waitcnt vmcnt(8)
    v_mfma_f32_16x16x32_bf16 v[112:115], v[184:187], v[160:163], v[112:115]
    v_mfma_f32_16x16x32_bf16 v[116:119], v[184:187], v[164:167], v[116:119]
    v_mfma_f32_16x16x32_bf16 v[120:123], v[184:187], v[168:171], v[120:123]
    v_mfma_f32_16x16x32_bf16 v[124:127], v[184:187], v[172:175], v[124:127]
    buffer_load_dwordx4 v[184:187], v58, s[60:63], s77 offen offset:3072 sc1
    s_add_u32 s77, s77, 4096
    ds_read_b128 v[160:163], v57 offset:20480
    ds_read_b128 v[164:167], v57 offset:21504
    ds_read_b128 v[168:171], v57 offset:22528
    ds_read_b128 v[172:175], v57 offset:23552
    s_waitcnt lgkmcnt(4)
    s_waitcnt vmcnt(8)
    v_mfma_f32_16x16x32_bf16 v[80:83], v[188:191], v[144:147], v[80:83]
    v_mfma_f32_16x16x32_bf16 v[84:87], v[188:191], v[148:151], v[84:87]
    v_mfma_f32_16x16x32_bf16 v[88:91], v[188:191], v[152:155], v[88:91]
    v_mfma_f32_16x16x32_bf16 v[92:95], v[188:191], v[156:159], v[92:95]
    buffer_load_dwordx4 v[188:191], v58, s[60:63], s77 offen offset:0 sc1
    s_waitcnt vmcnt(8)
    v_mfma_f32_16x16x32_bf16 v[96:99], v[192:195], v[144:147], v[96:99]
    v_mfma_f32_16x16x32_bf16 v[100:103], v[192:195], v[148:151], v[100:103]
    v_mfma_f32_16x16x32_bf16 v[104:107], v[192:195], v[152:155], v[104:107]
    v_mfma_f32_16x16x32_bf16 v[108:111], v[192:195], v[156:159], v[108:111]
    buffer_load_dwordx4 v[192:195], v58, s[60:63], s77 offen offset:1024 sc1
    s_waitcnt vmcnt(8)
    v_mfma_f32_16x16x32_bf16 v[112:115], v[196:199], v[144:147], v[112:115]
    v_mfma_f32_16x16x32_bf16 v[116:119], v[196:199], v[148:151], v[116:119]
    v_mfma_f32_16x16x32_bf16 v[120:123], v[196:199], v[152:155], v[120:123]
    v_mfma_f32_16x16x32_bf16 v[124:127], v[196:199], v[156:159], v[124:127]
    buffer_load_dwordx4 v[196:199], v58, s[60:63], s77 offen offset:2048 sc1
    ds_read_b128 v[144:147], v56 offset:24576
    ds_read_b128 v[148:151], v56 offset:25600
    ds_read_b128 v[152:155], v56 offset:26624
    ds_read_b128 v[156:159], v56 offset:27648
    s_waitcnt lgkmcnt(4)
    s_waitcnt vmcnt(8)
    v_mfma_f32_16x16x32_bf16 v[80:83], v[200:203], v[160:163], v[80:83]
    v_mfma_f32_16x16x32_bf16 v[84:87], v[200:203], v[164:167], v[84:87]
    v_mfma_f32_16x16x32_bf16 v[88:91], v[200:203], v[168:171], v[88:91]
    v_mfma_f32_16x16x32_bf16 v[92:95], v[200:203], v[172:175], v[92:95]
    buffer_load_dwordx4 v[200:203], v58, s[60:63], s77 offen offset:3072 sc1
    s_add_u32 s77, s77, 4096
    s_waitcnt vmcnt(8)
    v_mfma_f32_16x16x32_bf16 v[96:99], v[204:207], v[160:163], v[96:99]
    v_mfma_f32_16x16x32_bf16 v[100:103], v[204:207], v[164:167], v[100:103]
    v_mfma_f32_16x16x32_bf16 v[104:107], v[204:207], v[168:171], v[104:107]
    v_mfma_f32_16x16x32_bf16 v[108:111], v[204:207], v[172:175], v[108:111]
    buffer_load_dwordx4 v[204:207], v58, s[60:63], s77 offen offset:0 sc1
    s_waitcnt vmcnt(8)
    v_mfma_f32_16x16x32_bf16 v[112:115], v[208:211], v[160:163], v[112:115]
    v_mfma_f32_16x16x32_bf16 v[116:119], v[208:211], v[164:167], v[116:119]
    v_mfma_f32_16x16x32_bf16 v[120:123], v[208:211], v[168:171], v[120:123]
    v_mfma_f32_16x16x32_bf16 v[124:127], v[208:211], v[172:175], v[124:127]
    buffer_load_dwordx4 v[208:211], v58, s[60:63], s77 offen offset:1024 sc1
    s_add_u32 s77, s77, 2048
    v_add_u32 v56, 24576, v56
    v_add_u32 v57, 24576, v57
    ds_read_b128 v[160:163], v57 offset:4096
    ds_read_b128 v[164:167], v57 offset:5120
    ds_read_b128 v[168:171], v57 offset:6144
    ds_read_b128 v[172:175], v57 offset:7168
    s_waitcnt lgkmcnt(4)
    s_waitcnt vmcnt(8)
    v_mfma_f32_16x16x32_bf16 v[80:83], v[176:179], v[144:147], v[80:83]
    v_mfma_f32_16x16x32_bf16 v[84:87], v[176:179], v[148:151], v[84:87]
    v_mfma_f32_16x16x32_bf16 v[88:91], v[176:179], v[152:155], v[88:91]
    v_mfma_f32_16x16x32_bf16 v[92:95], v[176:179], v[156:159], v[92:95]
    buffer_load_dwordx4 v[176:179], v58, s[60:63], s77 offen offset:0 sc1
    s_waitcnt vmcnt(8)
    v_mfma_f32_16x16x32_bf16 v[96:99], v[180:183], v[144:147], v[96:99]
    v_mfma_f32_16x16x32_bf16 v[100:103], v[180:183], v[148:151], v[100:103]
    v_mfma_f32_16x16x32_bf16 v[104:107], v[180:183], v[152:155], v[104:107]
    v_mfma_f32_16x16x32_bf16 v[108:111], v[180:183], v[156:159], v[108:111]
    buffer_load_dwordx4 v[180:183], v58, s[60:63], s77 offen offset:1024 sc1
    s_waitcnt vmcnt(8)
    v_mfma_f32_16x16x32_bf16 v[112:115], v[184:187], v[144:147], v[112:115]
    v_mfma_f32_16x16x32_bf16 v[116:119], v[184:187], v[148:151], v[116:119]
    v_mfma_f32_16x16x32_bf16 v[120:123], v[184:187], v[152:155], v[120:123]
    v_mfma_f32_16x16x32_bf16 v[124:127], v[184:187], v[156:159], v[124:127]
    buffer_load_dwordx4 v[184:187], v58, s[60:63], s77 offen offset:2048 sc1
    ds_read_b128 v[144:147], v56 offset:8192
    ds_read_b128 v[148:151], v56 offset:9216
    ds_read_b128 v[152:155], v56 offset:10240
    ds_read_b128 v[156:159], v56 offset:11264
    s_waitcnt lgkmcnt(4)
    s_waitcnt vmcnt(8)
    v_mfma_f32_16x16x32_bf16 v[80:83], v[188:191], v[160:163], v[80:83]
    v_mfma_f32_16x16x32_bf16 v[84:87], v[188:191], v[164:167], v[84:87]
    v_mfma_f32_16x16x32_bf16 v[88:91], v[188:191], v[168:171], v[88:91]
    v_mfma_f32_16x16x32_bf16 v[92:95], v[188:191], v[172:175], v[92:95]
    buffer_load_dwordx4 v[188:191], v58, s[60:63], s77 offen offset:3072 sc1
    s_add_u32 s77, s77, 4096
    s_waitcnt vmcnt(8)
    v_mfma_f32_16x16x32_bf16 v[96:99], v[192:195], v[160:163], v[96:99]
    v_mfma_f32_16x16x32_bf16 v[100:103], v[192:195], v[164:167], v[100:103]
    v_mfma_f32_16x16x32_bf16 v[104:107], v[192:195], v[168:171], v[104:107]
    v_mfma_f32_16x16x32_bf16 v[108:111], v[192:195], v[172:175], v[108:111]
    buffer_load_dwordx4 v[192:195], v58, s[60:63], s77 offen offset:0 sc1
    s_waitcnt vmcnt(8)
    v_mfma_f32_16x16x32_bf16 v[112:115], v[196:199], v[160:163], v[112:115]
    v_mfma_f32_16x16x32_bf16 v[116:119], v[196:199], v[164:167], v[116:119]
    v_mfma_f32_16x16x32_bf16 v[120:123], v[196:199], v[168:171], v[120:123]
    v_mfma_f32_16x16x32_bf16 v[124:127], v[196:199], v[172:175], v[124:127]
    buffer_load_dwordx4 v[196:199], v58, s[60:63], s77 offen offset:1024 sc1
    ds_read_b128 v[160:163], v57 offset:12288
    ds_read_b128 v[164:167], v57 offset:13312
    ds_read_b128 v[168:171], v57 offset:14336
    ds_read_b128 v[172:175], v57 offset:15360
    s_waitcnt lgkmcnt(4)
    s_waitcnt vmcnt(8)
    v_mfma_f32_16x16x32_bf16 v[80:83], v[200:203], v[144:147], v[80:83]
    v_mfma_f32_16x16x32_bf16 v[84:87], v[200:203], v[148:151], v[84:87]
    v_mfma_f32_16x16x32_bf16 v[88:91], v[200:203], v[152:155], v[88:91]
    v_mfma_f32_16x16x32_bf16 v[92:95], v[200:203], v[156:159], v[92:95]
    buffer_load_dwordx4 v[200:203], v58, s[60:63], s77 offen offset:2048 sc1
    s_waitcnt vmcnt(8)
    v_mfma_f32_16x16x32_bf16 v[96:99], v[204:207], v[144:147], v[96:99]
    v_mfma_f32_16x16x32_bf16 v[100:103], v[204:207], v[148:151], v[100:103]
    v_mfma_f32_16x16x32_bf16 v[104:107], v[204:207], v[152:155], v[104:107]
    v_mfma_f32_16x16x32_bf16 v[108:111], v[204:207], v[156:159], v[108:111]
    buffer_load_dwordx4 v[204:207], v58, s[60:63], s77 offen offset:3072 sc1
    s_add_u32 s77, s77, 4096
    s_waitcnt vmcnt(8)
    v_mfma_f32_16x16x32_bf16 v[112:115], v[208:211], v[144:147], v[112:115]
    v_mfma_f32_16x16x32_bf16 v[116:119], v[208:211], v[148:151], v[116:119]
    v_mfma_f32_16x16x32_bf16 v[120:123], v[208:211], v[152:155], v[120:123]
    v_mfma_f32_16x16x32_bf16 v[124:127], v[208:211], v[156:159], v[124:127]
    buffer_load_dwordx4 v[208:211], v58, s[60:63], s77 offen offset:0 sc1
    ds_read_b128 v[144:147], v56 offset:16384
    ds_read_b128 v[148:151], v56 offset:17408
    ds_read_b128 v[152:155], v56 offset:18432
    ds_read_b128 v[156:159], v56 offset:19456
    s_waitcnt lgkmcnt(4)
    s_add_u32 s77, s77, 1024
    buffer_load_dwordx4 v[8:11], v58, s[60:63], s77 offen offset:0 sc1
    buffer_load_dwordx4 v[12:15], v58, s[60:63], s77 offen offset:1024 sc1
    buffer_load_dwordx4 v[16:19], v58, s[60:63], s77 offen offset:2048 sc1
    buffer_load_dwordx4 v[20:23], v58, s[60:63], s77 offen offset:3072 sc1
    s_add_u32 s77, s77, 4096
    buffer_load_dwordx4 v[24:27], v58, s[60:63], s77 offen offset:0 sc1
    buffer_load_dwordx4 v[28:31], v58, s[60:63], s77 offen offset:1024 sc1
    buffer_load_dwordx4 v[32:35], v58, s[60:63], s77 offen offset:2048 sc1
    buffer_load_dwordx4 v[36:39], v58, s[60:63], s77 offen offset:3072 sc1
    s_add_u32 s77, s77, 4096
    buffer_load_dwordx4 v[40:43], v58, s[60:63], s77 offen offset:0 sc1
    buffer_load_dwordx4 v[44:47], v58, s[60:63], s77 offen offset:1024 sc1
    buffer_load_dwordx4 v[48:51], v58, s[60:63], s77 offen offset:2048 sc1
    buffer_load_dwordx4 v[52:55], v58, s[60:63], s77 offen offset:3072 sc1
    s_add_u32 s77, s77, 4096
    buffer_load_dwordx4 v[212:215], v58, s[60:63], s77 offen offset:0 sc1
    buffer_load_dwordx4 v[216:219], v58, s[60:63], s77 offen offset:1024 sc1
    buffer_load_dwordx4 v[220:223], v58, s[60:63], s77 offen offset:2048 sc1
    buffer_load_dwordx4 v[224:227], v58, s[60:63], s77 offen offset:3072 sc1
    s_add_u32 s77, s77, 4096
    buffer_load_dwordx4 v[228:231], v58, s[60:63], s77 offen offset:0 sc1
    buffer_load_dwordx4 v[232:235], v58, s[60:63], s77 offen offset:1024 sc1
    s_waitcnt vmcnt(26)
    v_mfma_f32_16x16x32_bf16 v[80:83], v[176:179], v[160:163], v[80:83]
    v_mfma_f32_16x16x32_bf16 v[84:87], v[176:179], v[164:167], v[84:87]
    v_mfma_f32_16x16x32_bf16 v[88:91], v[176:179], v[168:171], v[88:91]
    v_mfma_f32_16x16x32_bf16 v[92:95], v[176:179], v[172:175], v[92:95]
    s_waitcnt vmcnt(25)
    v_mfma_f32_16x16x32_bf16 v[96:99], v[180:183], v[160:163], v[96:99]
    v_mfma_f32_16x16x32_bf16 v[100:103], v[180:183], v[164:167], v[100:103]
    v_mfma_f32_16x16x32_bf16 v[104:107], v[180:183], v[168:171], v[104:107]
    v_mfma_f32_16x16x32_bf16 v[108:111], v[180:183], v[172:175], v[108:111]
    s_waitcnt vmcnt(24)
    v_mfma_f32_16x16x32_bf16 v[112:115], v[184:187], v[160:163], v[112:115]
    v_mfma_f32_16x16x32_bf16 v[116:119], v[184:187], v[164:167], v[116:119]
    v_mfma_f32_16x16x32_bf16 v[120:123], v[184:187], v[168:171], v[120:123]
    v_mfma_f32_16x16x32_bf16 v[124:127], v[184:187], v[172:175], v[124:127]
    ds_read_b128 v[160:163], v57 offset:20480
    ds_read_b128 v[164:167], v57 offset:21504
    ds_read_b128 v[168:171], v57 offset:22528
    ds_read_b128 v[172:175], v57 offset:23552
    s_waitcnt lgkmcnt(4)
    s_waitcnt vmcnt(23)
    v_mfma_f32_16x16x32_bf16 v[80:83], v[188:191], v[144:147], v[80:83]
    v_mfma_f32_16x16x32_bf16 v[84:87], v[188:191], v[148:151], v[84:87]
    v_mfma_f32_16x16x32_bf16 v[88:91], v[188:191], v[152:155], v[88:91]
    v_mfma_f32_16x16x32_bf16 v[92:95], v[188:191], v[156:159], v[92:95]
    s_waitcnt vmcnt(22)
    v_mfma_f32_16x16x32_bf16 v[96:99], v[192:195], v[144:147], v[96:99]
    v_mfma_f32_16x16x32_bf16 v[100:103], v[192:195], v[148:151], v[100:103]
    v_mfma_f32_16x16x32_bf16 v[104:107], v[192:195], v[152:155], v[104:107]
    v_mfma_f32_16x16x32_bf16 v[108:111], v[192:195], v[156:159], v[108:111]
    s_waitcnt vmcnt(21)
    v_mfma_f32_16x16x32_bf16 v[112:115], v[196:199], v[144:147], v[112:115]
    v_mfma_f32_16x16x32_bf16 v[116:119], v[196:199], v[148:151], v[116:119]
    v_mfma_f32_16x16x32_bf16 v[120:123], v[196:199], v[152:155], v[120:123]
    v_mfma_f32_16x16x32_bf16 v[124:127], v[196:199], v[156:159], v[124:127]
    s_waitcnt lgkmcnt(0)
    s_waitcnt vmcnt(20)
    v_mfma_f32_16x16x32_bf16 v[80:83], v[200:203], v[160:163], v[80:83]
    v_mfma_f32_16x16x32_bf16 v[84:87], v[200:203], v[164:167], v[84:87]
    v_mfma_f32_16x16x32_bf16 v[88:91], v[200:203], v[168:171], v[88:91]
    v_mfma_f32_16x16x32_bf16 v[92:95], v[200:203], v[172:175], v[92:95]
    s_waitcnt vmcnt(19)
    v_mfma_f32_16x16x32_bf16 v[96:99], v[204:207], v[160:163], v[96:99]
    v_mfma_f32_16x16x32_bf16 v[100:103], v[204:207], v[164:167], v[100:103]
    v_mfma_f32_16x16x32_bf16 v[104:107], v[204:207], v[168:171], v[104:107]
    v_mfma_f32_16x16x32_bf16 v[108:111], v[204:207], v[172:175], v[108:111]
    s_waitcnt vmcnt(18)
    v_mfma_f32_16x16x32_bf16 v[112:115], v[208:211], v[160:163], v[112:115]
    v_mfma_f32_16x16x32_bf16 v[116:119], v[208:211], v[164:167], v[116:119]
    v_mfma_f32_16x16x32_bf16 v[120:123], v[208:211], v[168:171], v[120:123]
    v_mfma_f32_16x16x32_bf16 v[124:127], v[208:211], v[172:175], v[124:127]
    s_mul_i32 s72, s4, 9
    s_lshr_b32 s72, s72, 1
    s_lshl_b32 s73, s3, 3
    s_add_u32 s73, s73, s4
    s_mul_i32 s73, s73, 73728
    s_add_u32 s73, s73, 15335424
    s_add_u32 s6, s72, s5
    s_add_u32 s6, s6, 8
    s_sub_u32 s7, s6, 36
    s_min_u32 s6, s6, s7
    s_lshl_b32 s6, s6, 11
    s_add_u32 s6, s6, s73
    v_cvt_pk_bf16_f32 v196, v80, v81
    v_cvt_pk_bf16_f32 v197, v82, v83
    v_cvt_pk_bf16_f32 v198, v84, v85
    v_cvt_pk_bf16_f32 v199, v86, v87
    buffer_store_dwordx4 v[196:199], v58, s[52:55], s6 offen offset:0 sc1
    v_cvt_pk_bf16_f32 v200, v88, v89
    v_cvt_pk_bf16_f32 v201, v90, v91
    v_cvt_pk_bf16_f32 v202, v92, v93
    v_cvt_pk_bf16_f32 v203, v94, v95
    buffer_store_dwordx4 v[200:203], v58, s[52:55], s6 offen offset:1024 sc1
    s_add_u32 s6, s72, s5
    s_add_u32 s6, s6, 16
    s_sub_u32 s7, s6, 36
    s_min_u32 s6, s6, s7
    s_lshl_b32 s6, s6, 11
    s_add_u32 s6, s6, s73
    v_cvt_pk_bf16_f32 v204, v96, v97
    v_cvt_pk_bf16_f32 v205, v98, v99
    v_cvt_pk_bf16_f32 v206, v100, v101
    v_cvt_pk_bf16_f32 v207, v102, v103
    buffer_store_dwordx4 v[204:207], v58, s[52:55], s6 offen offset:0 sc1
    v_cvt_pk_bf16_f32 v208, v104, v105
    v_cvt_pk_bf16_f32 v209, v106, v107
    v_cvt_pk_bf16_f32 v210, v108, v109
    v_cvt_pk_bf16_f32 v211, v110, v111
    buffer_store_dwordx4 v[208:211], v58, s[52:55], s6 offen offset:1024 sc1
    s_add_u32 s6, s72, s5
    s_add_u32 s6, s6, 24
    s_sub_u32 s7, s6, 36
    s_min_u32 s6, s6, s7
    s_lshl_b32 s6, s6, 11
    s_add_u32 s6, s6, s73
    v_cvt_pk_bf16_f32 v196, v112, v113
    v_cvt_pk_bf16_f32 v197, v114, v115
    v_cvt_pk_bf16_f32 v198, v116, v117
    v_cvt_pk_bf16_f32 v199, v118, v119
    buffer_store_dwordx4 v[196:199], v58, s[52:55], s6 offen offset:0 sc1
    v_cvt_pk_bf16_f32 v200, v120, v121
    v_cvt_pk_bf16_f32 v201, v122, v123
    v_cvt_pk_bf16_f32 v202, v124, v125
    v_cvt_pk_bf16_f32 v203, v126, v127
    buffer_store_dwordx4 v[200:203], v58, s[52:55], s6 offen offset:1024 sc1
    v_add_u32 v56, 0, v58
    ds_read_b128 v[144:147], v56 offset:0
    ds_read_b128 v[148:151], v56 offset:1024
    ds_read_b128 v[152:155], v56 offset:2048
    ds_read_b128 v[156:159], v56 offset:3072
    ds_read_b128 v[160:163], v56 offset:4096
    ds_read_b128 v[164:167], v56 offset:5120
    ds_read_b128 v[168:171], v56 offset:6144
    ds_read_b128 v[172:175], v56 offset:7168
    s_waitcnt lgkmcnt(4)
    s_waitcnt vmcnt(23)
    v_mfma_f32_16x16x32_bf16 v[64:67], v[8:11], v[144:147], 0
    v_mfma_f32_16x16x32_bf16 v[68:71], v[8:11], v[148:151], 0
    v_mfma_f32_16x16x32_bf16 v[72:75], v[8:11], v[152:155], 0
    v_mfma_f32_16x16x32_bf16 v[76:79], v[8:11], v[156:159], 0
    ds_read_b128 v[144:147], v56 offset:8192
    ds_read_b128 v[148:151], v56 offset:9216
    ds_read_b128 v[152:155], v56 offset:10240
    ds_read_b128 v[156:159], v56 offset:11264
    s_waitcnt lgkmcnt(4)
    s_waitcnt vmcnt(22)
    v_mfma_f32_16x16x32_bf16 v[64:67], v[12:15], v[160:163], v[64:67]
    v_mfma_f32_16x16x32_bf16 v[68:71], v[12:15], v[164:167], v[68:71]
    v_mfma_f32_16x16x32_bf16 v[72:75], v[12:15], v[168:171], v[72:75]
    v_mfma_f32_16x16x32_bf16 v[76:79], v[12:15], v[172:175], v[76:79]
    ds_read_b128 v[160:163], v56 offset:12288
    ds_read_b128 v[164:167], v56 offset:13312
    ds_read_b128 v[168:171], v56 offset:14336
    ds_read_b128 v[172:175], v56 offset:15360
    s_waitcnt lgkmcnt(4)
    s_waitcnt vmcnt(21)
    v_mfma_f32_16x16x32_bf16 v[64:67], v[16:19], v[144:147], v[64:67]
    v_mfma_f32_16x16x32_bf16 v[68:71], v[16:19], v[148:151], v[68:71]
    v_mfma_f32_16x16x32_bf16 v[72:75], v[16:19], v[152:155], v[72:75]
    v_mfma_f32_16x16x32_bf16 v[76:79], v[16:19], v[156:159], v[76:79]
    ds_read_b128 v[144:147], v56 offset:16384
    ds_read_b128 v[148:151], v56 offset:17408
    ds_read_b128 v[152:155], v56 offset:18432
    ds_read_b128 v[156:159], v56 offset:19456
    s_waitcnt lgkmcnt(4)
    s_waitcnt vmcnt(20)
    v_mfma_f32_16x16x32_bf16 v[64:67], v[20:23], v[160:163], v[64:67]
    v_mfma_f32_16x16x32_bf16 v[68:71], v[20:23], v[164:167], v[68:71]
    v_mfma_f32_16x16x32_bf16 v[72:75], v[20:23], v[168:171], v[72:75]
    v_mfma_f32_16x16x32_bf16 v[76:79], v[20:23], v[172:175], v[76:79]
    ds_read_b128 v[160:163], v56 offset:20480
    ds_read_b128 v[164:167], v56 offset:21504
    ds_read_b128 v[168:171], v56 offset:22528
    ds_read_b128 v[172:175], v56 offset:23552
    s_waitcnt lgkmcnt(4)
    s_waitcnt vmcnt(19)
    v_mfma_f32_16x16x32_bf16 v[64:67], v[24:27], v[144:147], v[64:67]
    v_mfma_f32_16x16x32_bf16 v[68:71], v[24:27], v[148:151], v[68:71]
    v_mfma_f32_16x16x32_bf16 v[72:75], v[24:27], v[152:155], v[72:75]
    v_mfma_f32_16x16x32_bf16 v[76:79], v[24:27], v[156:159], v[76:79]
    ds_read_b128 v[144:147], v56 offset:24576
    ds_read_b128 v[148:151], v56 offset:25600
    ds_read_b128 v[152:155], v56 offset:26624
    ds_read_b128 v[156:159], v56 offset:27648
    s_waitcnt lgkmcnt(4)
    s_waitcnt vmcnt(18)
    v_mfma_f32_16x16x32_bf16 v[64:67], v[28:31], v[160:163], v[64:67]
    v_mfma_f32_16x16x32_bf16 v[68:71], v[28:31], v[164:167], v[68:71]
    v_mfma_f32_16x16x32_bf16 v[72:75], v[28:31], v[168:171], v[72:75]
    v_mfma_f32_16x16x32_bf16 v[76:79], v[28:31], v[172:175], v[76:79]
    ds_read_b128 v[160:163], v56 offset:28672
    ds_read_b128 v[164:167], v56 offset:29696
    ds_read_b128 v[168:171], v56 offset:30720
    ds_read_b128 v[172:175], v56 offset:31744
    s_waitcnt lgkmcnt(4)
    s_waitcnt vmcnt(17)
    v_mfma_f32_16x16x32_bf16 v[64:67], v[32:35], v[144:147], v[64:67]
    v_mfma_f32_16x16x32_bf16 v[68:71], v[32:35], v[148:151], v[68:71]
    v_mfma_f32_16x16x32_bf16 v[72:75], v[32:35], v[152:155], v[72:75]
    v_mfma_f32_16x16x32_bf16 v[76:79], v[32:35], v[156:159], v[76:79]
    ds_read_b128 v[144:147], v56 offset:32768
    ds_read_b128 v[148:151], v56 offset:33792
    ds_read_b128 v[152:155], v56 offset:34816
    ds_read_b128 v[156:159], v56 offset:35840
    s_waitcnt lgkmcnt(4)
    s_waitcnt vmcnt(16)
    v_mfma_f32_16x16x32_bf16 v[64:67], v[36:39], v[160:163], v[64:67]
    v_mfma_f32_16x16x32_bf16 v[68:71], v[36:39], v[164:167], v[68:71]
    v_mfma_f32_16x16x32_bf16 v[72:75], v[36:39], v[168:171], v[72:75]
    v_mfma_f32_16x16x32_bf16 v[76:79], v[36:39], v[172:175], v[76:79]
    ds_read_b128 v[160:163], v56 offset:36864
    ds_read_b128 v[164:167], v56 offset:37888
    ds_read_b128 v[168:171], v56 offset:38912
    ds_read_b128 v[172:175], v56 offset:39936
    s_waitcnt lgkmcnt(4)
    s_waitcnt vmcnt(15)
    v_mfma_f32_16x16x32_bf16 v[64:67], v[40:43], v[144:147], v[64:67]
    v_mfma_f32_16x16x32_bf16 v[68:71], v[40:43], v[148:151], v[68:71]
    v_mfma_f32_16x16x32_bf16 v[72:75], v[40:43], v[152:155], v[72:75]
    v_mfma_f32_16x16x32_bf16 v[76:79], v[40:43], v[156:159], v[76:79]
    ds_read_b128 v[144:147], v56 offset:40960
    ds_read_b128 v[148:151], v56 offset:41984
    ds_read_b128 v[152:155], v56 offset:43008
    ds_read_b128 v[156:159], v56 offset:44032
    s_waitcnt lgkmcnt(4)
    s_waitcnt vmcnt(14)
    v_mfma_f32_16x16x32_bf16 v[64:67], v[44:47], v[160:163], v[64:67]
    v_mfma_f32_16x16x32_bf16 v[68:71], v[44:47], v[164:167], v[68:71]
    v_mfma_f32_16x16x32_bf16 v[72:75], v[44:47], v[168:171], v[72:75]
    v_mfma_f32_16x16x32_bf16 v[76:79], v[44:47], v[172:175], v[76:79]
    ds_read_b128 v[160:163], v56 offset:45056
    ds_read_b128 v[164:167], v56 offset:46080
    ds_read_b128 v[168:171], v56 offset:47104
    ds_read_b128 v[172:175], v56 offset:48128
    s_waitcnt lgkmcnt(4)
    s_waitcnt vmcnt(13)
    v_mfma_f32_16x16x32_bf16 v[64:67], v[48:51], v[144:147], v[64:67]
    v_mfma_f32_16x16x32_bf16 v[68:71], v[48:51], v[148:151], v[68:71]
    v_mfma_f32_16x16x32_bf16 v[72:75], v[48:51], v[152:155], v[72:75]
    v_mfma_f32_16x16x32_bf16 v[76:79], v[48:51], v[156:159], v[76:79]
    ds_read_b128 v[144:147], v56 offset:49152
    ds_read_b128 v[148:151], v56 offset:50176
    ds_read_b128 v[152:155], v56 offset:51200
    ds_read_b128 v[156:159], v56 offset:52224
    s_waitcnt lgkmcnt(4)
    s_waitcnt vmcnt(12)
    v_mfma_f32_16x16x32_bf16 v[64:67], v[52:55], v[160:163], v[64:67]
    v_mfma_f32_16x16x32_bf16 v[68:71], v[52:55], v[164:167], v[68:71]
    v_mfma_f32_16x16x32_bf16 v[72:75], v[52:55], v[168:171], v[72:75]
    v_mfma_f32_16x16x32_bf16 v[76:79], v[52:55], v[172:175], v[76:79]
    ds_read_b128 v[160:163], v56 offset:53248
    ds_read_b128 v[164:167], v56 offset:54272
    ds_read_b128 v[168:171], v56 offset:55296
    ds_read_b128 v[172:175], v56 offset:56320
    s_waitcnt lgkmcnt(4)
    s_waitcnt vmcnt(11)
    v_mfma_f32_16x16x32_bf16 v[64:67], v[212:215], v[144:147], v[64:67]
    v_mfma_f32_16x16x32_bf16 v[68:71], v[212:215], v[148:151], v[68:71]
    v_mfma_f32_16x16x32_bf16 v[72:75], v[212:215], v[152:155], v[72:75]
    v_mfma_f32_16x16x32_bf16 v[76:79], v[212:215], v[156:159], v[76:79]
    v_add_u32 v56, 57344, v56
    ds_read_b128 v[144:147], v56 offset:0
    ds_read_b128 v[148:151], v56 offset:1024
    ds_read_b128 v[152:155], v56 offset:2048
    ds_read_b128 v[156:159], v56 offset:3072
    s_waitcnt lgkmcnt(4)
    s_waitcnt vmcnt(10)
    v_mfma_f32_16x16x32_bf16 v[64:67], v[216:219], v[160:163], v[64:67]
    v_mfma_f32_16x16x32_bf16 v[68:71], v[216:219], v[164:167], v[68:71]
    v_mfma_f32_16x16x32_bf16 v[72:75], v[216:219], v[168:171], v[72:75]
    v_mfma_f32_16x16x32_bf16 v[76:79], v[216:219], v[172:175], v[76:79]
    ds_read_b128 v[160:163], v56 offset:4096
    ds_read_b128 v[164:167], v56 offset:5120
    ds_read_b128 v[168:171], v56 offset:6144
    ds_read_b128 v[172:175], v56 offset:7168
    s_waitcnt lgkmcnt(4)
    s_waitcnt vmcnt(9)
    v_mfma_f32_16x16x32_bf16 v[64:67], v[220:223], v[144:147], v[64:67]
    v_mfma_f32_16x16x32_bf16 v[68:71], v[220:223], v[148:151], v[68:71]
    v_mfma_f32_16x16x32_bf16 v[72:75], v[220:223], v[152:155], v[72:75]
    v_mfma_f32_16x16x32_bf16 v[76:79], v[220:223], v[156:159], v[76:79]
    ds_read_b128 v[144:147], v56 offset:8192
    ds_read_b128 v[148:151], v56 offset:9216
    ds_read_b128 v[152:155], v56 offset:10240
    ds_read_b128 v[156:159], v56 offset:11264
    s_waitcnt lgkmcnt(4)
    s_waitcnt vmcnt(8)
    v_mfma_f32_16x16x32_bf16 v[64:67], v[224:227], v[160:163], v[64:67]
    v_mfma_f32_16x16x32_bf16 v[68:71], v[224:227], v[164:167], v[68:71]
    v_mfma_f32_16x16x32_bf16 v[72:75], v[224:227], v[168:171], v[72:75]
    v_mfma_f32_16x16x32_bf16 v[76:79], v[224:227], v[172:175], v[76:79]
    ds_read_b128 v[160:163], v56 offset:12288
    ds_read_b128 v[164:167], v56 offset:13312
    ds_read_b128 v[168:171], v56 offset:14336
    ds_read_b128 v[172:175], v56 offset:15360
    s_waitcnt lgkmcnt(4)
    s_waitcnt vmcnt(7)
    v_mfma_f32_16x16x32_bf16 v[64:67], v[228:231], v[144:147], v[64:67]
    v_mfma_f32_16x16x32_bf16 v[68:71], v[228:231], v[148:151], v[68:71]
    v_mfma_f32_16x16x32_bf16 v[72:75], v[228:231], v[152:155], v[72:75]
    v_mfma_f32_16x16x32_bf16 v[76:79], v[228:231], v[156:159], v[76:79]
    s_waitcnt lgkmcnt(0)
    s_waitcnt vmcnt(6)
    v_mfma_f32_16x16x32_bf16 v[64:67], v[232:235], v[160:163], v[64:67]
    v_mfma_f32_16x16x32_bf16 v[68:71], v[232:235], v[164:167], v[68:71]
    v_mfma_f32_16x16x32_bf16 v[72:75], v[232:235], v[168:171], v[72:75]
    v_mfma_f32_16x16x32_bf16 v[76:79], v[232:235], v[172:175], v[76:79]
    s_add_u32 s6, s72, s5
    s_sub_u32 s7, s6, 36
    s_min_u32 s6, s6, s7
    s_lshl_b32 s6, s6, 11
    s_add_u32 s6, s6, s73
    s_cmp_gt_u32 s5, 4
    s_cbranch_scc1 L_st_90
    s_cmp_lg_u32 s5, 0
    s_cbranch_scc1 L_own_89
    s_and_b32 s7, s4, 1
    s_cmp_eq_u32 s7, 0
    s_cbranch_scc1 L_own_89
L_st_90:
    v_cvt_pk_bf16_f32 v144, v64, v65
    v_cvt_pk_bf16_f32 v145, v66, v67
    v_cvt_pk_bf16_f32 v146, v68, v69
    v_cvt_pk_bf16_f32 v147, v70, v71
    buffer_store_dwordx4 v[144:147], v58, s[52:55], s6 offen offset:0 sc1
L_own_89:
    s_cmp_gt_u32 s5, 4
    s_cbranch_scc1 L_st_92
    s_cmp_lg_u32 s5, 4
    s_cbranch_scc1 L_own_91
    s_and_b32 s7, s4, 1
    s_cmp_eq_u32 s7, 1
    s_cbranch_scc1 L_own_91
L_st_92:
    v_cvt_pk_bf16_f32 v148, v72, v73
    v_cvt_pk_bf16_f32 v149, v74, v75
    v_cvt_pk_bf16_f32 v150, v76, v77
    v_cvt_pk_bf16_f32 v151, v78, v79
    buffer_store_dwordx4 v[148:151], v58, s[52:55], s6 offen offset:1024 sc1
L_own_91:
    v_mov_b32 v240, v64
    v_mov_b32 v241, v65
    v_mov_b32 v242, v66
    v_mov_b32 v243, v67
    v_mov_b32 v244, v68
    v_mov_b32 v245, v69
    v_mov_b32 v246, v70
    v_mov_b32 v247, v71
    v_mov_b32 v248, v72
    v_mov_b32 v249, v73
    v_mov_b32 v250, v74
    v_mov_b32 v251, v75
    v_mov_b32 v252, v76
    v_mov_b32 v253, v77
    v_mov_b32 v254, v78
    v_mov_b32 v255, v79
    s_waitcnt vmcnt(0)
    v_mov_b32 v2, 163668
    v_mov_b32 v3, 1
    s_mov_b64 s[14:15], exec
    s_mov_b64 exec, 1
    ds_add_rtn_u32 v4, v2, v3
    s_waitcnt lgkmcnt(0)
    v_readfirstlane_b32 s6, v4
    s_cmp_lg_u32 s6, 3
    s_cbranch_scc1 L_cs_93
    s_lshl_b32 s6, s3, 7
    s_add_u32 s6, s6, 34209792
    v_mov_b32 v2, 0
    buffer_atomic_add v3, v2, s[52:55], s6 offen sc1
L_cs_93:
    s_mov_b64 exec, s[14:15]
    s_cmp_eq_u32 s5, 7
    s_cbranch_scc1 L_poller_94
    s_cmp_gt_u32 s5, 4
    s_cbranch_scc1 L_out
    s_add_u32 s74, s72, s5
    s_and_b32 s75, s4, 1
    v_and_b32 v2, 15, v1
    v_lshrrev_b32 v3, 4, v1
    s_lshl_b32 s6, s3, 6
    v_add_u32 v4, s6, v2
    v_mul_u32_u24 v4, 1152, v4
    s_lshl_b32 s6, s74, 5
    v_lshl_add_u32 v4, v3, 3, v4
    v_add_u32 v59, s6, v4
    s_mov_b32 s6, 0
    buffer_load_dwordx2 v[144:145], v59, s[48:51], s6 offen
    s_mov_b32 s6, 18432
    buffer_load_dwordx2 v[146:147], v59, s[48:51], s6 offen
    s_mov_b32 s6, 36864
    buffer_load_dwordx2 v[148:149], v59, s[48:51], s6 offen
    s_mov_b32 s6, 55296
    buffer_load_dwordx2 v[150:151], v59, s[48:51], s6 offen
    s_lshl_b32 s6, s74, 5
    v_lshl_add_u32 v4, v3, 3, s6
    global_load_dwordx2 v[6:7], v4, s[38:39]
    v_lshlrev_b32 v3, 14, v3
    v_lshl_add_u32 v60, v2, 1, v3
    s_lshl_b32 s6, s74, 16
    s_lshl_b32 s7, s3, 7
    s_add_u32 s6, s6, s7
    s_add_u32 s76, s6, 12976128
    v_mov_b32 v8, 0x00003f80
    v_mov_b32 v9, 0x3f800000
    s_mul_i32 s6, s3, 589824
    s_lshl_b32 s7, s74, 11
    s_add_u32 s6, s6, s7
    s_add_u32 s78, s6, 15335424
    s_mov_b32 s79, 0
    s_branch L_fin_41
L_poller_94:
    s_lshl_b32 s6, s3, 7
    v_and_b32 v2, 1, v1
    v_lshlrev_b32 v2, 13, v2
    v_add_u32 v2, s6, v2
    s_mov_b32 s7, 34209792
    s_mov_b32 s6, 0
L_fp_95:
    buffer_load_dword v3, v2, s[52:55], s7 offen sc1
    s_add_u32 s6, s6, 1
    s_cmp_gt_u32 s6, 2000000
    s_cbranch_scc1 L_fp_d_96
    s_waitcnt vmcnt(0)
    v_cmp_gt_u32 vcc, 8, v3
    s_nop 4
    s_cbranch_vccz L_fp_d_96
    s_sleep 3
    s_branch L_fp_95
L_fp_d_96:
    v_and_b32 v2, 7, v1
    v_lshlrev_b32 v2, 7, v2
    v_add_u32 v2, 4096, v2
    s_mov_b32 s7, 34209792
    s_mov_b32 s6, 0
L_fp_97:
    buffer_load_dword v3, v2, s[52:55], s7 offen sc1
    s_add_u32 s6, s6, 1
    s_cmp_gt_u32 s6, 2000000
    s_cbranch_scc1 L_fp_d_98
    s_waitcnt vmcnt(0)
    v_cmp_gt_u32 vcc, 32, v3
    s_nop 4
    s_cbranch_vccz L_fp_d_98
    s_sleep 3
    s_branch L_fp_97
L_fp_d_98:
    v_mov_b32 v2, 163672
    v_mov_b32 v3, 1
    ds_write_b32 v2, v3
    s_waitcnt lgkmcnt(0)
    s_branch L_out
L_fin_41:
    v_mov_b32 v2, 163672
    s_mov_b32 s6, 0
L_fw_99:
    ds_read_b32 v4, v2
    s_add_u32 s6, s6, 1
    s_cmp_gt_u32 s6, 40000000
    s_cbranch_scc1 L_fw_d_100
    s_waitcnt lgkmcnt(0)
    v_readfirstlane_b32 s7, v4
    s_cmp_lg_u32 s7, 0
    s_cbranch_scc1 L_fw_d_100
    s_sleep 1
    s_branch L_fw_99
L_fw_d_100:
    s_mov_b32 s10, 268435456
    s_cmp_eq_u32 s5, 0
    s_cselect_b32 s8, s75, 0
    s_xor_b32 s9, s75, 1
    s_cmp_eq_u32 s5, 4
    s_cselect_b32 s9, s9, 0
    s_lshl_b32 s8, s8, 28
    s_lshl_b32 s9, s9, 28
    s_add_u32 s6, s4, 1
    s_and_b32 s6, s6, 7
    s_mul_i32 s6, s6, 73728
    s_add_u32 s6, s6, s78
    s_bitcmp1_b32 s79, 1
    s_cselect_b32 s6, s10, s6
    s_or_b32 s7, s6, s8
    buffer_load_dwordx4 v[168:171], v58, s[52:55], s7 offen offset:0 sc1
    s_or_b32 s7, s6, s9
    buffer_load_dwordx4 v[172:175], v58, s[52:55], s7 offen offset:1024 sc1
    s_add_u32 s6, s4, 2
    s_and_b32 s6, s6, 7
    s_mul_i32 s6, s6, 73728
    s_add_u32 s6, s6, s78
    s_bitcmp1_b32 s79, 2
    s_cselect_b32 s6, s10, s6
    s_or_b32 s7, s6, s8
    buffer_load_dwordx4 v[176:179], v58, s[52:55], s7 offen offset:0 sc1
    s_or_b32 s7, s6, s9
    buffer_load_dwordx4 v[180:183], v58, s[52:55], s7 offen offset:1024 sc1
    s_add_u32 s6, s4, 3
    s_and_b32 s6, s6, 7
    s_mul_i32 s6, s6, 73728
    s_add_u32 s6, s6, s78
    s_bitcmp1_b32 s79, 3
    s_cselect_b32 s6, s10, s6
    s_or_b32 s7, s6, s8
    buffer_load_dwordx4 v[184:187], v58, s[52:55], s7 offen offset:0 sc1
    s_or_b32 s7, s6, s9
    buffer_load_dwordx4 v[188:191], v58, s[52:55], s7 offen offset:1024 sc1
    s_add_u32 s6, s4, 4
    s_and_b32 s6, s6, 7
    s_mul_i32 s6, s6, 73728
    s_add_u32 s6, s6, s78
    s_bitcmp1_b32 s79, 4
    s_cselect_b32 s6, s10, s6
    s_or_b32 s7, s6, s8
    buffer_load_dwordx4 v[192:195], v58, s[52:55], s7 offen offset:0 sc1
    s_or_b32 s7, s6, s9
    buffer_load_dwordx4 v[196:199], v58, s[52:55], s7 offen offset:1024 sc1
    s_add_u32 s6, s4, 5
    s_and_b32 s6, s6, 7
    s_mul_i32 s6, s6, 73728
    s_add_u32 s6, s6, s78
    s_bitcmp1_b32 s79, 5
    s_cselect_b32 s6, s10, s6
    s_or_b32 s7, s6, s8
    buffer_load_dwordx4 v[200:203], v58, s[52:55], s7 offen offset:0 sc1
    s_or_b32 s7, s6, s9
    buffer_load_dwordx4 v[204:207], v58, s[52:55], s7 offen offset:1024 sc1
    s_add_u32 s6, s4, 6
    s_and_b32 s6, s6, 7
    s_mul_i32 s6, s6, 73728
    s_add_u32 s6, s6, s78
    s_bitcmp1_b32 s79, 6
    s_cselect_b32 s6, s10, s6
    s_or_b32 s7, s6, s8
    buffer_load_dwordx4 v[208:211], v58, s[52:55], s7 offen offset:0 sc1
    s_or_b32 s7, s6, s9
    buffer_load_dwordx4 v[212:215], v58, s[52:55], s7 offen offset:1024 sc1
    s_add_u32 s6, s4, 7
    s_and_b32 s6, s6, 7
    s_mul_i32 s6, s6, 73728
    s_add_u32 s6, s6, s78
    s_bitcmp1_b32 s79, 7
    s_cselect_b32 s6, s10, s6
    s_or_b32 s7, s6, s8
    buffer_load_dwordx4 v[216:219], v58, s[52:55], s7 offen offset:0 sc1
    s_or_b32 s7, s6, s9
    buffer_load_dwordx4 v[220:223], v58, s[52:55], s7 offen offset:1024 sc1
    s_lshl_b32 s8, s5, 11
    s_add_u32 s8, s8, 139264
    v_lshrrev_b32 v2, 3, v1
    v_lshlrev_b32 v2, 12, v2
    v_and_b32 v3, 7, v1
    v_lshl_add_u32 v2, v3, 4, v2
    s_add_u32 m0, s8, 0
    s_add_u32 s6, s76, 0
    buffer_load_dwordx4 v2, s[52:55], s6 offen sc1 lds
    s_add_u32 m0, s8, 1024
    s_add_u32 s6, s76, 32768
    buffer_load_dwordx4 v2, s[52:55], s6 offen sc1 lds
    v_and_b32 v2, 15, v1
    v_lshrrev_b32 v3, 4, v1
    v_lshlrev_b32 v3, 9, v3
    v_lshl_add_u32 v3, v2, 1, v3
    v_add_u32 v3, s8, v3
    v_mov_b32 v152, 0
    v_mov_b32 v153, 0
    v_mov_b32 v154, 0
    v_mov_b32 v155, 0
    v_mov_b32 v156, 0
    v_mov_b32 v157, 0
    v_mov_b32 v158, 0
    v_mov_b32 v159, 0
    v_mov_b32 v160, 0
    v_mov_b32 v161, 0
    v_mov_b32 v162, 0
    v_mov_b32 v163, 0
    v_mov_b32 v164, 0
    v_mov_b32 v165, 0
    v_mov_b32 v166, 0
    v_mov_b32 v167, 0
    s_waitcnt vmcnt(0)
    ds_read_u16_d16_hi v152, v3 offset:0
    ds_read_u16_d16_hi v153, v3 offset:128
    ds_read_u16_d16_hi v154, v3 offset:256
    ds_read_u16_d16_hi v155, v3 offset:384
    ds_read_u16_d16_hi v156, v3 offset:32
    ds_read_u16_d16_hi v157, v3 offset:160
    ds_read_u16_d16_hi v158, v3 offset:288
    ds_read_u16_d16_hi v159, v3 offset:416
    ds_read_u16_d16_hi v160, v3 offset:64
    ds_read_u16_d16_hi v161, v3 offset:192
    ds_read_u16_d16_hi v162, v3 offset:320
    ds_read_u16_d16_hi v163, v3 offset:448
    ds_read_u16_d16_hi v164, v3 offset:96
    ds_read_u16_d16_hi v165, v3 offset:224
    ds_read_u16_d16_hi v166, v3 offset:352
    ds_read_u16_d16_hi v167, v3 offset:480
    v_lshlrev_b32 v4, 16, v6
    v_and_b32 v5, 0xffff0000, v6
    v_lshlrev_b32 v6, 16, v7
    v_and_b32 v7, 0xffff0000, v7
    v_dot2_f32_bf16 v240, v168, v8, v240
    v_dot2_f32_bf16 v241, v168, v9, v241
    v_dot2_f32_bf16 v242, v169, v8, v242
    v_dot2_f32_bf16 v243, v169, v9, v243
    v_dot2_f32_bf16 v244, v170, v8, v244
    v_dot2_f32_bf16 v245, v170, v9, v245
    v_dot2_f32_bf16 v246, v171, v8, v246
    v_dot2_f32_bf16 v247, v171, v9, v247
    v_dot2_f32_bf16 v248, v172, v8, v248
    v_dot2_f32_bf16 v249, v172, v9, v249
    v_dot2_f32_bf16 v250, v173, v8, v250
    v_dot2_f32_bf16 v251, v173, v9, v251
    v_dot2_f32_bf16 v252, v174, v8, v252
    v_dot2_f32_bf16 v253, v174, v9, v253
    v_dot2_f32_bf16 v254, v175, v8, v254
    v_dot2_f32_bf16 v255, v175, v9, v255
    v_dot2_f32_bf16 v240, v176, v8, v240
    v_dot2_f32_bf16 v241, v176, v9, v241
    v_dot2_f32_bf16 v242, v177, v8, v242
    v_dot2_f32_bf16 v243, v177, v9, v243
    v_dot2_f32_bf16 v244, v178, v8, v244
    v_dot2_f32_bf16 v245, v178, v9, v245
    v_dot2_f32_bf16 v246, v179, v8, v246
    v_dot2_f32_bf16 v247, v179, v9, v247
    v_dot2_f32_bf16 v248, v180, v8, v248
    v_dot2_f32_bf16 v249, v180, v9, v249
    v_dot2_f32_bf16 v250, v181, v8, v250
    v_dot2_f32_bf16 v251, v181, v9, v251
    v_dot2_f32_bf16 v252, v182, v8, v252
    v_dot2_f32_bf16 v253, v182, v9, v253
    v_dot2_f32_bf16 v254, v183, v8, v254
    v_dot2_f32_bf16 v255, v183, v9, v255
    v_dot2_f32_bf16 v240, v184, v8, v240
    v_dot2_f32_bf16 v241, v184, v9, v241
    v_dot2_f32_bf16 v242, v185, v8, v242
    v_dot2_f32_bf16 v243, v185, v9, v243
    v_dot2_f32_bf16 v244, v186, v8, v244
    v_dot2_f32_bf16 v245, v186, v9, v245
    v_dot2_f32_bf16 v246, v187, v8, v246
    v_dot2_f32_bf16 v247, v187, v9, v247
    v_dot2_f32_bf16 v248, v188, v8, v248
    v_dot2_f32_bf16 v249, v188, v9, v249
    v_dot2_f32_bf16 v250, v189, v8, v250
    v_dot2_f32_bf16 v251, v189, v9, v251
    v_dot2_f32_bf16 v252, v190, v8, v252
    v_dot2_f32_bf16 v253, v190, v9, v253
    v_dot2_f32_bf16 v254, v191, v8, v254
    v_dot2_f32_bf16 v255, v191, v9, v255
    v_dot2_f32_bf16 v240, v192, v8, v240
    v_dot2_f32_bf16 v241, v192, v9, v241
    v_dot2_f32_bf16 v242, v193, v8, v242
    v_dot2_f32_bf16 v243, v193, v9, v243
    v_dot2_f32_bf16 v244, v194, v8, v244
    v_dot2_f32_bf16 v245, v194, v9, v245
    v_dot2_f32_bf16 v246, v195, v8, v246
    v_dot2_f32_bf16 v247, v195, v9, v247
    v_dot2_f32_bf16 v248, v196, v8, v248
    v_dot2_f32_bf16 v249, v196, v9, v249
    v_dot2_f32_bf16 v250, v197, v8, v250
    v_dot2_f32_bf16 v251, v197, v9, v251
    v_dot2_f32_bf16 v252, v198, v8, v252
    v_dot2_f32_bf16 v253, v198, v9, v253
    v_dot2_f32_bf16 v254, v199, v8, v254
    v_dot2_f32_bf16 v255, v199, v9, v255
    v_dot2_f32_bf16 v240, v200, v8, v240
    v_dot2_f32_bf16 v241, v200, v9, v241
    v_dot2_f32_bf16 v242, v201, v8, v242
    v_dot2_f32_bf16 v243, v201, v9, v243
    v_dot2_f32_bf16 v244, v202, v8, v244
    v_dot2_f32_bf16 v245, v202, v9, v245
    v_dot2_f32_bf16 v246, v203, v8, v246
    v_dot2_f32_bf16 v247, v203, v9, v247
    v_dot2_f32_bf16 v248, v204, v8, v248
    v_dot2_f32_bf16 v249, v204, v9, v249
    v_dot2_f32_bf16 v250, v205, v8, v250
    v_dot2_f32_bf16 v251, v205, v9, v251
    v_dot2_f32_bf16 v252, v206, v8, v252
    v_dot2_f32_bf16 v253, v206, v9, v253
    v_dot2_f32_bf16 v254, v207, v8, v254
    v_dot2_f32_bf16 v255, v207, v9, v255
    v_dot2_f32_bf16 v240, v208, v8, v240
    v_dot2_f32_bf16 v241, v208, v9, v241
    v_dot2_f32_bf16 v242, v209, v8, v242
    v_dot2_f32_bf16 v243, v209, v9, v243
    v_dot2_f32_bf16 v244, v210, v8, v244
    v_dot2_f32_bf16 v245, v210, v9, v245
    v_dot2_f32_bf16 v246, v211, v8, v246
    v_dot2_f32_bf16 v247, v211, v9, v247
    v_dot2_f32_bf16 v248, v212, v8, v248
    v_dot2_f32_bf16 v249, v212, v9, v249
    v_dot2_f32_bf16 v250, v213, v8, v250
    v_dot2_f32_bf16 v251, v213, v9, v251
    v_dot2_f32_bf16 v252, v214, v8, v252
    v_dot2_f32_bf16 v253, v214, v9, v253
    v_dot2_f32_bf16 v254, v215, v8, v254
    v_dot2_f32_bf16 v255, v215, v9, v255
    v_dot2_f32_bf16 v240, v216, v8, v240
    v_dot2_f32_bf16 v241, v216, v9, v241
    v_dot2_f32_bf16 v242, v217, v8, v242
    v_dot2_f32_bf16 v243, v217, v9, v243
    v_dot2_f32_bf16 v244, v218, v8, v244
    v_dot2_f32_bf16 v245, v218, v9, v245
    v_dot2_f32_bf16 v246, v219, v8, v246
    v_dot2_f32_bf16 v247, v219, v9, v247
    v_dot2_f32_bf16 v248, v220, v8, v248
    v_dot2_f32_bf16 v249, v220, v9, v249
    v_dot2_f32_bf16 v250, v221, v8, v250
    v_dot2_f32_bf16 v251, v221, v9, v251
    v_dot2_f32_bf16 v252, v222, v8, v252
    v_dot2_f32_bf16 v253, v222, v9, v253
    v_dot2_f32_bf16 v254, v223, v8, v254
    v_dot2_f32_bf16 v255, v223, v9, v255
    s_waitcnt lgkmcnt(0)
    s_cmp_lg_u32 s5, 0
    s_cbranch_scc1 L_fin_own_102
    s_cmp_eq_u32 s75, 1
    s_cbranch_scc1 L_fin_c_101
L_fin_own_102:
    v_add_f32 v240, v240, v4
    v_add_f32 v241, v241, v5
    v_add_f32 v242, v242, v6
    v_add_f32 v243, v243, v7
    v_mul_f32 v16, 0xbfb8aa3b, v240
    v_mul_f32 v17, 0xbfb8aa3b, v241
    v_mul_f32 v18, 0xbfb8aa3b, v242
    v_mul_f32 v19, 0xbfb8aa3b, v243
    v_exp_f32 v16, v16
    v_exp_f32 v17, v17
    v_exp_f32 v18, v18
    v_exp_f32 v19, v19
    v_add_f32 v16, 1.0, v16
    v_add_f32 v17, 1.0, v17
    v_add_f32 v18, 1.0, v18
    v_add_f32 v19, 1.0, v19
    v_rcp_f32 v16, v16
    v_rcp_f32 v17, v17
    v_rcp_f32 v18, v18
    v_rcp_f32 v19, v19
    v_mul_f32 v240, v240, v16
    v_mul_f32 v241, v241, v17
    v_mul_f32 v242, v242, v18
    v_mul_f32 v243, v243, v19
    v_lshlrev_b32 v20, 16, v144
    v_and_b32 v21, 0xffff0000, v144
    v_lshlrev_b32 v22, 16, v145
    v_and_b32 v23, 0xffff0000, v145
    v_fma_f32 v240, v240, v152, v20
    v_fma_f32 v241, v241, v153, v21
    v_fma_f32 v242, v242, v154, v22
    v_fma_f32 v243, v243, v155, v23
    v_cvt_pk_bf16_f32 v24, v240, v241
    v_cvt_pk_bf16_f32 v25, v242, v243
    s_mov_b32 s6, 0
    buffer_store_dwordx2 v[24:25], v59, s[64:67], s6 offen nt
    v_add_f32 v244, v244, v4
    v_add_f32 v245, v245, v5
    v_add_f32 v246, v246, v6
    v_add_f32 v247, v247, v7
    v_mul_f32 v28, 0xbfb8aa3b, v244
    v_mul_f32 v29, 0xbfb8aa3b, v245
    v_mul_f32 v30, 0xbfb8aa3b, v246
    v_mul_f32 v31, 0xbfb8aa3b, v247
    v_exp_f32 v28, v28
    v_exp_f32 v29, v29
    v_exp_f32 v30, v30
    v_exp_f32 v31, v31
    v_add_f32 v28, 1.0, v28
    v_add_f32 v29, 1.0, v29
    v_add_f32 v30, 1.0, v30
    v_add_f32 v31, 1.0, v31
    v_rcp_f32 v28, v28
    v_rcp_f32 v29, v29
    v_rcp_f32 v30, v30
    v_rcp_f32 v31, v31
    v_mul_f32 v244, v244, v28
    v_mul_f32 v245, v245, v29
    v_mul_f32 v246, v246, v30
    v_mul_f32 v247, v247, v31
    v_lshlrev_b32 v32, 16, v146
    v_and_b32 v33, 0xffff0000, v146
    v_lshlrev_b32 v34, 16, v147
    v_and_b32 v35, 0xffff0000, v147
    v_fma_f32 v244, v244, v156, v32
    v_fma_f32 v245, v245, v157, v33
    v_fma_f32 v246, v246, v158, v34
    v_fma_f32 v247, v247, v159, v35
    v_cvt_pk_bf16_f32 v36, v244, v245
    v_cvt_pk_bf16_f32 v37, v246, v247
    s_mov_b32 s6, 18432
    buffer_store_dwordx2 v[36:37], v59, s[64:67], s6 offen nt
L_fin_c_101:
    s_cmp_lg_u32 s5, 4
    s_cbranch_scc1 L_fin_own_104
    s_cmp_eq_u32 s75, 0
    s_cbranch_scc1 L_fin_c_103
L_fin_own_104:
    v_add_f32 v248, v248, v4
    v_add_f32 v249, v249, v5
    v_add_f32 v250, v250, v6
    v_add_f32 v251, v251, v7
    v_mul_f32 v16, 0xbfb8aa3b, v248
    v_mul_f32 v17, 0xbfb8aa3b, v249
    v_mul_f32 v18, 0xbfb8aa3b, v250
    v_mul_f32 v19, 0xbfb8aa3b, v251
    v_exp_f32 v16, v16
    v_exp_f32 v17, v17
    v_exp_f32 v18, v18
    v_exp_f32 v19, v19
    v_add_f32 v16, 1.0, v16
    v_add_f32 v17, 1.0, v17
    v_add_f32 v18, 1.0, v18
    v_add_f32 v19, 1.0, v19
    v_rcp_f32 v16, v16
    v_rcp_f32 v17, v17
    v_rcp_f32 v18, v18
    v_rcp_f32 v19, v19
    v_mul_f32 v248, v248, v16
    v_mul_f32 v249, v249, v17
    v_mul_f32 v250, v250, v18
    v_mul_f32 v251, v251, v19
    v_lshlrev_b32 v20, 16, v148
    v_and_b32 v21, 0xffff0000, v148
    v_lshlrev_b32 v22, 16, v149
    v_and_b32 v23, 0xffff0000, v149
    v_fma_f32 v248, v248, v160, v20
    v_fma_f32 v249, v249, v161, v21
    v_fma_f32 v250, v250, v162, v22
    v_fma_f32 v251, v251, v163, v23
    v_cvt_pk_bf16_f32 v24, v248, v249
    v_cvt_pk_bf16_f32 v25, v250, v251
    s_mov_b32 s6, 36864
    buffer_store_dwordx2 v[24:25], v59, s[64:67], s6 offen nt
    v_add_f32 v252, v252, v4
    v_add_f32 v253, v253, v5
    v_add_f32 v254, v254, v6
    v_add_f32 v255, v255, v7
    v_mul_f32 v28, 0xbfb8aa3b, v252
    v_mul_f32 v29, 0xbfb8aa3b, v253
    v_mul_f32 v30, 0xbfb8aa3b, v254
    v_mul_f32 v31, 0xbfb8aa3b, v255
    v_exp_f32 v28, v28
    v_exp_f32 v29, v29
    v_exp_f32 v30, v30
    v_exp_f32 v31, v31
    v_add_f32 v28, 1.0, v28
    v_add_f32 v29, 1.0, v29
    v_add_f32 v30, 1.0, v30
    v_add_f32 v31, 1.0, v31
    v_rcp_f32 v28, v28
    v_rcp_f32 v29, v29
    v_rcp_f32 v30, v30
    v_rcp_f32 v31, v31
    v_mul_f32 v252, v252, v28
    v_mul_f32 v253, v253, v29
    v_mul_f32 v254, v254, v30
    v_mul_f32 v255, v255, v31
    v_lshlrev_b32 v32, 16, v150
    v_and_b32 v33, 0xffff0000, v150
    v_lshlrev_b32 v34, 16, v151
    v_and_b32 v35, 0xffff0000, v151
    v_fma_f32 v252, v252, v164, v32
    v_fma_f32 v253, v253, v165, v33
    v_fma_f32 v254, v254, v166, v34
    v_fma_f32 v255, v255, v167, v35
    v_cvt_pk_bf16_f32 v36, v252, v253
    v_cvt_pk_bf16_f32 v37, v254, v255
    s_mov_b32 s6, 55296
    buffer_store_dwordx2 v[36:37], v59, s[64:67], s6 offen nt
L_fin_c_103:
L_out:
L_end:
    s_endpgm
L_code_end:
.section .rodata,"a"
.p2align 6
.amdhsa_kernel recurrent_scan__ssm_conv_s4d__mixer_channel_mlp__prompt_kernel
  .amdhsa_next_free_vgpr 256
  .amdhsa_next_free_sgpr 102
  .amdhsa_accum_offset 256
  .amdhsa_group_segment_fixed_size 0
  .amdhsa_kernarg_size 120
  .amdhsa_user_sgpr_count 2
  .amdhsa_user_sgpr_kernarg_segment_ptr 1
  .amdhsa_system_sgpr_workgroup_id_x 1
  .amdhsa_float_denorm_mode_32 3
.end_amdhsa_kernel
```
